```python
import torch

def _softmax(x, axis=-1):
    return torch.softmax(x, dim=axis)

def _gelu(x):
    return torch.nn.functional.gelu(x, approximate='tanh')

def _silu(x):
    return torch.nn.functional.silu(x)

def _sigmoid(x):
    return torch.sigmoid(x)

def _layernorm(x, axis=-1, eps=1e-05):
    m = x.mean(dim=axis, keepdim=True)
    v = x.var(dim=axis, keepdim=True, unbiased=False)
    return (x - m) / torch.sqrt(v + eps)

def _scatter_add(tgt, idx, src, axis=0):
    return tgt.clone().index_add_(axis, idx, src)

def _segment_sum(src, seg, n):
    out = torch.zeros((n,) + src.shape[1:], dtype=src.dtype)
    return out.index_add_(0, seg, src)

def _pad(x, pw):
    flat = tuple((v for pair in reversed(pw) for v in pair))
    return torch.nn.functional.pad(x, flat)
kernel_name = 'adaLN_cond__grouped_kv_mqa__mixer_gmlp__prompt'

def setup_inputs():

    _w = lambda a: (lambda t: t.to(torch.bfloat16) if t.is_floating_point() else t)(torch.as_tensor(a))

    def _A_setup():
        B, S, D, H = (1, 2048, 512, 32)
        Dh = D // H
        return {'x': _w((lambda *s: torch.randn(*s, dtype=torch.bfloat16) * 0.05)(B, S, D)), 'wq': _w((lambda *s: torch.randn(*s, dtype=torch.bfloat16) * 0.05)(D, H * Dh)), 'wk': _w((lambda *s: torch.randn(*s, dtype=torch.bfloat16) * 0.05)(D, Dh)), 'wv': _w((lambda *s: torch.randn(*s, dtype=torch.bfloat16) * 0.05)(D, Dh)), 'wo': _w((lambda *s: torch.randn(*s, dtype=torch.bfloat16) * 0.05)(H * Dh, D))}
    _A_in = _A_setup()

    def _B_setup():
        B, S, D, F = (1, 2048, 512, 1792)
        Fh = F // 2
        return {'x': _w((lambda *s: torch.randn(*s, dtype=torch.bfloat16) * 0.05)(B, S, D)), 'w_in': _w((lambda *s: torch.randn(*s, dtype=torch.bfloat16) * 0.2)(D, 2 * Fh)), 'w_sp': _w(0.01 * (lambda *s: torch.randn(*s, dtype=torch.bfloat16) * 0.2)(S, S)), 'b_sp': _w(1.0 + 0.01 * (lambda *s: torch.randn(*s, dtype=torch.bfloat16) * 0.05)(S)), 'w_out': _w((lambda *s: torch.randn(*s, dtype=torch.bfloat16) * 0.05)(Fh, D))}
    _B_in = _B_setup()
    return {'A_x': _A_in['x'], 'A_wq': _A_in['wq'], 'A_wk': _A_in['wk'], 'A_wv': _A_in['wv'], 'A_wo': _A_in['wo'], 'B_x': _B_in['x'], 'B_w_in': _B_in['w_in'], 'B_w_sp': _B_in['w_sp'], 'B_b_sp': _B_in['b_sp'], 'B_w_out': _B_in['w_out'], 'c': _w((lambda *s: torch.randn(*s, dtype=torch.bfloat16) * 0.1)(1, 512) * 8.0), 'w_mod': _w((lambda *s: torch.randn(*s, dtype=torch.bfloat16) * 0.1)(512, 6 * 512) * 512 ** (-0.5) * 8.0)}

def reference(A_x, A_wq, A_wk, A_wv, A_wo, B_x, B_w_in, B_w_sp, B_b_sp, B_w_out, c, w_mod):

    def _A_ref(x, wq, wk, wv, wo):
        B, S, D = x.shape
        H = 32
        Dh = D // H
        q = (lambda x, *d: x.permute(*d))((x @ wq).reshape(B, S, H, Dh), 0, 2, 1, 3)
        k = x @ wk
        v = x @ wv
        scores = torch.einsum('bhqd,bkd->bhqk', q, k) * Dh ** (-0.5)
        p = _softmax(scores, axis=-1)
        o = torch.einsum('bhqk,bkd->bhqd', p, v)
        return (lambda x, *d: x.permute(*d))(o, 0, 2, 1, 3).reshape(B, S, H * Dh) @ wo

    def _B_ref(x, w_in, w_sp, b_sp, w_out):
        B, S, D = x.shape
        F = w_in.shape[-1]
        Fh = F // 2
        z = _gelu(torch.einsum('bsd,df->bsf', x, w_in))
        z1 = z[..., :Fh].clone()
        z2 = _layernorm(z[..., Fh:], axis=-1)
        g = torch.einsum('ts,bsf->btf', w_sp, z2) + b_sp[None, :, None]
        return torch.einsum('bsf,fd->bsd', z1 * g, w_out)
    x = A_x
    mod = (_silu(c) @ w_mod).reshape(c.shape[0], 6, 1, -1)
    sa, ca, ga, sb, cb, gb = (mod[:, 0].clone(), mod[:, 1].clone(), mod[:, 2].clone(), mod[:, 3].clone(), mod[:, 4].clone(), mod[:, 5].clone())
    h = _layernorm(x, axis=-1) * (1 + ca) + sa
    x = x + ga * _A_ref(h, A_wq, A_wk, A_wv, A_wo)
    h = _layernorm(x, axis=-1) * (1 + cb) + sb
    x = x + gb * _B_ref(h, B_w_in, B_w_sp, B_b_sp, B_w_out)
    return x
```

```asm
; @launch grid=(256,1,1) block=(256,1,1) lds=163840
.amdgcn_target "amdgcn-amd-amdhsa--gfx950"
.text
.globl adaLN_cond__grouped_kv_mqa__mixer_gmlp__prompt_kernel
.p2align 8
.type adaLN_cond__grouped_kv_mqa__mixer_gmlp__prompt_kernel,@function
adaLN_cond__grouped_kv_mqa__mixer_gmlp__prompt_kernel:
L_code_start:
  s_cmp_ge_u32 s2, 256
  s_cbranch_scc1 L_end
  s_load_dwordx2 s[44:45], s[0:1], 88
  s_load_dwordx2 s[40:41], s[0:1], 80
  s_load_dwordx2 s[4:5], s[0:1], 0
  s_load_dwordx2 s[52:53], s[0:1], 112
  s_load_dwordx2 s[12:13], s[0:1], 16
  s_load_dwordx2 s[16:17], s[0:1], 24
  s_load_dwordx2 s[8:9], s[0:1], 8
  v_lshrrev_b32 v6, 6, v0
  v_and_b32 v1, 63, v0
  v_readfirstlane_b32 s56, v6
  s_and_b32 s57, s2, 7
  s_lshr_b32 s58, s2, 3
  s_and_b32 s59, s58, 7
  s_lshr_b32 s65, s58, 3
  s_lshl_b32 s60, s57, 2
  s_add_u32 s60, s60, s65
  s_cmp_eq_u32 s56, 2
  s_cbranch_scc0 L_arm_2
  s_getpc_b64 s[66:67]
  s_lshl_b32 s65, s58, 9
  v_lshrrev_b32 v10, 4, v1
  v_lshlrev_b32 v10, 7, v10
  v_add_u32_e64 v10, s65, v10
  global_load_dword v27, v10, s[66:67]
L_arm_2:
L_join_1:
  s_mov_b32 s46, 0x300000
  s_mov_b32 s47, 0x20000
  s_mov_b32 s42, 0x400
  s_mov_b32 s43, 0x20000
  s_mov_b32 s6, 0x200000
  s_mov_b32 s7, 0x20000
  s_mov_b32 s54, 0x2400000
  s_mov_b32 s55, 0x20000
  s_mov_b32 s14, 0x4000
  s_mov_b32 s15, 0x20000
  s_mov_b32 s18, 0x4000
  s_mov_b32 s19, 0x20000
  s_mov_b32 s10, 0x80000
  s_mov_b32 s11, 0x20000
  v_lshlrev_b32 v4, 4, v1
  v_and_b32 v2, 15, v1
  v_lshrrev_b32 v3, 4, v1
  v_lshlrev_b32 v36, 2, v0
  v_lshlrev_b32 v6, 1, v3
  v_and_b32 v7, 7, v1
  v_xor_b32 v6, v6, v7
  v_lshlrev_b32 v6, 4, v6
  v_lshrrev_b32_e64 v7, 3, v1
  v_lshl_add_u32 v5, v7, 10, v6
  v_mul_u32_u24 v7, 6144, v7
  v_add_u32_e64 v37, v6, v7
  s_lshl_b32 s87, s59, 7
  s_lshl_b32 s90, s60, 6
  s_lshl_b32 s65, s59, 3
  s_add_u32 s90, s90, s65
  s_lshl_b32 s90, s90, 10
  s_and_b32 s95, s58, 1
  s_lshl_b32 s95, s95, 2
  s_add_u32 s95, s95, s56
  s_mul_i32 s86, s95, 393216
  s_lshr_b32 s65, s58, 1
  s_lshl_b32 s65, s65, 7
  s_add_u32 s86, s86, s65
  s_lshl_b32 s68, s56, 13
  s_add_u32 s68, s68, 8448
  s_waitcnt lgkmcnt(0)
  s_load_dword s61, s[52:53], 0
  buffer_load_dword v56, v36, s[40:43], 0 offen
  s_cmp_lt_u32 s56, 2
  s_cbranch_scc0 L_arm_4
  v_lshrrev_b32 v10, 3, v1
  v_lshlrev_b32 v10, 10, v10
  v_and_b32 v6, 7, v1
  v_lshl_add_u32 v10, v6, 4, v10
  buffer_load_dwordx4 v[140:143], v10, s[4:7], s90 offen offset:0
  buffer_load_dwordx4 v[144:147], v10, s[4:7], s90 offen offset:128
  buffer_load_dwordx4 v[148:151], v10, s[4:7], s90 offen offset:256
  buffer_load_dwordx4 v[152:155], v10, s[4:7], s90 offen offset:384
  buffer_load_dwordx4 v[156:159], v10, s[4:7], s90 offen offset:512
  buffer_load_dwordx4 v[160:163], v10, s[4:7], s90 offen offset:640
  buffer_load_dwordx4 v[164:167], v10, s[4:7], s90 offen offset:768
  buffer_load_dwordx4 v[168:171], v10, s[4:7], s90 offen offset:896
  v_lshlrev_b32_e64 v9, 3, v0
  s_add_u32 s66, s90, 4096
  buffer_load_dwordx2 v[204:205], v9, s[4:7], s90 offen offset:0
  buffer_load_dwordx2 v[206:207], v9, s[4:7], s90 offen offset:1024
  buffer_load_dwordx2 v[208:209], v9, s[4:7], s90 offen offset:2048
  buffer_load_dwordx2 v[210:211], v9, s[4:7], s90 offen offset:3072
  buffer_load_dwordx2 v[212:213], v9, s[4:7], s66 offen offset:0
  buffer_load_dwordx2 v[214:215], v9, s[4:7], s66 offen offset:1024
  buffer_load_dwordx2 v[216:217], v9, s[4:7], s66 offen offset:2048
  buffer_load_dwordx2 v[218:219], v9, s[4:7], s66 offen offset:3072
  s_branch L_join_3
L_arm_4:
  s_cmp_eq_u32 s56, 2
  s_cbranch_scc0 L_arm_5
  s_lshl_b32 s65, s58, 9
  v_lshlrev_b32_e64 v9, 7, v3
  buffer_load_dword v27, v9, s[12:15], s65 offen
  s_branch L_join_3
L_arm_5:
  s_lshl_b32 s65, s58, 9
  v_lshlrev_b32_e64 v9, 7, v3
  buffer_load_dword v27, v9, s[16:19], s65 offen
L_join_3:
  s_add_u32 m0, s68, 0
  s_add_u32 s65, s86, 0
  buffer_load_dwordx4 v37, s[44:47], s65 offen  lds
  s_add_u32 m0, s68, 1024
  s_add_u32 s65, s86, 49152
  buffer_load_dwordx4 v37, s[44:47], s65 offen  lds
  s_add_u32 m0, s68, 2048
  s_add_u32 s65, s86, 98304
  buffer_load_dwordx4 v37, s[44:47], s65 offen  lds
  s_add_u32 m0, s68, 3072
  s_add_u32 s65, s86, 147456
  buffer_load_dwordx4 v37, s[44:47], s65 offen  lds
  s_add_u32 m0, s68, 4096
  s_add_u32 s65, s86, 196608
  buffer_load_dwordx4 v37, s[44:47], s65 offen  lds
  s_add_u32 m0, s68, 5120
  s_add_u32 s65, s86, 245760
  buffer_load_dwordx4 v37, s[44:47], s65 offen  lds
  s_add_u32 m0, s68, 6144
  s_add_u32 s65, s86, 294912
  buffer_load_dwordx4 v37, s[44:47], s65 offen  lds
  s_add_u32 m0, s68, 7168
  s_add_u32 s65, s86, 344064
  buffer_load_dwordx4 v37, s[44:47], s65 offen  lds
  s_load_dwordx2 s[20:21], s[0:1], 32
  s_load_dwordx2 s[24:25], s[0:1], 48
  s_load_dwordx2 s[28:29], s[0:1], 56
  s_load_dwordx2 s[32:33], s[0:1], 64
  s_load_dwordx2 s[36:37], s[0:1], 72
  s_load_dwordx2 s[48:49], s[0:1], 96
  v_lshrrev_b32 v38, 2, v1
  v_and_b32 v39, 3, v1
  v_lshlrev_b32 v39, 3, v39
  s_lshl_b32 s100, s57, 15
  s_add_u32 s100, s100, 262144
  s_and_b32 s101, s60, 3
  s_lshl_b32 s101, s101, 7
  s_add_u32 s101, s101, s100
  s_add_u32 s101, s101, 21504
  s_lshr_b32 s67, s59, 2
  s_lshl_b32 s67, s67, 5
  s_add_u32 s65, s60, s67
  s_lshl_b32 s93, s65, 11
  s_add_u32 s93, s93, 65536
  v_bfe_u32 v6, v1, 3, 2
  v_lshl_add_u32 v7, v38, 7, v39
  v_xor_b32 v8, 0, v6
  v_lshl_add_u32 v220, v8, 5, v7
  v_add_u32_e64 v228, s68, v220
  v_add_u32 v224, 75008, v220
  v_xor_b32_e64 v8, 1, v6
  v_lshl_add_u32 v221, v8, 5, v7
  v_add_u32_e64 v229, s68, v221
  v_add_u32 v225, 75008, v221
  v_xor_b32_e64 v8, 2, v6
  v_lshl_add_u32 v222, v8, 5, v7
  v_add_u32_e64 v230, s68, v222
  v_add_u32 v226, 75008, v222
  v_xor_b32_e64 v8, 3, v6
  v_lshl_add_u32 v223, v8, 5, v7
  v_add_u32_e64 v231, s68, v223
  v_add_u32 v227, 75008, v223
  s_mov_b32 s22, 0x80000
  s_mov_b32 s23, 0x20000
  s_mov_b32 s26, 0x1c0000
  s_mov_b32 s27, 0x20000
  s_mov_b32 s30, 0x800000
  s_mov_b32 s31, 0x20000
  s_mov_b32 s34, 0x1000
  s_mov_b32 s35, 0x20000
  s_mov_b32 s38, 0xe0000
  s_mov_b32 s39, 0x20000
  s_mov_b32 s50, 0x200000
  s_mov_b32 s51, 0x20000
  s_mov_b32 s63, 30000
  s_mov_b32 s69, 0x3f803f80
  v_lshlrev_b32_e64 v14, 10, v2
  v_lshl_add_u32 v14, v3, 3, v14
  s_lshl_b32 s75, s60, 16
  s_lshl_b32 s65, s56, 14
  s_add_u32 s75, s75, s65
  s_add_u32 s74, s75, s87
  s_lshl_b32 s3, s60, 17
  s_add_u32 s3, s3, 4194304
  s_and_b32 s65, s56, 1
  s_mul_i32 s65, s65, 66560
  s_lshr_b32 s66, s56, 1
  s_mul_i32 s67, s66, 2080
  s_add_u32 s92, s65, s67
  s_lshl_b32 s66, s66, 11
  s_and_b32 s67, s56, 1
  s_lshl_b32 s67, s67, 16
  s_add_u32 s2, s66, s67
  s_add_u32 s2, s2, 65536
  v_add_u32 v11, s65, v4
  v_and_b32 v6, 31, v1
  v_lshrrev_b32 v7, 5, v1
  v_lshlrev_b32 v7, 8, v7
  v_lshl_add_u32 v7, v6, 4, v7
  v_add_u32 v7, 1024, v7
  v_and_b32 v8, 27, v6
  v_cmp_eq_u32 vcc, 16, v8
  v_mov_b32 v8, 2064
  v_mov_b32 v13, 2048
  v_cndmask_b32 v8, v8, v13, vcc
  v_cmp_gt_u32 vcc, 16, v6
  v_add_u32 v13, 512, v7
  s_nop 0
  v_cndmask_b32 v12, v8, v7, vcc
  v_cndmask_b32 v13, v8, v13, vcc
  v_add_u32 v12, s65, v12
  v_add_u32 v13, s65, v13
  v_add_u32 v6, 0, v1
  v_mul_u32_u24 v7, 4682, v6
  v_lshrrev_b32_e64 v7, 16, v7
  v_mul_u32_u24 v8, 14, v7
  v_sub_u32 v6, v6, v8
  v_mul_u32_u24 v7, 3584, v7
  v_lshl_add_u32 v16, v6, 4, v7
  v_add_u32_e64 v6, 64, v1
  v_mul_u32_u24 v7, 4682, v6
  v_lshrrev_b32_e64 v7, 16, v7
  v_mul_u32_u24 v8, 14, v7
  v_sub_u32 v6, v6, v8
  v_mul_u32_u24 v7, 3584, v7
  v_lshl_add_u32 v17, v6, 4, v7
  v_add_u32 v6, 128, v1
  v_mul_u32_u24 v7, 4682, v6
  v_lshrrev_b32_e64 v7, 16, v7
  v_mul_u32_u24 v8, 14, v7
  v_sub_u32 v6, v6, v8
  v_mul_u32_u24 v7, 3584, v7
  v_lshl_add_u32 v18, v6, 4, v7
  v_add_u32 v6, 192, v1
  v_mul_u32_u24 v7, 4682, v6
  v_lshrrev_b32_e64 v7, 16, v7
  v_mul_u32_u24 v8, 14, v7
  v_sub_u32 v6, v6, v8
  v_mul_u32_u24 v7, 3584, v7
  v_lshl_add_u32 v19, v6, 4, v7
  v_add_u32 v6, 256, v1
  v_mul_u32_u24 v7, 4682, v6
  v_lshrrev_b32_e64 v7, 16, v7
  v_mul_u32_u24 v8, 14, v7
  v_sub_u32 v6, v6, v8
  v_mul_u32_u24 v7, 3584, v7
  v_lshl_add_u32 v20, v6, 4, v7
  v_add_u32 v6, 320, v1
  v_mul_u32_u24 v7, 4682, v6
  v_lshrrev_b32_e64 v7, 16, v7
  v_mul_u32_u24 v8, 14, v7
  v_sub_u32 v6, v6, v8
  v_mul_u32_u24 v7, 3584, v7
  v_lshl_add_u32 v21, v6, 4, v7
  v_add_u32 v6, 384, v1
  v_mul_u32_u24 v7, 4682, v6
  v_lshrrev_b32_e64 v7, 16, v7
  v_mul_u32_u24 v8, 14, v7
  v_sub_u32 v6, v6, v8
  v_mul_u32_u24 v7, 3584, v7
  v_lshl_add_u32 v22, v6, 4, v7
  s_mul_i32 s88, s56, 114688
  s_mul_i32 s65, s59, 224
  s_add_u32 s88, s88, s65
  s_mul_i32 s89, s56, 7168
  v_lshlrev_b32 v6, 12, v2
  v_lshl_add_u32 v6, v3, 4, v6
  s_lshl_b32 s66, s60, 18
  s_lshl_b32 s67, s56, 7
  s_add_u32 s66, s66, s67
  s_add_u32 s65, s56, 0
  s_and_b32 s65, s65, 3
  s_lshl_b32 s65, s65, 16
  s_add_u32 s65, s65, s66
  v_add_u32 v23, s65, v6
  s_add_u32 s65, s56, 1
  s_and_b32 s65, s65, 3
  s_lshl_b32 s65, s65, 16
  s_add_u32 s65, s65, s66
  v_add_u32 v24, s65, v6
  s_add_u32 s65, s56, 2
  s_and_b32 s65, s65, 3
  s_lshl_b32 s65, s65, 16
  s_add_u32 s65, s65, s66
  v_add_u32 v25, s65, v6
  s_add_u32 s65, s56, 3
  s_and_b32 s65, s65, 3
  s_lshl_b32 s65, s65, 16
  s_add_u32 s65, s65, s66
  v_add_u32_e64 v26, s65, v6
  s_and_b32 s65, s60, 3
  s_lshl_b32 s65, s65, 1
  s_xor_b32 s65, s65, s57
  s_xor_b32 s65, s65, s59
  s_xor_b32 s76, s65, 0
  s_lshl_b32 s76, s76, 9
  s_xor_b32 s77, s65, 1
  s_lshl_b32 s77, s77, 9
  s_xor_b32 s78, s65, 2
  s_lshl_b32 s78, s78, 9
  s_xor_b32 s79, s65, 3
  s_lshl_b32 s79, s79, 9
  s_xor_b32 s80, s65, 4
  s_lshl_b32 s80, s80, 9
  s_xor_b32 s81, s65, 5
  s_lshl_b32 s81, s81, 9
  s_xor_b32 s82, s65, 6
  s_lshl_b32 s82, s82, 9
  s_xor_b32 s83, s65, 7
  s_lshl_b32 s83, s83, 9
  s_mov_b32 s70, 0xffff0000
  s_mov_b32 s71, 0xffff0000
  s_mov_b32 s72, 0
  s_mov_b32 s73, -1
  s_cmp_lt_u32 s56, 2
  s_cbranch_scc0 L_arm_7
  s_waitcnt vmcnt(24)
  s_branch L_join_6
L_arm_7:
  s_cmp_eq_u32 s56, 2
  s_cbranch_scc0 L_arm_8
  s_waitcnt vmcnt(9)
  s_branch L_join_6
L_arm_8:
  s_waitcnt vmcnt(9)
L_join_6:
  v_lshlrev_b32 v57, 16, v56
  v_and_b32 v58, 0xffff0000, v56
  v_mul_f32 v59, 0xbfb8aa3b, v57
  v_mul_f32 v232, 0xbfb8aa3b, v58
  v_exp_f32 v59, v59
  v_exp_f32 v232, v232
  v_add_f32 v59, 1.0, v59
  v_add_f32 v232, 1.0, v232
  v_rcp_f32 v59, v59
  v_rcp_f32 v232, v232
  v_mul_f32 v57, v57, v59
  v_mul_f32 v58, v58, v232
  v_cvt_pk_bf16_f32 v57, v57, v58
  v_add_u32 v58, 157824, v36
  s_waitcnt lgkmcnt(0)
  ds_write_b32 v58, v57
  s_mul_i32 s61, s61, 0x9e3779b1
  s_add_u32 s61, s61, 0x7f4a7c15
  s_getreg_b32 s65, hwreg(HW_REG_XCC_ID, 0, 4)
  s_and_b32 s62, s61, 0xfffffff0
  s_or_b32 s62, s62, s65
  s_cmp_eq_u32 s56, 3
  s_cbranch_scc0 L_arm_10
  s_lshl_b32 s66, s58, 7
  s_add_u32 s65, s100, s66
  v_mov_b32 v59, s62
  v_lshlrev_b32_e64 v232, 2, v1
  s_mov_b32 exec_hi, 0
  buffer_store_dword v59, v232, s[52:55], s65 offen offset:0 sc1
  s_mov_b64 exec, -1
L_arm_10:
L_join_9:
  s_waitcnt lgkmcnt(0)
  s_barrier
  s_lshl_b32 s65, s95, 7
  s_add_u32 s65, s65, 157824
  v_lshl_add_u32 v9, v3, 3, s65
  ds_read2_b64 v[92:95], v9 offset0:0 offset1:4
  ds_read2_b64 v[96:99], v9 offset0:8 offset1:12
  s_cmp_eq_u32 s56, 0
  s_cbranch_scc0 L_arm_12
  s_mov_b32 m0, 41216
  s_mov_b32 s65, 0
  buffer_load_dwordx4 v4, s[12:15], s65 offen  lds
  buffer_load_dwordx4 v4, s[12:15], s65 offen offset:1024  lds
  buffer_load_dwordx4 v4, s[12:15], s65 offen offset:2048  lds
  buffer_load_dwordx4 v4, s[12:15], s65 offen offset:3072  lds
  s_mov_b32 m0, 45312
  s_mov_b32 s65, 4096
  buffer_load_dwordx4 v4, s[12:15], s65 offen  lds
  buffer_load_dwordx4 v4, s[12:15], s65 offen offset:1024  lds
  buffer_load_dwordx4 v4, s[12:15], s65 offen offset:2048  lds
  buffer_load_dwordx4 v4, s[12:15], s65 offen offset:3072  lds
  s_mov_b32 m0, 49408
  s_mov_b32 s65, 8192
  buffer_load_dwordx4 v4, s[12:15], s65 offen  lds
  buffer_load_dwordx4 v4, s[12:15], s65 offen offset:1024  lds
  buffer_load_dwordx4 v4, s[12:15], s65 offen offset:2048  lds
  buffer_load_dwordx4 v4, s[12:15], s65 offen offset:3072  lds
  s_mov_b32 m0, 53504
  s_mov_b32 s65, 12288
  buffer_load_dwordx4 v4, s[12:15], s65 offen  lds
  buffer_load_dwordx4 v4, s[12:15], s65 offen offset:1024  lds
  buffer_load_dwordx4 v4, s[12:15], s65 offen offset:2048  lds
  buffer_load_dwordx4 v4, s[12:15], s65 offen offset:3072  lds
  s_branch L_join_11
L_arm_12:
  s_cmp_eq_u32 s56, 1
  s_cbranch_scc0 L_arm_13
  s_mov_b32 m0, 107776
  s_mov_b32 s65, 0
  buffer_load_dwordx4 v4, s[16:19], s65 offen  lds
  buffer_load_dwordx4 v4, s[16:19], s65 offen offset:1024  lds
  buffer_load_dwordx4 v4, s[16:19], s65 offen offset:2048  lds
  buffer_load_dwordx4 v4, s[16:19], s65 offen offset:3072  lds
  s_mov_b32 m0, 111872
  s_mov_b32 s65, 4096
  buffer_load_dwordx4 v4, s[16:19], s65 offen  lds
  buffer_load_dwordx4 v4, s[16:19], s65 offen offset:1024  lds
  buffer_load_dwordx4 v4, s[16:19], s65 offen offset:2048  lds
  buffer_load_dwordx4 v4, s[16:19], s65 offen offset:3072  lds
  s_mov_b32 m0, 115968
  s_mov_b32 s65, 8192
  buffer_load_dwordx4 v4, s[16:19], s65 offen  lds
  buffer_load_dwordx4 v4, s[16:19], s65 offen offset:1024  lds
  buffer_load_dwordx4 v4, s[16:19], s65 offen offset:2048  lds
  buffer_load_dwordx4 v4, s[16:19], s65 offen offset:3072  lds
  s_mov_b32 m0, 120064
  s_mov_b32 s65, 12288
  buffer_load_dwordx4 v4, s[16:19], s65 offen  lds
  buffer_load_dwordx4 v4, s[16:19], s65 offen offset:1024  lds
  buffer_load_dwordx4 v4, s[16:19], s65 offen offset:2048  lds
  buffer_load_dwordx4 v4, s[16:19], s65 offen offset:3072  lds
  s_branch L_join_11
L_arm_13:
  s_cmp_eq_u32 s56, 2
  s_cbranch_scc0 L_arm_14
  s_getpc_b64 s[66:67]
L_pc:
  s_lshl_b32 s65, s58, 11
  v_lshlrev_b32 v10, 7, v38
  v_add_u32 v10, s65, v10
  v_min_u32 v10, L_code_end-L_pc-4, v10
  global_load_dword v27, v10, s[66:67]
  v_lshlrev_b32_e64 v9, 7, v1
  s_mul_i32 s65, s58, 896
  s_add_u32 s65, s65, s100
  v_add_u32_e64 v6, s65, v9
  s_and_b32 s65, s59, 3
  s_lshl_b32 s65, s65, 9
  s_add_u32 s65, s65, s93
  s_sub_u32 s65, s65, 1024
  v_add_u32_e64 v7, s65, v9
  v_cmp_gt_u32 vcc, 8, v1
  s_nop 1
  v_cndmask_b32 v6, v7, v6, vcc
  s_lshl_b32 s65, s59, 5
  s_add_u32 s65, s65, s60
  s_lshl_b32 s65, s65, 7
  s_add_u32 s65, s65, 786432
  v_writelane_b32 v6, s65, 12
  s_add_u32 s65, s65, 128
  v_writelane_b32 v6, s65, 13
  s_add_u32 s65, s65, 128
  v_writelane_b32 v6, s65, 14
  s_add_u32 s65, s65, 128
  v_writelane_b32 v6, s65, 15
  s_lshl_b32 s65, s57, 7
  s_add_u32 s65, s65, 4096
  v_writelane_b32 v6, s65, 7
  s_lshl_b32 s65, s58, 9
  s_mov_b64 exec, 0x1fff
  buffer_load_dword v27, v6, s[52:55], 0 offen
  s_mov_b64 exec, -1
  s_lshl_b32 s65, s60, 16
  s_lshl_b32 s66, s59, 13
  s_add_u32 s65, s65, s66
  s_add_u32 s65, s65, 1048576
  v_lshlrev_b32_e64 v10, 7, v1
  buffer_load_dword v27, v10, s[52:55], s65 offen
L_arm_14:
L_join_11:
  s_lshl_b32 s65, s56, 2
  s_add_u32 s65, s65, 158848
  v_add_u32_e64 v9, s65, v4
  s_cmp_lt_u32 s56, 2
  s_cbranch_scc0 L_arm_16
  s_waitcnt vmcnt(16)
  s_branch L_join_15
L_arm_16:
  s_cmp_eq_u32 s56, 2
  s_cbranch_scc0 L_arm_17
  s_waitcnt vmcnt(3)
  s_branch L_join_15
L_arm_17:
  s_waitcnt vmcnt(1)
L_join_15:
  ds_read_b64_tr_b16 v[108:109], v228 offset:0
  ds_read_b64_tr_b16 v[110:111], v228 offset:2048
  ds_read_b64_tr_b16 v[112:113], v229 offset:0
  ds_read_b64_tr_b16 v[114:115], v229 offset:2048
  ds_read_b64_tr_b16 v[116:117], v230 offset:0
  ds_read_b64_tr_b16 v[118:119], v230 offset:2048
  ds_read_b64_tr_b16 v[120:121], v231 offset:0
  ds_read_b64_tr_b16 v[122:123], v231 offset:2048
  ds_read_b64_tr_b16 v[124:125], v228 offset:4096
  ds_read_b64_tr_b16 v[126:127], v228 offset:6144
  ds_read_b64_tr_b16 v[128:129], v229 offset:4096
  ds_read_b64_tr_b16 v[130:131], v229 offset:6144
  s_waitcnt lgkmcnt(8)
  ds_read_b64_tr_b16 v[132:133], v230 offset:4096
  ds_read_b64_tr_b16 v[134:135], v230 offset:6144
  v_mfma_f32_16x16x32_bf16 v[76:79], v[92:95], v[108:111], 0
  ds_read_b64_tr_b16 v[136:137], v231 offset:4096
  ds_read_b64_tr_b16 v[138:139], v231 offset:6144
  v_mfma_f32_16x16x32_bf16 v[80:83], v[92:95], v[112:115], 0
  s_waitcnt lgkmcnt(8)
  v_mfma_f32_16x16x32_bf16 v[84:87], v[92:95], v[116:119], 0
  v_mfma_f32_16x16x32_bf16 v[88:91], v[92:95], v[120:123], 0
  s_waitcnt lgkmcnt(4)
  v_mfma_f32_16x16x32_bf16 v[76:79], v[96:99], v[124:127], v[76:79]
  v_mfma_f32_16x16x32_bf16 v[80:83], v[96:99], v[128:131], v[80:83]
  s_waitcnt lgkmcnt(0)
  v_mfma_f32_16x16x32_bf16 v[84:87], v[96:99], v[132:135], v[84:87]
  v_mfma_f32_16x16x32_bf16 v[88:91], v[96:99], v[136:139], v[88:91]
  s_nop 4
  v_cndmask_b32 v76, v76, v80, s[70:71]
  s_nop 1
  v_cndmask_b32 v84, v84, v88, s[70:71]
  v_cndmask_b32 v76, v76, v84, s[72:73]
  ds_write_b32 v9, v76
  s_waitcnt lgkmcnt(0)
  s_barrier
  s_cmp_lt_u32 s56, 2
  s_cbranch_scc0 L_arm_19
  s_add_u32 s85, s100, 0
  v_lshlrev_b32 v9, 7, v1
  s_mov_b32 exec_lo, 0xffffffff
  s_mov_b32 exec_hi, 0x0
  buffer_load_dword v36, v9, s[52:55], s85 offen sc1
  s_mov_b64 exec, -1
  v_mov_b32 v232, 0
  v_mov_b32_e64 v233, 0
  s_waitcnt vmcnt(17)
  v_dot2c_f32_bf16 v232, s69, v140
  v_dot2c_f32_bf16 v233, v140, v140
  v_dot2c_f32_bf16 v232, s69, v141
  v_dot2c_f32_bf16 v233, v141, v141
  v_dot2c_f32_bf16 v232, s69, v142
  v_dot2c_f32_bf16 v233, v142, v142
  v_dot2c_f32_bf16 v232, s69, v143
  v_dot2c_f32_bf16 v233, v143, v143
  v_dot2c_f32_bf16 v232, s69, v144
  v_dot2c_f32_bf16 v233, v144, v144
  v_dot2c_f32_bf16 v232, s69, v145
  v_dot2c_f32_bf16 v233, v145, v145
  v_dot2c_f32_bf16 v232, s69, v146
  v_dot2c_f32_bf16 v233, v146, v146
  v_dot2c_f32_bf16 v232, s69, v147
  v_dot2c_f32_bf16 v233, v147, v147
  v_dot2c_f32_bf16 v232, s69, v148
  v_dot2c_f32_bf16 v233, v148, v148
  v_dot2c_f32_bf16 v232, s69, v149
  v_dot2c_f32_bf16 v233, v149, v149
  v_dot2c_f32_bf16 v232, s69, v150
  v_dot2c_f32_bf16 v233, v150, v150
  v_dot2c_f32_bf16 v232, s69, v151
  v_dot2c_f32_bf16 v233, v151, v151
  v_dot2c_f32_bf16 v232, s69, v152
  v_dot2c_f32_bf16 v233, v152, v152
  v_dot2c_f32_bf16 v232, s69, v153
  v_dot2c_f32_bf16 v233, v153, v153
  v_dot2c_f32_bf16 v232, s69, v154
  v_dot2c_f32_bf16 v233, v154, v154
  v_dot2c_f32_bf16 v232, s69, v155
  v_dot2c_f32_bf16 v233, v155, v155
  v_dot2c_f32_bf16 v232, s69, v156
  v_dot2c_f32_bf16 v233, v156, v156
  v_dot2c_f32_bf16 v232, s69, v157
  v_dot2c_f32_bf16 v233, v157, v157
  v_dot2c_f32_bf16 v232, s69, v158
  v_dot2c_f32_bf16 v233, v158, v158
  v_dot2c_f32_bf16 v232, s69, v159
  v_dot2c_f32_bf16 v233, v159, v159
  v_dot2c_f32_bf16 v232, s69, v160
  v_dot2c_f32_bf16 v233, v160, v160
  v_dot2c_f32_bf16 v232, s69, v161
  v_dot2c_f32_bf16 v233, v161, v161
  v_dot2c_f32_bf16 v232, s69, v162
  v_dot2c_f32_bf16 v233, v162, v162
  v_dot2c_f32_bf16 v232, s69, v163
  v_dot2c_f32_bf16 v233, v163, v163
  v_dot2c_f32_bf16 v232, s69, v164
  v_dot2c_f32_bf16 v233, v164, v164
  v_dot2c_f32_bf16 v232, s69, v165
  v_dot2c_f32_bf16 v233, v165, v165
  v_dot2c_f32_bf16 v232, s69, v166
  v_dot2c_f32_bf16 v233, v166, v166
  v_dot2c_f32_bf16 v232, s69, v167
  v_dot2c_f32_bf16 v233, v167, v167
  v_dot2c_f32_bf16 v232, s69, v168
  v_dot2c_f32_bf16 v233, v168, v168
  v_dot2c_f32_bf16 v232, s69, v169
  v_dot2c_f32_bf16 v233, v169, v169
  v_dot2c_f32_bf16 v232, s69, v170
  v_dot2c_f32_bf16 v233, v170, v170
  v_dot2c_f32_bf16 v232, s69, v171
  v_dot2c_f32_bf16 v233, v171, v171
  s_nop 1
  v_add_f32_dpp v232, v232, v232 quad_perm:[1,0,3,2] row_mask:0xf bank_mask:0xf
  v_add_f32_dpp v233, v233, v233 quad_perm:[1,0,3,2] row_mask:0xf bank_mask:0xf
  s_nop 0
  v_add_f32_dpp v232, v232, v232 quad_perm:[2,3,0,1] row_mask:0xf bank_mask:0xf
  v_add_f32_dpp v233, v233, v233 quad_perm:[2,3,0,1] row_mask:0xf bank_mask:0xf
  s_nop 0
  v_add_f32_dpp v232, v232, v232 row_half_mirror row_mask:0xf bank_mask:0xf
  v_add_f32_dpp v233, v233, v233 row_half_mirror row_mask:0xf bank_mask:0xf
  v_mul_f32 v232, 0x3b000000, v232
  v_mul_f32_e64 v56, v232, v232
  s_mov_b32 s65, 0x3b000000
  v_fma_f32 v233, v233, s65, -v56
  v_max_f32_e64 v233, 0, v233
  v_add_f32 v233, 0x3727c5ac, v233
  v_rsq_f32 v233, v233
  s_nop 0
  v_mul_f32_e64 v232, -v232, v233
  s_mul_i32 s65, s56, 66560
  s_add_u32 s65, s65, 41216
  v_lshl_add_u32 v10, v38, 5, v39
  v_add_u32_e64 v10, s65, v10
  v_readlane_b32 s12, v233, 0
  v_readlane_b32 s13, v232, 0
  v_readlane_b32 s14, v233, 8
  v_readlane_b32 s15, v232, 8
  v_readlane_b32 s16, v233, 16
  v_readlane_b32 s17, v232, 16
  v_readlane_b32 s18, v233, 24
  v_readlane_b32 s19, v232, 24
  v_readlane_b32 s40, v233, 32
  v_readlane_b32 s41, v232, 32
  v_readlane_b32 s42, v233, 40
  v_readlane_b32 s43, v232, 40
  v_readlane_b32 s44, v233, 48
  v_readlane_b32 s45, v232, 48
  v_readlane_b32 s46, v233, 56
  v_readlane_b32 s47, v232, 56
  s_mov_b32 exec_lo, 0xffffffff
  s_mov_b32 exec_hi, 0x0
  s_waitcnt vmcnt(0)
  v_xor_b32 v6, s61, v36
  v_lshrrev_b32 v6, 4, v6
  v_cmp_ne_u32 vcc, 0, v6
  s_cbranch_vccnz L_rare_21
L_back_22:
  v_cmp_ne_u32 vcc, s62, v36
  s_nop 0
  s_cmp_eq_u64 vcc, 0
  s_cselect_b32 s62, 1, 0
  s_mov_b64 exec, -1
  v_lshlrev_b32_e64 v9, 4, v0
  v_add_u32 v8, 8192, v9
  s_lshl_b32 s67, s57, 14
  s_add_u32 s67, s67, 524288
  s_add_u32 s66, s100, 4096
  s_cmp_eq_u32 s62, 1
  s_cselect_b32 s85, s66, s67
  s_add_u32 s86, s85, 4096
  buffer_load_dwordx4 v[108:111], v9, s[52:55], s85 offen offset:0 sc1
  buffer_load_dwordx4 v[112:115], v9, s[52:55], s85 offen offset:2048 sc1
  buffer_load_dwordx4 v[116:119], v9, s[52:55], s86 offen offset:0 sc1
  buffer_load_dwordx4 v[120:123], v9, s[52:55], s86 offen offset:2048 sc1
  buffer_load_dwordx4 v[124:127], v8, s[52:55], s85 offen offset:0 sc1
  buffer_load_dwordx4 v[128:131], v8, s[52:55], s85 offen offset:2048 sc1
  buffer_load_dwordx4 v[132:135], v8, s[52:55], s86 offen offset:0 sc1
  buffer_load_dwordx4 v[136:139], v8, s[52:55], s86 offen offset:2048 sc1
  v_lshlrev_b32 v76, 16, v204
  v_and_b32 v77, 0xffff0000, v204
  v_lshlrev_b32_e64 v78, 16, v205
  v_and_b32 v79, 0xffff0000, v205
  v_lshlrev_b32_e64 v80, 16, v206
  v_and_b32 v81, 0xffff0000, v206
  v_lshlrev_b32_e64 v82, 16, v207
  v_and_b32 v83, 0xffff0000, v207
  v_lshlrev_b32_e64 v84, 16, v208
  v_and_b32 v85, 0xffff0000, v208
  v_lshlrev_b32_e64 v86, 16, v209
  v_and_b32 v87, 0xffff0000, v209
  v_lshlrev_b32_e64 v88, 16, v210
  v_and_b32 v89, 0xffff0000, v210
  v_lshlrev_b32_e64 v90, 16, v211
  v_and_b32 v91, 0xffff0000, v211
  v_lshlrev_b32_e64 v92, 16, v212
  v_and_b32 v93, 0xffff0000, v212
  v_lshlrev_b32_e64 v94, 16, v213
  v_and_b32 v95, 0xffff0000, v213
  v_lshlrev_b32_e64 v96, 16, v214
  v_and_b32 v97, 0xffff0000, v214
  v_lshlrev_b32_e64 v98, 16, v215
  v_and_b32 v99, 0xffff0000, v215
  v_lshlrev_b32_e64 v100, 16, v216
  v_and_b32 v101, 0xffff0000, v216
  v_lshlrev_b32_e64 v102, 16, v217
  v_and_b32 v103, 0xffff0000, v217
  v_lshlrev_b32_e64 v104, 16, v218
  v_and_b32 v105, 0xffff0000, v218
  v_lshlrev_b32_e64 v106, 16, v219
  v_and_b32 v107, 0xffff0000, v219
  v_pk_fma_f32 v[76:77], v[76:77], s[12:13], s[12:13] op_sel:[0,0,1] op_sel_hi:[1,0,1]
  v_pk_fma_f32 v[78:79], v[78:79], s[12:13], s[12:13] op_sel:[0,0,1] op_sel_hi:[1,0,1]
  v_pk_fma_f32 v[80:81], v[80:81], s[14:15], s[14:15] op_sel:[0,0,1] op_sel_hi:[1,0,1]
  v_pk_fma_f32 v[82:83], v[82:83], s[14:15], s[14:15] op_sel:[0,0,1] op_sel_hi:[1,0,1]
  v_pk_fma_f32 v[84:85], v[84:85], s[16:17], s[16:17] op_sel:[0,0,1] op_sel_hi:[1,0,1]
  v_pk_fma_f32 v[86:87], v[86:87], s[16:17], s[16:17] op_sel:[0,0,1] op_sel_hi:[1,0,1]
  v_pk_fma_f32 v[88:89], v[88:89], s[18:19], s[18:19] op_sel:[0,0,1] op_sel_hi:[1,0,1]
  v_pk_fma_f32 v[90:91], v[90:91], s[18:19], s[18:19] op_sel:[0,0,1] op_sel_hi:[1,0,1]
  v_pk_fma_f32 v[92:93], v[92:93], s[40:41], s[40:41] op_sel:[0,0,1] op_sel_hi:[1,0,1]
  v_pk_fma_f32 v[94:95], v[94:95], s[40:41], s[40:41] op_sel:[0,0,1] op_sel_hi:[1,0,1]
  v_pk_fma_f32 v[96:97], v[96:97], s[42:43], s[42:43] op_sel:[0,0,1] op_sel_hi:[1,0,1]
  v_pk_fma_f32 v[98:99], v[98:99], s[42:43], s[42:43] op_sel:[0,0,1] op_sel_hi:[1,0,1]
  v_pk_fma_f32 v[100:101], v[100:101], s[44:45], s[44:45] op_sel:[0,0,1] op_sel_hi:[1,0,1]
  v_pk_fma_f32 v[102:103], v[102:103], s[44:45], s[44:45] op_sel:[0,0,1] op_sel_hi:[1,0,1]
  v_pk_fma_f32 v[104:105], v[104:105], s[46:47], s[46:47] op_sel:[0,0,1] op_sel_hi:[1,0,1]
  v_pk_fma_f32 v[106:107], v[106:107], s[46:47], s[46:47] op_sel:[0,0,1] op_sel_hi:[1,0,1]
  ds_read_b64_tr_b16 v[140:141], v10 offset:0
  ds_read_b64_tr_b16 v[142:143], v10 offset:512
  ds_read_b64_tr_b16 v[144:145], v10 offset:1024
  ds_read_b64_tr_b16 v[146:147], v10 offset:1536
  ds_read_b64_tr_b16 v[148:149], v10 offset:2048
  ds_read_b64_tr_b16 v[150:151], v10 offset:2560
  ds_read_b64_tr_b16 v[152:153], v10 offset:3072
  ds_read_b64_tr_b16 v[154:155], v10 offset:3584
  s_waitcnt lgkmcnt(6)
  ds_read_b64_tr_b16 v[156:157], v10 offset:4096
  ds_read_b64_tr_b16 v[158:159], v10 offset:4608
  ds_read_b64_tr_b16 v[160:161], v10 offset:5120
  ds_read_b64_tr_b16 v[162:163], v10 offset:5632
  ds_read_b64_tr_b16 v[164:165], v10 offset:6144
  ds_read_b64_tr_b16 v[166:167], v10 offset:6656
  ds_read_b64_tr_b16 v[168:169], v10 offset:7168
  ds_read_b64_tr_b16 v[170:171], v10 offset:7680
  s_waitcnt lgkmcnt(6)
  ds_read_b64_tr_b16 v[172:173], v10 offset:8192
  ds_read_b64_tr_b16 v[174:175], v10 offset:8704
  ds_read_b64_tr_b16 v[176:177], v10 offset:9216
  ds_read_b64_tr_b16 v[178:179], v10 offset:9728
  ds_read_b64_tr_b16 v[180:181], v10 offset:10240
  ds_read_b64_tr_b16 v[182:183], v10 offset:10752
  ds_read_b64_tr_b16 v[184:185], v10 offset:11264
  ds_read_b64_tr_b16 v[186:187], v10 offset:11776
  s_waitcnt lgkmcnt(6)
  ds_read_b64_tr_b16 v[188:189], v10 offset:12288
  ds_read_b64_tr_b16 v[190:191], v10 offset:12800
  ds_read_b64_tr_b16 v[192:193], v10 offset:13312
  ds_read_b64_tr_b16 v[194:195], v10 offset:13824
  ds_read_b64_tr_b16 v[196:197], v10 offset:14336
  ds_read_b64_tr_b16 v[198:199], v10 offset:14848
  ds_read_b64_tr_b16 v[200:201], v10 offset:15360
  ds_read_b64_tr_b16 v[202:203], v10 offset:15872
  s_waitcnt lgkmcnt(6)
  s_waitcnt vmcnt(0)
  v_min3_u32 v6, v109, v111, v113
  v_max3_u32 v7, v109, v111, v113
  v_min3_u32 v6, v6, v115, v117
  v_max3_u32 v7, v7, v115, v117
  v_min3_u32 v6, v6, v119, v121
  v_max3_u32 v7, v7, v119, v121
  v_min3_u32 v6, v6, v123, v125
  v_max3_u32 v7, v7, v123, v125
  v_min3_u32 v6, v6, v127, v129
  v_max3_u32 v7, v7, v127, v129
  v_min3_u32 v6, v6, v131, v133
  v_max3_u32 v7, v7, v131, v133
  v_min3_u32 v6, v6, v135, v137
  v_max3_u32 v7, v7, v135, v137
  v_min_u32 v6, v6, v139
  v_max_u32 v7, v7, v139
  v_xor_b32 v6, s61, v6
  v_xor_b32 v7, s61, v7
  v_or_b32_e64 v6, v6, v7
  v_cmp_ne_u32 vcc, 0, v6
  s_cbranch_vccz L_mok_26
  s_mov_b32 s64, s63
L_poll_27:
  buffer_load_dwordx4 v[108:111], v9, s[52:55], s85 offen offset:0 sc1
  buffer_load_dwordx4 v[112:115], v9, s[52:55], s85 offen offset:2048 sc1
  buffer_load_dwordx4 v[116:119], v9, s[52:55], s86 offen offset:0 sc1
  buffer_load_dwordx4 v[120:123], v9, s[52:55], s86 offen offset:2048 sc1
  buffer_load_dwordx4 v[124:127], v8, s[52:55], s85 offen offset:0 sc1
  buffer_load_dwordx4 v[128:131], v8, s[52:55], s85 offen offset:2048 sc1
  buffer_load_dwordx4 v[132:135], v8, s[52:55], s86 offen offset:0 sc1
  buffer_load_dwordx4 v[136:139], v8, s[52:55], s86 offen offset:2048 sc1
  s_sub_u32 s64, s64, 1
  s_cbranch_scc1 L_giveup_29
  s_waitcnt vmcnt(0)
  v_min3_u32 v6, v109, v111, v113
  v_max3_u32 v7, v109, v111, v113
  v_min3_u32 v6, v6, v115, v117
  v_max3_u32 v7, v7, v115, v117
  v_min3_u32 v6, v6, v119, v121
  v_max3_u32 v7, v7, v119, v121
  v_min3_u32 v6, v6, v123, v125
  v_max3_u32 v7, v7, v123, v125
  v_min3_u32 v6, v6, v127, v129
  v_max3_u32 v7, v7, v127, v129
  v_min3_u32 v6, v6, v131, v133
  v_max3_u32 v7, v7, v131, v133
  v_min3_u32 v6, v6, v135, v137
  v_max3_u32 v7, v7, v135, v137
  v_min_u32 v6, v6, v139
  v_max_u32 v7, v7, v139
  v_xor_b32 v6, s61, v6
  v_xor_b32 v7, s61, v7
  v_or_b32 v6, v6, v7
  v_cmp_ne_u32 vcc, 0, v6
  s_cbranch_vccnz L_poll_27
L_pdone_28:
L_mok_26:
  v_lshlrev_b32_e64 v9, 3, v0
  v_add_u32 v9, 141312, v9
  v_add_f32 v108, v108, v124
  v_add_f32 v109, v110, v126
  v_add_f32 v112, v112, v128
  v_add_f32 v113, v114, v130
  v_add_f32 v116, v116, v132
  v_add_f32 v117, v118, v134
  v_add_f32 v120, v120, v136
  v_add_f32 v121, v122, v138
  v_pk_add_f32 v[116:117], v[116:117], 1.0 op_sel_hi:[1,0]
  v_pk_add_f32 v[120:121], v[120:121], 1.0 op_sel_hi:[1,0]
  v_pk_fma_f32 v[76:77], v[76:77], v[116:117], v[108:109]
  v_pk_fma_f32 v[78:79], v[78:79], v[120:121], v[112:113]
  v_cvt_pk_bf16_f32 v76, v76, v77
  v_cvt_pk_bf16_f32 v77, v78, v79
  ds_write_b64 v9, v[76:77] offset:0
  v_pk_fma_f32 v[80:81], v[80:81], v[116:117], v[108:109]
  v_pk_fma_f32 v[82:83], v[82:83], v[120:121], v[112:113]
  v_cvt_pk_bf16_f32 v80, v80, v81
  v_cvt_pk_bf16_f32 v81, v82, v83
  ds_write_b64 v9, v[80:81] offset:1040
  v_pk_fma_f32 v[84:85], v[84:85], v[116:117], v[108:109]
  v_pk_fma_f32 v[86:87], v[86:87], v[120:121], v[112:113]
  v_cvt_pk_bf16_f32 v84, v84, v85
  v_cvt_pk_bf16_f32 v85, v86, v87
  ds_write_b64 v9, v[84:85] offset:2080
  v_pk_fma_f32 v[88:89], v[88:89], v[116:117], v[108:109]
  v_pk_fma_f32 v[90:91], v[90:91], v[120:121], v[112:113]
  v_cvt_pk_bf16_f32 v88, v88, v89
  v_cvt_pk_bf16_f32 v89, v90, v91
  ds_write_b64 v9, v[88:89] offset:3120
  v_pk_fma_f32 v[92:93], v[92:93], v[116:117], v[108:109]
  v_pk_fma_f32 v[94:95], v[94:95], v[120:121], v[112:113]
  v_cvt_pk_bf16_f32 v92, v92, v93
  v_cvt_pk_bf16_f32 v93, v94, v95
  ds_write_b64 v9, v[92:93] offset:4160
  v_pk_fma_f32 v[96:97], v[96:97], v[116:117], v[108:109]
  v_pk_fma_f32 v[98:99], v[98:99], v[120:121], v[112:113]
  v_cvt_pk_bf16_f32 v96, v96, v97
  v_cvt_pk_bf16_f32 v97, v98, v99
  ds_write_b64 v9, v[96:97] offset:5200
  v_pk_fma_f32 v[100:101], v[100:101], v[116:117], v[108:109]
  v_pk_fma_f32 v[102:103], v[102:103], v[120:121], v[112:113]
  v_cvt_pk_bf16_f32 v100, v100, v101
  v_cvt_pk_bf16_f32 v101, v102, v103
  ds_write_b64 v9, v[100:101] offset:6240
  v_pk_fma_f32 v[104:105], v[104:105], v[116:117], v[108:109]
  v_pk_fma_f32 v[106:107], v[106:107], v[120:121], v[112:113]
  v_cvt_pk_bf16_f32 v104, v104, v105
  v_cvt_pk_bf16_f32 v105, v106, v107
  ds_write_b64 v9, v[104:105] offset:7280
  s_waitcnt lgkmcnt(0)
  s_branch L_join_18
L_arm_19:
  s_cmp_eq_u32 s56, 3
  s_cbranch_scc0 L_arm_31
  v_add_u32 v9, 158848, v4
  ds_read_b128 v[232:235], v9
  s_and_b32 s65, s58, 1
  s_lshl_b32 s65, s65, 13
  s_lshr_b32 s66, s58, 4
  s_lshl_b32 s66, s66, 12
  s_add_u32 s65, s65, s66
  s_bfe_u32 s66, s58, 0x30001
  s_lshl_b32 s66, s66, 8
  s_add_u32 s65, s65, s66
  s_lshl_b32 s66, s57, 14
  s_add_u32 s66, s66, s65
  s_add_u32 s66, s66, 524288
  s_add_u32 s65, s65, s100
  s_add_u32 s65, s65, 4096
  v_lshlrev_b32 v9, 4, v38
  v_and_b32 v6, 1, v1
  v_lshl_add_u32 v9, v6, 3, v9
  v_and_b32_e64 v6, 2, v1
  v_lshl_add_u32 v9, v6, 10, v9
  s_waitcnt lgkmcnt(0)
  v_add_f32 v232, v232, v233
  v_add_f32 v234, v234, v235
  v_mov_b32 v233, s61
  v_add_f32_e64 v232, v232, v234
  buffer_store_dwordx2 v[232:233], v9, s[52:55], s65 offen
  buffer_store_dwordx2 v[232:233], v9, s[52:55], s66 offen sc1
L_arm_31:
L_join_30:
  s_add_u32 s85, s100, 0
  v_lshlrev_b32_e64 v9, 7, v1
  s_mov_b32 exec_lo, 0xffffffff
  s_mov_b32 exec_hi, 0x0
  s_mov_b32 s64, s63
L_poll_33:
  buffer_load_dword v36, v9, s[52:55], s85 offen sc1
  s_sub_u32 s64, s64, 1
  s_cbranch_scc1 L_giveup_35
  s_waitcnt vmcnt(0)
  v_xor_b32 v6, s61, v36
  v_lshrrev_b32 v6, 4, v6
  v_cmp_ne_u32 vcc, 0, v6
  s_cbranch_vccnz L_poll_33
L_pdone_34:
  v_cmp_ne_u32 vcc, s62, v36
  s_nop 0
  s_cmp_eq_u64 vcc, 0
  s_cselect_b32 s62, 1, 0
  s_mov_b64 exec, -1
  v_add_u32 v6, 7168, v5
  v_add_u32 v7, 14336, v5
  v_add_u32 v8, 21504, v5
  s_and_b32 s66, s56, 1
  s_mul_i32 s94, s66, 66560
  s_add_u32 s94, s94, 8448
  s_lshl_b32 s66, s66, 18
  s_add_u32 s66, s66, s87
  s_and_b32 s91, s60, 3
  s_lshl_b32 s91, s91, 1
  s_add_u32 s65, s91, 0
  s_and_b32 s65, s65, 7
  s_lshl_b32 s65, s65, 12
  s_add_u32 m0, s65, s94
  s_lshl_b32 s65, s65, 3
  s_add_u32 s65, s65, s66
  buffer_load_dwordx4 v5, s[8:11], s65 offen  lds
  buffer_load_dwordx4 v6, s[8:11], s65 offen offset:1024  lds
  buffer_load_dwordx4 v7, s[8:11], s65 offen offset:2048  lds
  buffer_load_dwordx4 v8, s[8:11], s65 offen offset:3072  lds
  s_add_u32 s65, s91, 1
  s_and_b32 s65, s65, 7
  s_lshl_b32 s65, s65, 12
  s_add_u32 m0, s65, s94
  s_lshl_b32 s65, s65, 3
  s_add_u32 s65, s65, s66
  buffer_load_dwordx4 v5, s[8:11], s65 offen  lds
  buffer_load_dwordx4 v6, s[8:11], s65 offen offset:1024  lds
  buffer_load_dwordx4 v7, s[8:11], s65 offen offset:2048  lds
  buffer_load_dwordx4 v8, s[8:11], s65 offen offset:3072  lds
  s_add_u32 s65, s91, 2
  s_and_b32 s65, s65, 7
  s_lshl_b32 s65, s65, 12
  s_add_u32 m0, s65, s94
  s_lshl_b32 s65, s65, 3
  s_add_u32 s65, s65, s66
  buffer_load_dwordx4 v5, s[8:11], s65 offen  lds
  buffer_load_dwordx4 v6, s[8:11], s65 offen offset:1024  lds
  buffer_load_dwordx4 v7, s[8:11], s65 offen offset:2048  lds
  buffer_load_dwordx4 v8, s[8:11], s65 offen offset:3072  lds
  s_add_u32 s65, s91, 3
  s_and_b32 s65, s65, 7
  s_lshl_b32 s65, s65, 12
  s_add_u32 m0, s65, s94
  s_lshl_b32 s65, s65, 3
  s_add_u32 s65, s65, s66
  buffer_load_dwordx4 v5, s[8:11], s65 offen  lds
  buffer_load_dwordx4 v6, s[8:11], s65 offen offset:1024  lds
  buffer_load_dwordx4 v7, s[8:11], s65 offen offset:2048  lds
  buffer_load_dwordx4 v8, s[8:11], s65 offen offset:3072  lds
  s_waitcnt vmcnt(8)
  s_add_u32 s65, s91, 4
  s_and_b32 s65, s65, 7
  s_lshl_b32 s65, s65, 12
  s_add_u32 m0, s65, s94
  s_lshl_b32 s65, s65, 3
  s_add_u32 s65, s65, s66
  buffer_load_dwordx4 v5, s[8:11], s65 offen  lds
  buffer_load_dwordx4 v6, s[8:11], s65 offen offset:1024  lds
  buffer_load_dwordx4 v7, s[8:11], s65 offen offset:2048  lds
  buffer_load_dwordx4 v8, s[8:11], s65 offen offset:3072  lds
  s_waitcnt vmcnt(8)
  s_add_u32 s65, s91, 5
  s_and_b32 s65, s65, 7
  s_lshl_b32 s65, s65, 12
  s_add_u32 m0, s65, s94
  s_lshl_b32 s65, s65, 3
  s_add_u32 s65, s65, s66
  buffer_load_dwordx4 v5, s[8:11], s65 offen  lds
  buffer_load_dwordx4 v6, s[8:11], s65 offen offset:1024  lds
  buffer_load_dwordx4 v7, s[8:11], s65 offen offset:2048  lds
  buffer_load_dwordx4 v8, s[8:11], s65 offen offset:3072  lds
  s_waitcnt vmcnt(8)
  s_add_u32 s65, s91, 6
  s_and_b32 s65, s65, 7
  s_lshl_b32 s65, s65, 12
  s_add_u32 m0, s65, s94
  s_lshl_b32 s65, s65, 3
  s_add_u32 s65, s65, s66
  buffer_load_dwordx4 v5, s[8:11], s65 offen  lds
  buffer_load_dwordx4 v6, s[8:11], s65 offen offset:1024  lds
  buffer_load_dwordx4 v7, s[8:11], s65 offen offset:2048  lds
  buffer_load_dwordx4 v8, s[8:11], s65 offen offset:3072  lds
  s_waitcnt vmcnt(8)
  s_add_u32 s65, s91, 7
  s_and_b32 s65, s65, 7
  s_lshl_b32 s65, s65, 12
  s_add_u32 m0, s65, s94
  s_lshl_b32 s65, s65, 3
  s_add_u32 s65, s65, s66
  buffer_load_dwordx4 v5, s[8:11], s65 offen  lds
  buffer_load_dwordx4 v6, s[8:11], s65 offen offset:1024  lds
  buffer_load_dwordx4 v7, s[8:11], s65 offen offset:2048  lds
  buffer_load_dwordx4 v8, s[8:11], s65 offen offset:3072  lds
  s_lshl_b32 s66, s57, 1
  s_add_u32 s66, s66, s56
  s_mul_i32 s66, s66, 196608
  s_lshl_b32 s65, s58, 7
  s_add_u32 s66, s66, s65
  s_sub_u32 s66, s66, 391168
  s_lshl_b32 s67, s56, 12
  s_add_u32 m0, s67, 124928
  s_add_u32 s65, s66, 0
  buffer_load_dwordx4 v37, s[44:47], s65 offen  lds
  s_add_u32 m0, s67, 125952
  s_add_u32 s65, s66, 49152
  buffer_load_dwordx4 v37, s[44:47], s65 offen  lds
  s_add_u32 m0, s67, 126976
  s_add_u32 s65, s66, 98304
  buffer_load_dwordx4 v37, s[44:47], s65 offen  lds
  s_add_u32 m0, s67, 128000
  s_add_u32 s65, s66, 147456
  buffer_load_dwordx4 v37, s[44:47], s65 offen  lds
L_join_18:
  s_barrier
  s_cmp_eq_u32 s56, 0
  s_cbranch_scc0 L_arm_37
  v_and_b32_e64 v9, 7, v1
  v_mul_u32_u24 v9, 1040, v9
  v_lshl_add_u32 v9, v3, 3, v9
  v_add_u32 v9, 141312, v9
  ds_read2_b64 v[60:63], v9 offset0:0 offset1:4
  ds_read2_b64 v[64:67], v9 offset0:8 offset1:12
  ds_read2_b64 v[68:71], v9 offset0:16 offset1:20
  ds_read2_b64 v[72:75], v9 offset0:24 offset1:28
  ds_read2_b64 v[76:79], v9 offset0:32 offset1:36
  ds_read2_b64 v[80:83], v9 offset0:40 offset1:44
  ds_read2_b64 v[84:87], v9 offset0:48 offset1:52
  ds_read2_b64 v[88:91], v9 offset0:56 offset1:60
  v_lshrrev_b32 v10, 2, v2
  v_lshlrev_b32 v10, 3, v10
  v_and_b32 v6, 3, v2
  v_add_u32 v10, v10, v6
  v_and_b32_e64 v6, 1, v3
  v_lshl_add_u32 v10, v6, 5, v10
  v_lshlrev_b32 v10, 4, v10
  v_lshrrev_b32 v6, 1, v3
  v_lshl_add_u32 v10, v6, 3, v10
  s_and_b32 s65, s59, 2
  s_lshl_b32 s65, s65, 7
  s_and_b32 s66, s59, 1
  s_lshl_b32 s66, s66, 6
  s_add_u32 s65, s65, s66
  s_add_u32 s65, s65, s93
  v_mov_b32 v36, 0
  s_waitcnt lgkmcnt(6)
  v_mfma_f32_16x16x32_bf16 v[232:235], v[140:143], v[60:63], 0
  ds_read2_b64 v[92:95], v9 offset0:64 offset1:68
  v_mfma_f32_16x16x32_bf16 v[232:235], v[144:147], v[64:67], v[232:235]
  ds_read2_b64 v[96:99], v9 offset0:72 offset1:76
  s_waitcnt lgkmcnt(6)
  v_mfma_f32_16x16x32_bf16 v[232:235], v[148:151], v[68:71], v[232:235]
  ds_read2_b64 v[100:103], v9 offset0:80 offset1:84
  v_mfma_f32_16x16x32_bf16 v[232:235], v[152:155], v[72:75], v[232:235]
  ds_read2_b64 v[104:107], v9 offset0:88 offset1:92
  s_waitcnt lgkmcnt(6)
  v_mfma_f32_16x16x32_bf16 v[232:235], v[156:159], v[76:79], v[232:235]
  ds_read2_b64 v[108:111], v9 offset0:96 offset1:100
  v_mfma_f32_16x16x32_bf16 v[232:235], v[160:163], v[80:83], v[232:235]
  ds_read2_b64 v[112:115], v9 offset0:104 offset1:108
  s_waitcnt lgkmcnt(6)
  v_mfma_f32_16x16x32_bf16 v[232:235], v[164:167], v[84:87], v[232:235]
  ds_read2_b64 v[116:119], v9 offset0:112 offset1:116
  v_mfma_f32_16x16x32_bf16 v[232:235], v[168:171], v[88:91], v[232:235]
  ds_read2_b64 v[120:123], v9 offset0:120 offset1:124
  s_waitcnt lgkmcnt(6)
  v_mfma_f32_16x16x32_bf16 v[232:235], v[172:175], v[92:95], v[232:235]
  v_mfma_f32_16x16x32_bf16 v[232:235], v[176:179], v[96:99], v[232:235]
  s_waitcnt lgkmcnt(4)
  v_mfma_f32_16x16x32_bf16 v[232:235], v[180:183], v[100:103], v[232:235]
  v_mfma_f32_16x16x32_bf16 v[232:235], v[184:187], v[104:107], v[232:235]
  s_waitcnt lgkmcnt(2)
  v_mfma_f32_16x16x32_bf16 v[232:235], v[188:191], v[108:111], v[232:235]
  v_mfma_f32_16x16x32_bf16 v[232:235], v[192:195], v[112:115], v[232:235]
  s_waitcnt lgkmcnt(0)
  v_mfma_f32_16x16x32_bf16 v[232:235], v[196:199], v[116:119], v[232:235]
  v_mfma_f32_16x16x32_bf16 v[232:235], v[200:203], v[120:123], v[232:235]
  s_nop 7
  v_cvt_pk_bf16_f32 v232, v232, v233
  v_cvt_pk_bf16_f32 v233, v234, v235
  s_mov_b32 exec_lo, 0xff00ff
  s_mov_b32 exec_hi, 0xff00ff
  buffer_store_dwordx2 v[232:233], v10, s[52:55], s65 offen sc1
  s_mov_b64 exec, -1
  s_branch L_join_36
L_arm_37:
  s_cmp_eq_u32 s56, 1
  s_cbranch_scc0 L_arm_38
  v_and_b32_e64 v9, 7, v1
  v_mul_u32_u24 v9, 1040, v9
  v_lshl_add_u32 v9, v3, 3, v9
  v_add_u32 v9, 141312, v9
  ds_read2_b64 v[60:63], v9 offset0:0 offset1:4
  ds_read2_b64 v[64:67], v9 offset0:8 offset1:12
  ds_read2_b64 v[68:71], v9 offset0:16 offset1:20
  ds_read2_b64 v[72:75], v9 offset0:24 offset1:28
  ds_read2_b64 v[76:79], v9 offset0:32 offset1:36
  ds_read2_b64 v[80:83], v9 offset0:40 offset1:44
  ds_read2_b64 v[84:87], v9 offset0:48 offset1:52
  ds_read2_b64 v[88:91], v9 offset0:56 offset1:60
  v_lshlrev_b32_e64 v10, 4, v2
  v_lshl_add_u32 v10, v3, 3, v10
  s_and_b32 s66, s59, 3
  s_lshl_b32 s65, s66, 8
  s_add_u32 s65, s65, s93
  v_mov_b32_e64 v36, 0
  s_waitcnt lgkmcnt(6)
  v_mfma_f32_16x16x32_bf16 v[232:235], v[60:63], v[140:143], 0
  ds_read2_b64 v[92:95], v9 offset0:64 offset1:68
  v_mfma_f32_16x16x32_bf16 v[232:235], v[64:67], v[144:147], v[232:235]
  ds_read2_b64 v[96:99], v9 offset0:72 offset1:76
  s_waitcnt lgkmcnt(6)
  v_mfma_f32_16x16x32_bf16 v[232:235], v[68:71], v[148:151], v[232:235]
  ds_read2_b64 v[100:103], v9 offset0:80 offset1:84
  v_mfma_f32_16x16x32_bf16 v[232:235], v[72:75], v[152:155], v[232:235]
  ds_read2_b64 v[104:107], v9 offset0:88 offset1:92
  s_waitcnt lgkmcnt(6)
  v_mfma_f32_16x16x32_bf16 v[232:235], v[76:79], v[156:159], v[232:235]
  ds_read2_b64 v[108:111], v9 offset0:96 offset1:100
  v_mfma_f32_16x16x32_bf16 v[232:235], v[80:83], v[160:163], v[232:235]
  ds_read2_b64 v[112:115], v9 offset0:104 offset1:108
  s_waitcnt lgkmcnt(6)
  v_mfma_f32_16x16x32_bf16 v[232:235], v[84:87], v[164:167], v[232:235]
  ds_read2_b64 v[116:119], v9 offset0:112 offset1:116
  v_mfma_f32_16x16x32_bf16 v[232:235], v[88:91], v[168:171], v[232:235]
  ds_read2_b64 v[120:123], v9 offset0:120 offset1:124
  s_waitcnt lgkmcnt(6)
  v_mfma_f32_16x16x32_bf16 v[232:235], v[92:95], v[172:175], v[232:235]
  v_mfma_f32_16x16x32_bf16 v[232:235], v[96:99], v[176:179], v[232:235]
  s_waitcnt lgkmcnt(4)
  v_mfma_f32_16x16x32_bf16 v[232:235], v[100:103], v[180:183], v[232:235]
  v_mfma_f32_16x16x32_bf16 v[232:235], v[104:107], v[184:187], v[232:235]
  s_waitcnt lgkmcnt(2)
  v_mfma_f32_16x16x32_bf16 v[232:235], v[108:111], v[188:191], v[232:235]
  v_mfma_f32_16x16x32_bf16 v[232:235], v[112:115], v[192:195], v[232:235]
  s_waitcnt lgkmcnt(0)
  v_mfma_f32_16x16x32_bf16 v[232:235], v[116:119], v[196:199], v[232:235]
  v_mfma_f32_16x16x32_bf16 v[232:235], v[120:123], v[200:203], v[232:235]
  s_nop 7
  v_cvt_pk_bf16_f32 v232, v232, v233
  v_cvt_pk_bf16_f32 v233, v234, v235
  s_mov_b32 exec_lo, 0xffffffff
  s_mov_b32 exec_hi, 0x0
  buffer_store_dwordx2 v[232:233], v10, s[52:55], s65 offen offset:1024 sc1
  s_mov_b64 exec, -1
  s_branch L_join_36
L_arm_38:
  v_and_b32_e64 v6, 7, v1
  v_mul_u32_u24 v9, 1040, v6
  v_bfe_u32 v7, v1, 3, 2
  v_lshl_add_u32 v9, v7, 3, v9
  v_lshrrev_b32_e64 v8, 5, v1
  v_lshl_add_u32 v9, v8, 6, v9
  s_lshl_b32 s65, s56, 9
  s_add_u32 s65, s65, 140288
  v_add_u32 v9, s65, v9
  ds_read2_b64 v[60:63], v9 offset0:0 offset1:4
  ds_read2_b64 v[64:67], v9 offset0:16 offset1:20
  ds_read2_b64 v[68:71], v9 offset0:32 offset1:36
  ds_read2_b64 v[72:75], v9 offset0:48 offset1:52
  v_lshl_add_u32 v10, v7, 4, v6
  v_lshlrev_b32_e64 v10, 4, v10
  v_lshl_add_u32 v10, v8, 10, v10
  s_lshl_b32 s65, s60, 16
  s_lshr_b32 s66, s59, 1
  s_lshl_b32 s66, s66, 14
  s_add_u32 s65, s65, s66
  s_and_b32 s66, s59, 1
  s_lshl_b32 s66, s66, 7
  s_add_u32 s65, s65, s66
  s_lshl_b32 s66, s56, 13
  s_add_u32 s65, s65, s66
  s_add_u32 s65, s65, 1032192
  s_add_u32 s66, s65, 4096
  s_waitcnt lgkmcnt(0)
  s_cmp_eq_u32 s62, 1
  s_cbranch_scc0 L_far_39
  buffer_store_dwordx4 v[60:63], v10, s[52:55], s65 offen offset:0
  buffer_store_dwordx4 v[64:67], v10, s[52:55], s65 offen offset:2048
  buffer_store_dwordx4 v[68:71], v10, s[52:55], s66 offen offset:0
  buffer_store_dwordx4 v[72:75], v10, s[52:55], s66 offen offset:2048
L_stored_40:
  s_waitcnt vmcnt(0)
  s_lshl_b32 s65, s56, 5
  s_lshl_b32 s66, s59, 2
  s_add_u32 s65, s65, s66
  s_add_u32 s85, s65, s101
  s_sub_u32 s85, s85, 64
  v_mov_b32 v56, s61
  v_mov_b32_e64 v10, 0
  s_mov_b64 exec, 1
  s_cmp_eq_u32 s62, 1
  s_cbranch_scc0 L_far_41
  buffer_store_dword v56, v10, s[52:55], s85 offen
L_stored_42:
  s_mov_b64 exec, -1
L_join_36:
  s_barrier
  ds_read_b64_tr_b16 v[100:101], v220 offset:8448
  ds_read_b64_tr_b16 v[102:103], v220 offset:10496
  ds_read_b64_tr_b16 v[104:105], v221 offset:8448
  ds_read_b64_tr_b16 v[106:107], v221 offset:10496
  ds_read_b64_tr_b16 v[108:109], v222 offset:8448
  ds_read_b64_tr_b16 v[110:111], v222 offset:10496
  ds_read_b64_tr_b16 v[112:113], v223 offset:8448
  ds_read_b64_tr_b16 v[114:115], v223 offset:10496
  ds_read_b64_tr_b16 v[116:117], v220 offset:12544
  ds_read_b64_tr_b16 v[118:119], v220 offset:14592
  ds_read_b64_tr_b16 v[120:121], v221 offset:12544
  ds_read_b64_tr_b16 v[122:123], v221 offset:14592
  ds_read_b64_tr_b16 v[124:125], v222 offset:12544
  ds_read_b64_tr_b16 v[126:127], v222 offset:14592
  s_waitcnt lgkmcnt(8)
  ds_read_b64_tr_b16 v[128:129], v223 offset:12544
  ds_read_b64_tr_b16 v[130:131], v223 offset:14592
  ds_read_b64_tr_b16 v[132:133], v220 offset:16640
  ds_read_b64_tr_b16 v[134:135], v220 offset:18688
  ds_read_b64_tr_b16 v[136:137], v221 offset:16640
  ds_read_b64_tr_b16 v[138:139], v221 offset:18688
  s_lshl_b32 s65, s57, 7
  s_add_u32 s65, s65, 157824
  v_lshl_add_u32 v9, v3, 3, s65
  ds_read2_b64 v[60:63], v9 offset0:0 offset1:4
  ds_read2_b64 v[64:67], v9 offset0:8 offset1:12
  v_bfe_u32 v6, v1, 3, 2
  v_xor_b32_e64 v6, s56, v6
  v_lshl_add_u32 v6, v6, 5, v39
  v_lshl_add_u32 v10, v38, 7, v6
  v_add_u32 v10, 133120, v10
  ds_read_b64_tr_b16 v[68:69], v10 offset:0
  ds_read_b64_tr_b16 v[70:71], v10 offset:2048
  ds_read_b64_tr_b16 v[72:73], v10 offset:4096
  ds_read_b64_tr_b16 v[74:75], v10 offset:6144
  s_lshl_b32 s65, s57, 9
  s_lshl_b32 s66, s58, 12
  s_add_u32 s65, s65, s66
  s_lshl_b32 s66, s56, 7
  s_add_u32 s65, s65, s66
  s_add_u32 s67, s65, 655360
  v_lshlrev_b32_e64 v10, 3, v1
  s_waitcnt lgkmcnt(0)
  v_mfma_f32_16x16x32_bf16 v[236:239], v[60:63], v[68:71], 0
  v_mfma_f32_16x16x32_bf16 v[236:239], v[64:67], v[72:75], v[236:239]
  s_add_u32 s84, s101, 0
  v_lshlrev_b32 v58, 2, v2
  buffer_load_dword v37, v58, s[52:55], s84 offen sc1
  s_cmp_lt_u32 s56, 2
  s_cbranch_scc0 L_arm_44
  s_cmp_eq_u32 s56, 0
  s_cbranch_scc0 L_arm_46
  v_dot2c_f32_bf16 v36, v232, v232
  v_dot2c_f32_bf16 v36, v233, v233
  s_nop 2
  v_mov_b32 v59, v36
  s_nop 1
  v_permlane16_swap_b32 v36, v59
  v_add_f32 v36, v36, v59
  v_mov_b32 v59, v36
  s_nop 1
  v_permlane32_swap_b32 v36, v59
  v_add_f32 v36, v36, v59
  s_nop 1
  v_max_f32_dpp v36, v36, v36 quad_perm:[1,0,3,2] row_mask:0xf bank_mask:0xf
  s_nop 1
  v_max_f32_dpp v36, v36, v36 quad_perm:[2,3,0,1] row_mask:0xf bank_mask:0xf
  s_nop 1
  v_max_f32_dpp v36, v36, v36 row_half_mirror row_mask:0xf bank_mask:0xf
L_arm_46:
L_join_45:
  v_mov_b32 v56, s61
  v_mov_b32 v57, v36
  v_mov_b32_e64 v10, 0
  s_add_u32 s85, s100, 20480
  s_lshl_b32 s65, s58, 4
  s_lshl_b32 s66, s56, 3
  s_add_u32 s65, s65, s66
  s_add_u32 s86, s65, s85
  s_waitcnt vmcnt(0)
  s_mov_b64 exec, 1
  s_cmp_eq_u32 s62, 1
  s_cbranch_scc0 L_far_47
  buffer_store_dwordx2 v[56:57], v10, s[52:55], s86 offen
L_stored_48:
  s_mov_b64 exec, -1
L_arm_44:
L_join_43:
  s_and_b32 s65, s56, 1
  s_lshl_b32 s65, s65, 11
  s_lshr_b32 s66, s56, 1
  s_lshl_b32 s66, s66, 12
  s_add_u32 s66, s66, 149632
  s_add_u32 s68, s66, s65
  s_xor_b32 s65, s65, 2048
  s_add_u32 s66, s66, s65
  v_add_u32 v144, s68, v4
  v_add_u32 v145, s66, v4
  v_lshrrev_b32 v6, 1, v1
  s_lshl_b32 s65, s56, 4
  v_add_u32 v6, s65, v6
  v_mul_u32_u24 v36, 2080, v6
  v_and_b32_e64 v7, 1, v1
  v_lshl_add_u32 v36, v7, 4, v36
  v_cmp_eq_u32 vcc, 0, v7
  v_mov_b32 v8, s69
  s_nop 0
  v_cndmask_b32 v148, 0, v8, vcc
  v_mov_b32 v149, v148
  v_mov_b32 v150, v148
  v_mov_b32_e64 v151, v148
  s_and_b32 s65, s56, 1
  s_sub_u32 s65, s65, 1
  s_and_b32 exec_lo, s65, 0xff
  s_mov_b32 exec_hi, 0
  s_cmp_lg_u32 s65, 0
  s_cbranch_scc0 L_arm_50
  ds_write_b128 v36, v[148:151] offset:2048
L_arm_50:
L_join_49:
  s_mov_b64 exec, -1
  s_add_u32 s12, s75, 1048576
  s_add_u32 s13, s75, 1052672
  s_add_u32 s14, s75, 1056768
  s_add_u32 s15, s75, 1060864
  s_mov_b32 s64, s63
  s_waitcnt vmcnt(0)
  v_cmp_ne_u32 vcc, s61, v37
  s_cbranch_vccz L_pdone_52
L_again_51:
  buffer_load_dword v37, v58, s[52:55], s84 offen sc1
  s_waitcnt vmcnt(0)
  v_cmp_ne_u32 vcc, s61, v37
  s_cbranch_vccz L_pdone_52
  s_sub_u32 s64, s64, 1
  s_cbranch_scc0 L_again_51
  s_mov_b32 s63, 1
L_pdone_52:
  buffer_load_dwordx4 v[60:63], v4, s[52:55], s12 offen offset:0 sc1
  buffer_load_dwordx4 v[64:67], v4, s[52:55], s12 offen offset:1024 sc1
  buffer_load_dwordx4 v[68:71], v4, s[52:55], s12 offen offset:2048 sc1
  buffer_load_dwordx4 v[72:75], v4, s[52:55], s12 offen offset:3072 sc1
  buffer_load_dwordx4 v[76:79], v4, s[52:55], s13 offen offset:0 sc1
  buffer_load_dwordx4 v[80:83], v4, s[52:55], s13 offen offset:1024 sc1
  buffer_load_dwordx4 v[84:87], v4, s[52:55], s13 offen offset:2048 sc1
  s_and_b32 s65, s56, 1
  s_lshl_b32 s65, s65, 8
  s_lshr_b32 s66, s56, 1
  s_lshl_b32 s66, s66, 12
  s_add_u32 s65, s65, s66
  s_add_u32 s65, s65, 149632
  v_and_b32 v6, 1, v3
  v_lshl_add_u32 v9, v6, 5, v2
  v_lshlrev_b32 v9, 4, v9
  v_lshrrev_b32 v6, 1, v3
  v_lshl_add_u32 v9, v6, 3, v9
  v_add_u32_e64 v9, s65, v9
  s_mov_b32 s70, 0x3eb8aa3b
  s_mov_b32 s71, 0x3eb8aa3b
  s_add_u32 s85, s100, 20480
  v_mov_b32 v237, s61
  v_lshlrev_b32_e64 v10, 3, v1
  s_waitcnt vmcnt(6)
  v_mfma_f32_16x16x32_bf16 v[40:43], v[100:103], v[60:63], 0
  buffer_load_dwordx4 v[88:91], v4, s[52:55], s13 offen offset:3072 sc1
  ds_read_b64_tr_b16 v[140:141], v222 offset:16640
  ds_read_b64_tr_b16 v[142:143], v222 offset:18688
  v_mfma_f32_16x16x32_bf16 v[44:47], v[104:107], v[60:63], 0
  ds_read_b64_tr_b16 v[100:101], v223 offset:16640
  ds_read_b64_tr_b16 v[102:103], v223 offset:18688
  v_mfma_f32_16x16x32_bf16 v[48:51], v[108:111], v[60:63], 0
  ds_read_b64_tr_b16 v[104:105], v220 offset:20736
  ds_read_b64_tr_b16 v[106:107], v220 offset:22784
  v_mfma_f32_16x16x32_bf16 v[52:55], v[112:115], v[60:63], 0
  ds_read_b64_tr_b16 v[108:109], v221 offset:20736
  ds_read_b64_tr_b16 v[110:111], v221 offset:22784
  s_waitcnt vmcnt(6)
  v_mfma_f32_16x16x32_bf16 v[40:43], v[116:119], v[64:67], v[40:43]
  buffer_load_dwordx4 v[92:95], v4, s[52:55], s14 offen offset:0 sc1
  ds_read_b64_tr_b16 v[112:113], v222 offset:20736
  ds_read_b64_tr_b16 v[114:115], v222 offset:22784
  v_mfma_f32_16x16x32_bf16 v[44:47], v[120:123], v[64:67], v[44:47]
  ds_read_b64_tr_b16 v[116:117], v223 offset:20736
  ds_read_b64_tr_b16 v[118:119], v223 offset:22784
  v_mfma_f32_16x16x32_bf16 v[48:51], v[124:127], v[64:67], v[48:51]
  s_waitcnt lgkmcnt(8)
  ds_read_b64_tr_b16 v[120:121], v220 offset:24832
  ds_read_b64_tr_b16 v[122:123], v220 offset:26880
  v_mfma_f32_16x16x32_bf16 v[52:55], v[128:131], v[64:67], v[52:55]
  ds_read_b64_tr_b16 v[124:125], v221 offset:24832
  ds_read_b64_tr_b16 v[126:127], v221 offset:26880
  s_waitcnt vmcnt(6)
  v_mfma_f32_16x16x32_bf16 v[40:43], v[132:135], v[68:71], v[40:43]
  buffer_load_dwordx4 v[96:99], v4, s[52:55], s14 offen offset:1024 sc1
  ds_read_b64_tr_b16 v[128:129], v222 offset:24832
  ds_read_b64_tr_b16 v[130:131], v222 offset:26880
  v_mfma_f32_16x16x32_bf16 v[44:47], v[136:139], v[68:71], v[44:47]
  s_waitcnt lgkmcnt(8)
  ds_read_b64_tr_b16 v[132:133], v223 offset:24832
  ds_read_b64_tr_b16 v[134:135], v223 offset:26880
  v_mfma_f32_16x16x32_bf16 v[48:51], v[140:143], v[68:71], v[48:51]
  ds_read_b64_tr_b16 v[136:137], v220 offset:28928
  ds_read_b64_tr_b16 v[138:139], v220 offset:30976
  v_mfma_f32_16x16x32_bf16 v[52:55], v[100:103], v[68:71], v[52:55]
  ds_read_b64_tr_b16 v[140:141], v221 offset:28928
  ds_read_b64_tr_b16 v[142:143], v221 offset:30976
  s_waitcnt vmcnt(6)
  v_mfma_f32_16x16x32_bf16 v[40:43], v[104:107], v[72:75], v[40:43]
  buffer_load_dwordx4 v[60:63], v4, s[52:55], s14 offen offset:2048 sc1
  s_waitcnt lgkmcnt(8)
  ds_read_b64_tr_b16 v[100:101], v222 offset:28928
  ds_read_b64_tr_b16 v[102:103], v222 offset:30976
  v_mfma_f32_16x16x32_bf16 v[44:47], v[108:111], v[72:75], v[44:47]
  ds_read_b64_tr_b16 v[104:105], v223 offset:28928
  ds_read_b64_tr_b16 v[106:107], v223 offset:30976
  v_mfma_f32_16x16x32_bf16 v[48:51], v[112:115], v[72:75], v[48:51]
  ds_read_b64_tr_b16 v[108:109], v220 offset:33024
  ds_read_b64_tr_b16 v[110:111], v220 offset:35072
  v_mfma_f32_16x16x32_bf16 v[52:55], v[116:119], v[72:75], v[52:55]
  s_waitcnt lgkmcnt(8)
  ds_read_b64_tr_b16 v[112:113], v221 offset:33024
  ds_read_b64_tr_b16 v[114:115], v221 offset:35072
  s_waitcnt vmcnt(6)
  v_mfma_f32_16x16x32_bf16 v[40:43], v[120:123], v[76:79], v[40:43]
  buffer_load_dwordx4 v[64:67], v4, s[52:55], s14 offen offset:3072 sc1
  ds_read_b64_tr_b16 v[116:117], v222 offset:33024
  ds_read_b64_tr_b16 v[118:119], v222 offset:35072
  v_mfma_f32_16x16x32_bf16 v[44:47], v[124:127], v[76:79], v[44:47]
  ds_read_b64_tr_b16 v[120:121], v223 offset:33024
  ds_read_b64_tr_b16 v[122:123], v223 offset:35072
  v_mfma_f32_16x16x32_bf16 v[48:51], v[128:131], v[76:79], v[48:51]
  s_waitcnt lgkmcnt(8)
  ds_read_b64_tr_b16 v[124:125], v220 offset:37120
  ds_read_b64_tr_b16 v[126:127], v220 offset:39168
  v_mfma_f32_16x16x32_bf16 v[52:55], v[132:135], v[76:79], v[52:55]
  ds_read_b64_tr_b16 v[128:129], v221 offset:37120
  ds_read_b64_tr_b16 v[130:131], v221 offset:39168
  s_waitcnt vmcnt(6)
  v_mfma_f32_16x16x32_bf16 v[40:43], v[136:139], v[80:83], v[40:43]
  buffer_load_dwordx4 v[68:71], v4, s[52:55], s15 offen offset:0 sc1
  ds_read_b64_tr_b16 v[132:133], v222 offset:37120
  ds_read_b64_tr_b16 v[134:135], v222 offset:39168
  v_mfma_f32_16x16x32_bf16 v[44:47], v[140:143], v[80:83], v[44:47]
  s_waitcnt lgkmcnt(8)
  ds_read_b64_tr_b16 v[136:137], v223 offset:37120
  ds_read_b64_tr_b16 v[138:139], v223 offset:39168
  v_mfma_f32_16x16x32_bf16 v[48:51], v[100:103], v[80:83], v[48:51]
  ds_read_b64_tr_b16 v[140:141], v224 offset:0
  ds_read_b64_tr_b16 v[142:143], v224 offset:2048
  v_mfma_f32_16x16x32_bf16 v[52:55], v[104:107], v[80:83], v[52:55]
  ds_read_b64_tr_b16 v[100:101], v225 offset:0
  ds_read_b64_tr_b16 v[102:103], v225 offset:2048
  s_waitcnt vmcnt(6)
  v_mfma_f32_16x16x32_bf16 v[40:43], v[108:111], v[84:87], v[40:43]
  buffer_load_dwordx4 v[72:75], v4, s[52:55], s15 offen offset:1024 sc1
  s_waitcnt lgkmcnt(8)
  ds_read_b64_tr_b16 v[104:105], v226 offset:0
  ds_read_b64_tr_b16 v[106:107], v226 offset:2048
  v_mfma_f32_16x16x32_bf16 v[44:47], v[112:115], v[84:87], v[44:47]
  ds_read_b64_tr_b16 v[108:109], v227 offset:0
  ds_read_b64_tr_b16 v[110:111], v227 offset:2048
  v_mfma_f32_16x16x32_bf16 v[48:51], v[116:119], v[84:87], v[48:51]
  ds_read_b64_tr_b16 v[112:113], v224 offset:4096
  ds_read_b64_tr_b16 v[114:115], v224 offset:6144
  v_mfma_f32_16x16x32_bf16 v[52:55], v[120:123], v[84:87], v[52:55]
  s_waitcnt lgkmcnt(8)
  ds_read_b64_tr_b16 v[116:117], v225 offset:4096
  ds_read_b64_tr_b16 v[118:119], v225 offset:6144
  s_waitcnt vmcnt(6)
  v_mfma_f32_16x16x32_bf16 v[40:43], v[124:127], v[88:91], v[40:43]
  buffer_load_dwordx4 v[76:79], v4, s[52:55], s15 offen offset:2048 sc1
  ds_read_b64_tr_b16 v[120:121], v226 offset:4096
  ds_read_b64_tr_b16 v[122:123], v226 offset:6144
  v_mfma_f32_16x16x32_bf16 v[44:47], v[128:131], v[88:91], v[44:47]
  ds_read_b64_tr_b16 v[124:125], v227 offset:4096
  ds_read_b64_tr_b16 v[126:127], v227 offset:6144
  v_mfma_f32_16x16x32_bf16 v[48:51], v[132:135], v[88:91], v[48:51]
  s_waitcnt lgkmcnt(8)
  ds_read_b64_tr_b16 v[128:129], v224 offset:8192
  ds_read_b64_tr_b16 v[130:131], v224 offset:10240
  v_mfma_f32_16x16x32_bf16 v[52:55], v[136:139], v[88:91], v[52:55]
  ds_read_b64_tr_b16 v[132:133], v225 offset:8192
  ds_read_b64_tr_b16 v[134:135], v225 offset:10240
  s_waitcnt vmcnt(6)
  v_mfma_f32_16x16x32_bf16 v[40:43], v[140:143], v[92:95], v[40:43]
  buffer_load_dwordx4 v[80:83], v4, s[52:55], s15 offen offset:3072 sc1
  ds_read_b64_tr_b16 v[136:137], v226 offset:8192
  ds_read_b64_tr_b16 v[138:139], v226 offset:10240
  v_mfma_f32_16x16x32_bf16 v[44:47], v[100:103], v[92:95], v[44:47]
  buffer_load_dwordx2 v[56:57], v10, s[52:55], s85 offen sc1
  s_waitcnt lgkmcnt(8)
  ds_read_b64_tr_b16 v[140:141], v227 offset:8192
  ds_read_b64_tr_b16 v[142:143], v227 offset:10240
  v_mfma_f32_16x16x32_bf16 v[48:51], v[104:107], v[92:95], v[48:51]
  ds_read_b64_tr_b16 v[100:101], v224 offset:12288
  ds_read_b64_tr_b16 v[102:103], v224 offset:14336
  v_mfma_f32_16x16x32_bf16 v[52:55], v[108:111], v[92:95], v[52:55]
  s_mov_b64 exec, 0xffff
  buffer_store_dwordx2 v[236:237], v10, s[52:55], s67 offen sc1
  s_mov_b64 exec, -1
  ds_read_b64_tr_b16 v[104:105], v225 offset:12288
  ds_read_b64_tr_b16 v[106:107], v225 offset:14336
  s_waitcnt vmcnt(8)
  v_mfma_f32_16x16x32_bf16 v[40:43], v[112:115], v[96:99], v[40:43]
  s_waitcnt lgkmcnt(8)
  ds_read_b64_tr_b16 v[108:109], v226 offset:12288
  ds_read_b64_tr_b16 v[110:111], v226 offset:14336
  v_mfma_f32_16x16x32_bf16 v[44:47], v[116:119], v[96:99], v[44:47]
  ds_read_b64_tr_b16 v[112:113], v227 offset:12288
  ds_read_b64_tr_b16 v[114:115], v227 offset:14336
  v_mfma_f32_16x16x32_bf16 v[48:51], v[120:123], v[96:99], v[48:51]
  ds_read_b64_tr_b16 v[116:117], v224 offset:16384
  ds_read_b64_tr_b16 v[118:119], v224 offset:18432
  v_mfma_f32_16x16x32_bf16 v[52:55], v[124:127], v[96:99], v[52:55]
  s_waitcnt lgkmcnt(8)
  ds_read_b64_tr_b16 v[120:121], v225 offset:16384
  ds_read_b64_tr_b16 v[122:123], v225 offset:18432
  s_waitcnt vmcnt(7)
  v_mfma_f32_16x16x32_bf16 v[40:43], v[128:131], v[60:63], v[40:43]
  ds_read_b64_tr_b16 v[124:125], v226 offset:16384
  ds_read_b64_tr_b16 v[126:127], v226 offset:18432
  v_mfma_f32_16x16x32_bf16 v[44:47], v[132:135], v[60:63], v[44:47]
  ds_read_b64_tr_b16 v[128:129], v227 offset:16384
  ds_read_b64_tr_b16 v[130:131], v227 offset:18432
  v_mfma_f32_16x16x32_bf16 v[48:51], v[136:139], v[60:63], v[48:51]
  s_waitcnt lgkmcnt(8)
  ds_read_b64_tr_b16 v[132:133], v224 offset:20480
  ds_read_b64_tr_b16 v[134:135], v224 offset:22528
  v_mfma_f32_16x16x32_bf16 v[52:55], v[140:143], v[60:63], v[52:55]
  ds_read_b64_tr_b16 v[136:137], v225 offset:20480
  ds_read_b64_tr_b16 v[138:139], v225 offset:22528
  s_waitcnt vmcnt(6)
  v_mfma_f32_16x16x32_bf16 v[40:43], v[100:103], v[64:67], v[40:43]
  ds_read_b64_tr_b16 v[140:141], v226 offset:20480
  ds_read_b64_tr_b16 v[142:143], v226 offset:22528
  v_mfma_f32_16x16x32_bf16 v[44:47], v[104:107], v[64:67], v[44:47]
  s_waitcnt lgkmcnt(8)
  ds_read_b64_tr_b16 v[100:101], v227 offset:20480
  ds_read_b64_tr_b16 v[102:103], v227 offset:22528
  v_mfma_f32_16x16x32_bf16 v[48:51], v[108:111], v[64:67], v[48:51]
  ds_read_b64_tr_b16 v[104:105], v224 offset:24576
  ds_read_b64_tr_b16 v[106:107], v224 offset:26624
  v_mfma_f32_16x16x32_bf16 v[52:55], v[112:115], v[64:67], v[52:55]
  ds_read_b64_tr_b16 v[108:109], v225 offset:24576
  ds_read_b64_tr_b16 v[110:111], v225 offset:26624
  s_waitcnt vmcnt(5)
  v_mfma_f32_16x16x32_bf16 v[40:43], v[116:119], v[68:71], v[40:43]
  s_waitcnt vmcnt(1)
  v_cmp_ne_u32 vcc, s61, v56
  s_cbranch_vccnz L_rare_53
L_back_54:
  s_or_b32 s65, s58, s56
  s_cmp_eq_u32 s65, 0
  s_cbranch_scc1 L_rare_58
L_back_59:
  s_waitcnt lgkmcnt(8)
  ds_read_b64_tr_b16 v[112:113], v226 offset:24576
  ds_read_b64_tr_b16 v[114:115], v226 offset:26624
  v_mfma_f32_16x16x32_bf16 v[44:47], v[120:123], v[68:71], v[44:47]
  s_xor_b32 s86, s57, 0
  s_lshl_b32 s86, s86, 13
  s_add_u32 s86, s86, s2
  s_add_u32 m0, s92, 0
  ds_read_b64_tr_b16 v[116:117], v227 offset:24576
  ds_read_b64_tr_b16 v[118:119], v227 offset:26624
  v_mfma_f32_16x16x32_bf16 v[48:51], v[124:127], v[68:71], v[48:51]
  buffer_load_dwordx4 v4, s[52:55], s86 offen sc1 lds
  ds_read_b64_tr_b16 v[120:121], v224 offset:28672
  ds_read_b64_tr_b16 v[122:123], v224 offset:30720
  v_mfma_f32_16x16x32_bf16 v[52:55], v[128:131], v[68:71], v[52:55]
  buffer_load_dwordx4 v4, s[52:55], s86 offen offset:1024 sc1 lds
  s_waitcnt lgkmcnt(8)
  ds_read_b64_tr_b16 v[124:125], v225 offset:28672
  ds_read_b64_tr_b16 v[126:127], v225 offset:30720
  v_mfma_f32_16x16x32_bf16 v[40:43], v[132:135], v[72:75], v[40:43]
  ds_read_b64_tr_b16 v[128:129], v226 offset:28672
  ds_read_b64_tr_b16 v[130:131], v226 offset:30720
  v_mfma_f32_16x16x32_bf16 v[44:47], v[136:139], v[72:75], v[44:47]
  s_add_u32 s86, s86, 4096
  s_add_u32 m0, s92, 4160
  ds_read_b64_tr_b16 v[132:133], v227 offset:28672
  ds_read_b64_tr_b16 v[134:135], v227 offset:30720
  v_mfma_f32_16x16x32_bf16 v[48:51], v[140:143], v[72:75], v[48:51]
  buffer_load_dwordx4 v4, s[52:55], s86 offen sc1 lds
  v_mfma_f32_16x16x32_bf16 v[52:55], v[100:103], v[72:75], v[52:55]
  buffer_load_dwordx4 v4, s[52:55], s86 offen offset:1024 sc1 lds
  v_mfma_f32_16x16x32_bf16 v[40:43], v[104:107], v[76:79], v[40:43]
  s_waitcnt lgkmcnt(6)
  v_mfma_f32_16x16x32_bf16 v[44:47], v[108:111], v[76:79], v[44:47]
  v_mfma_f32_16x16x32_bf16 v[48:51], v[112:115], v[76:79], v[48:51]
  v_mfma_f32_16x16x32_bf16 v[52:55], v[116:119], v[76:79], v[52:55]
  v_mfma_f32_16x16x32_bf16 v[40:43], v[120:123], v[80:83], v[40:43]
  s_waitcnt lgkmcnt(0)
  v_mfma_f32_16x16x32_bf16 v[44:47], v[124:127], v[80:83], v[44:47]
  v_mfma_f32_16x16x32_bf16 v[48:51], v[128:131], v[80:83], v[48:51]
  v_mfma_f32_16x16x32_bf16 v[52:55], v[132:135], v[80:83], v[52:55]
  s_nop 3
  v_pk_mul_f32 v[40:41], v[40:41], s[70:71]
  v_pk_mul_f32 v[42:43], v[42:43], s[70:71]
  v_cvt_pk_bf16_f32 v40, v40, v41
  v_cvt_pk_bf16_f32 v41, v42, v43
  ds_write_b64 v9, v[40:41] offset:0
  v_pk_mul_f32 v[44:45], v[44:45], s[70:71]
  v_pk_mul_f32 v[46:47], v[46:47], s[70:71]
  v_cvt_pk_bf16_f32 v44, v44, v45
  v_cvt_pk_bf16_f32 v45, v46, v47
  ds_write_b64 v9, v[44:45] offset:1024
  v_pk_mul_f32 v[48:49], v[48:49], s[70:71]
  v_pk_mul_f32 v[50:51], v[50:51], s[70:71]
  v_cvt_pk_bf16_f32 v48, v48, v49
  v_cvt_pk_bf16_f32 v49, v50, v51
  ds_write_b64 v9, v[48:49] offset:2048
  v_pk_mul_f32 v[52:53], v[52:53], s[70:71]
  v_pk_mul_f32 v[54:55], v[54:55], s[70:71]
  v_cvt_pk_bf16_f32 v52, v52, v53
  v_cvt_pk_bf16_f32 v53, v54, v55
  ds_write_b64 v9, v[52:53] offset:3072
  v_and_b32 v38, 7, v1
  v_lshlrev_b32 v38, 7, v38
  s_mov_b32 s85, 4096
  s_waitcnt vmcnt(0) lgkmcnt(0)
  s_barrier
  ds_read_b128 v[40:43], v145 offset:0
  ds_read_b128 v[44:47], v145 offset:1024
  ds_read_b128 v[48:51], v144 offset:0
  ds_read_b128 v[52:55], v144 offset:1024
  ds_read_b128 v[184:187], v11
  ds_read_b128 v[192:195], v12
  ds_read_b128 v[196:199], v13
  s_mov_b32 exec_hi, 0
  ds_write_b128 v36, v[148:151] offset:2048
  s_mov_b64 exec, -1
  s_lshl_b32 s94, s56, 13
  s_lshl_b32 s91, s94, 3
  s_add_u32 s91, s91, s87
  s_lshl_b32 s65, s56, 15
  s_lshl_b32 s66, s59, 12
  s_add_u32 s65, s65, s66
  s_add_u32 s84, s65, 655360
  v_lshlrev_b32 v37, 3, v1
  v_mov_b32 v140, 0
  v_mov_b32 v141, 0
  v_mov_b32 v142, 0
  v_mov_b32 v143, 0
  s_waitcnt lgkmcnt(3)
  v_mfma_f32_32x32x16_bf16 v[152:167], v[184:187], v[40:43], 0
  buffer_load_dwordx2 v[56:57], v38, s[52:55], s85 offen sc1
  s_lshl_b32 s65, s60, 7
  s_lshl_b32 s66, s56, 5
  s_add_u32 s68, s65, s66
  v_lshlrev_b32 v15, 1, v2
  v_lshrrev_b32 v10, 2, v1
  v_lshlrev_b32 v10, 7, v10
  s_lshl_b32 s95, s58, 2
  s_add_u32 s95, s95, s56
  s_lshl_b32 s95, s95, 11
  s_waitcnt lgkmcnt(0)
  s_mov_b32 s15, 0x07060302
  v_exp_f32 v152, v152
  v_exp_f32 v153, v153
  v_exp_f32 v154, v154
  v_exp_f32 v155, v155
  v_perm_b32 v124, v153, v152, s15
  v_mfma_f32_32x32x16_bf16 v[168:183], v[184:187], v[44:47], 0
  v_exp_f32 v156, v156
  v_exp_f32 v157, v157
  v_perm_b32 v125, v155, v154, s15
  v_exp_f32 v158, v158
  v_exp_f32 v159, v159
  v_perm_b32 v126, v157, v156, s15
  v_exp_f32 v160, v160
  v_exp_f32 v161, v161
  v_perm_b32 v127, v159, v158, s15
  ds_read_b128 v[188:191], v11 offset:2080
  v_exp_f32 v162, v162
  v_exp_f32 v163, v163
  v_perm_b32 v128, v161, v160, s15
  v_exp_f32 v164, v164
  v_exp_f32 v165, v165
  v_perm_b32 v129, v163, v162, s15
  v_mfma_f32_32x32x16_bf16 v[60:75], v[192:195], v[124:127], 0
  v_exp_f32 v166, v166
  v_exp_f32 v167, v167
  v_perm_b32 v130, v165, v164, s15
  v_exp_f32 v168, v168
  v_exp_f32 v169, v169
  v_perm_b32 v131, v167, v166, s15
  v_exp_f32 v170, v170
  v_exp_f32 v171, v171
  v_perm_b32 v132, v169, v168, s15
  v_mfma_f32_32x32x16_bf16 v[152:167], v[184:187], v[48:51], 0
  v_exp_f32 v172, v172
  v_exp_f32 v173, v173
  v_perm_b32 v133, v171, v170, s15
  v_exp_f32 v174, v174
  v_exp_f32 v175, v175
  v_perm_b32 v134, v173, v172, s15
  v_exp_f32 v176, v176
  v_exp_f32 v177, v177
  v_perm_b32 v135, v175, v174, s15
  v_mfma_f32_32x32x16_bf16 v[60:75], v[196:199], v[128:131], v[60:75]
  ds_read_b128 v[200:203], v12 offset:2080
  ds_read_b128 v[204:207], v13 offset:2080
  v_exp_f32 v178, v178
  v_exp_f32 v179, v179
  v_perm_b32 v136, v177, v176, s15
  v_exp_f32 v180, v180
  v_exp_f32 v181, v181
  v_perm_b32 v137, v179, v178, s15
  v_mfma_f32_32x32x16_bf16 v[76:91], v[192:195], v[132:135], 0
  v_exp_f32 v182, v182
  v_exp_f32 v183, v183
  v_perm_b32 v138, v181, v180, s15
  v_exp_f32 v152, v152
  v_exp_f32 v153, v153
  v_perm_b32 v139, v183, v182, s15
  v_exp_f32 v154, v154
  v_exp_f32 v155, v155
  v_perm_b32 v124, v153, v152, s15
  v_mfma_f32_32x32x16_bf16 v[168:183], v[184:187], v[52:55], 0
  v_exp_f32 v156, v156
  v_exp_f32 v157, v157
  v_perm_b32 v125, v155, v154, s15
  v_exp_f32 v158, v158
  v_exp_f32 v159, v159
  v_perm_b32 v126, v157, v156, s15
  v_exp_f32 v160, v160
  v_exp_f32 v161, v161
  v_perm_b32 v127, v159, v158, s15
  v_mfma_f32_32x32x16_bf16 v[76:91], v[196:199], v[136:139], v[76:91]
  v_exp_f32 v162, v162
  v_exp_f32 v163, v163
  v_perm_b32 v128, v161, v160, s15
  v_exp_f32 v164, v164
  v_exp_f32 v165, v165
  v_perm_b32 v129, v163, v162, s15
  v_mfma_f32_32x32x16_bf16 v[92:107], v[192:195], v[124:127], 0
  s_waitcnt lgkmcnt(0)
  v_exp_f32 v166, v166
  v_exp_f32_e64 v167, v167
  v_perm_b32 v130, v165, v164, s15
  v_exp_f32 v168, v168
  v_exp_f32 v169, v169
  v_perm_b32 v131, v167, v166, s15
  v_exp_f32 v170, v170
  v_exp_f32 v171, v171
  v_perm_b32 v132, v169, v168, s15
  v_mfma_f32_32x32x16_bf16 v[152:167], v[188:191], v[40:43], 0
  v_exp_f32 v172, v172
  v_exp_f32 v173, v173
  v_perm_b32 v133, v171, v170, s15
  v_exp_f32 v174, v174
  v_exp_f32 v175, v175
  v_perm_b32 v134, v173, v172, s15
  v_exp_f32 v176, v176
  v_exp_f32 v177, v177
  v_perm_b32 v135, v175, v174, s15
  v_mfma_f32_32x32x16_bf16 v[92:107], v[196:199], v[128:131], v[92:107]
  v_exp_f32 v178, v178
  v_exp_f32 v179, v179
  v_perm_b32 v136, v177, v176, s15
  v_exp_f32 v180, v180
  v_exp_f32 v181, v181
  v_perm_b32 v137, v179, v178, s15
  v_mfma_f32_32x32x16_bf16 v[108:123], v[192:195], v[132:135], 0
  v_exp_f32 v182, v182
  v_exp_f32 v183, v183
  v_perm_b32 v138, v181, v180, s15
  v_exp_f32 v152, v152
  v_exp_f32 v153, v153
  v_perm_b32 v139, v183, v182, s15
  v_exp_f32 v154, v154
  v_exp_f32 v155, v155
  v_perm_b32 v124, v153, v152, s15
  v_mfma_f32_32x32x16_bf16 v[168:183], v[188:191], v[44:47], 0
  s_waitcnt vmcnt(0)
  v_cmp_ne_u32 vcc, s61, v56
  s_cbranch_vccnz L_rare_60
L_back_61:
  v_exp_f32 v156, v156
  v_exp_f32_e64 v157, v157
  v_perm_b32 v125, v155, v154, s15
  v_exp_f32 v158, v158
  v_exp_f32 v159, v159
  v_perm_b32 v126, v157, v156, s15
  v_exp_f32 v160, v160
  v_exp_f32 v161, v161
  v_perm_b32 v127, v159, v158, s15
  v_mfma_f32_32x32x16_bf16 v[108:123], v[196:199], v[136:139], v[108:123]
  ds_read_b128 v[184:187], v11 offset:4160
  v_exp_f32 v162, v162
  v_exp_f32 v163, v163
  v_perm_b32 v128, v161, v160, s15
  v_exp_f32 v164, v164
  v_exp_f32 v165, v165
  v_perm_b32 v129, v163, v162, s15
  v_mfma_f32_32x32x16_bf16 v[60:75], v[200:203], v[124:127], v[60:75]
  s_xor_b32 s86, s57, 1
  s_lshl_b32 s86, s86, 13
  s_add_u32 s86, s86, s2
  s_add_u32 m0, s92, 8320
  v_exp_f32 v166, v166
  v_exp_f32_e64 v167, v167
  v_perm_b32 v130, v165, v164, s15
  v_exp_f32 v168, v168
  v_exp_f32 v169, v169
  v_perm_b32 v131, v167, v166, s15
  v_exp_f32 v170, v170
  v_exp_f32 v171, v171
  v_perm_b32 v132, v169, v168, s15
  v_mfma_f32_32x32x16_bf16 v[152:167], v[188:191], v[48:51], 0
  buffer_load_dwordx4 v4, s[52:55], s86 offen sc1 lds
  buffer_load_dwordx4 v4, s[52:55], s86 offen offset:1024 sc1 lds
  v_exp_f32 v172, v172
  v_exp_f32 v173, v173
  v_perm_b32 v133, v171, v170, s15
  v_exp_f32 v174, v174
  v_exp_f32 v175, v175
  v_perm_b32 v134, v173, v172, s15
  v_exp_f32 v176, v176
  v_exp_f32 v177, v177
  v_perm_b32 v135, v175, v174, s15
  v_mfma_f32_32x32x16_bf16 v[60:75], v[204:207], v[128:131], v[60:75]
  ds_read_b128 v[192:195], v12 offset:4160
  ds_read_b128 v[196:199], v13 offset:4160
  v_exp_f32 v178, v178
  v_exp_f32 v179, v179
  v_perm_b32 v136, v177, v176, s15
  v_exp_f32 v180, v180
  v_exp_f32 v181, v181
  v_perm_b32 v137, v179, v178, s15
  v_mfma_f32_32x32x16_bf16 v[76:91], v[200:203], v[132:135], v[76:91]
  s_add_u32 s86, s86, 4096
  s_add_u32 m0, s92, 12480
  v_exp_f32 v182, v182
  v_exp_f32 v183, v183
  v_perm_b32 v138, v181, v180, s15
  v_exp_f32 v152, v152
  v_exp_f32 v153, v153
  v_perm_b32 v139, v183, v182, s15
  v_exp_f32 v154, v154
  v_exp_f32 v155, v155
  v_perm_b32 v124, v153, v152, s15
  v_mfma_f32_32x32x16_bf16 v[168:183], v[188:191], v[52:55], 0
  buffer_load_dwordx4 v4, s[52:55], s86 offen sc1 lds
  buffer_load_dwordx4 v4, s[52:55], s86 offen offset:1024 sc1 lds
  v_exp_f32 v156, v156
  v_exp_f32 v157, v157
  v_perm_b32 v125, v155, v154, s15
  v_exp_f32 v158, v158
  v_exp_f32 v159, v159
  v_perm_b32 v126, v157, v156, s15
  v_exp_f32 v160, v160
  v_exp_f32 v161, v161
  v_perm_b32 v127, v159, v158, s15
  v_mfma_f32_32x32x16_bf16 v[76:91], v[204:207], v[136:139], v[76:91]
  s_xor_b32 s86, s57, 2
  s_lshl_b32 s86, s86, 13
  s_add_u32 s86, s86, s2
  s_add_u32 m0, s92, 16640
  v_exp_f32 v162, v162
  v_exp_f32_e64 v163, v163
  v_perm_b32 v128, v161, v160, s15
  v_exp_f32 v164, v164
  v_exp_f32 v165, v165
  v_perm_b32 v129, v163, v162, s15
  v_mfma_f32_32x32x16_bf16 v[92:107], v[200:203], v[124:127], v[92:107]
  s_waitcnt lgkmcnt(0)
  v_exp_f32 v166, v166
  v_exp_f32_e64 v167, v167
  v_perm_b32 v130, v165, v164, s15
  v_exp_f32 v168, v168
  v_exp_f32 v169, v169
  v_perm_b32 v131, v167, v166, s15
  v_exp_f32 v170, v170
  v_exp_f32 v171, v171
  v_perm_b32 v132, v169, v168, s15
  v_mfma_f32_32x32x16_bf16 v[152:167], v[184:187], v[40:43], 0
  buffer_load_dwordx4 v4, s[52:55], s86 offen sc1 lds
  buffer_load_dwordx4 v4, s[52:55], s86 offen offset:1024 sc1 lds
  v_exp_f32 v172, v172
  v_exp_f32 v173, v173
  v_perm_b32 v133, v171, v170, s15
  v_exp_f32 v174, v174
  v_exp_f32 v175, v175
  v_perm_b32 v134, v173, v172, s15
  v_exp_f32 v176, v176
  v_exp_f32 v177, v177
  v_perm_b32 v135, v175, v174, s15
  v_mfma_f32_32x32x16_bf16 v[92:107], v[204:207], v[128:131], v[92:107]
  s_add_u32 s86, s86, 4096
  s_add_u32 m0, s92, 20800
  v_exp_f32 v178, v178
  v_exp_f32 v179, v179
  v_perm_b32 v136, v177, v176, s15
  v_exp_f32 v180, v180
  v_exp_f32 v181, v181
  v_perm_b32 v137, v179, v178, s15
  v_mfma_f32_32x32x16_bf16 v[108:123], v[200:203], v[132:135], v[108:123]
  buffer_load_dwordx4 v4, s[52:55], s86 offen sc1 lds
  buffer_load_dwordx4 v4, s[52:55], s86 offen offset:1024 sc1 lds
  v_exp_f32 v182, v182
  v_exp_f32 v183, v183
  v_perm_b32 v138, v181, v180, s15
  v_exp_f32 v152, v152
  v_exp_f32 v153, v153
  v_perm_b32 v139, v183, v182, s15
  v_exp_f32 v154, v154
  v_exp_f32 v155, v155
  v_perm_b32 v124, v153, v152, s15
  v_mfma_f32_32x32x16_bf16 v[168:183], v[184:187], v[44:47], 0
  s_xor_b32 s86, s57, 3
  s_lshl_b32 s86, s86, 13
  s_add_u32 s86, s86, s2
  s_add_u32 m0, s92, 24960
  v_exp_f32 v156, v156
  v_exp_f32_e64 v157, v157
  v_perm_b32 v125, v155, v154, s15
  v_exp_f32 v158, v158
  v_exp_f32 v159, v159
  v_perm_b32 v126, v157, v156, s15
  v_exp_f32 v160, v160
  v_exp_f32 v161, v161
  v_perm_b32 v127, v159, v158, s15
  v_mfma_f32_32x32x16_bf16 v[108:123], v[204:207], v[136:139], v[108:123]
  ds_read_b128 v[188:191], v11 offset:6240
  v_exp_f32 v162, v162
  v_exp_f32 v163, v163
  v_perm_b32 v128, v161, v160, s15
  v_exp_f32 v164, v164
  v_exp_f32 v165, v165
  v_perm_b32 v129, v163, v162, s15
  v_mfma_f32_32x32x16_bf16 v[60:75], v[192:195], v[124:127], v[60:75]
  buffer_load_dwordx4 v4, s[52:55], s86 offen sc1 lds
  buffer_load_dwordx4 v4, s[52:55], s86 offen offset:1024 sc1 lds
  v_exp_f32 v166, v166
  v_exp_f32 v167, v167
  v_perm_b32 v130, v165, v164, s15
  v_exp_f32 v168, v168
  v_exp_f32 v169, v169
  v_perm_b32 v131, v167, v166, s15
  v_exp_f32 v170, v170
  v_exp_f32 v171, v171
  v_perm_b32 v132, v169, v168, s15
  v_mfma_f32_32x32x16_bf16 v[152:167], v[184:187], v[48:51], 0
  s_add_u32 s86, s86, 4096
  s_add_u32 m0, s92, 29120
  v_exp_f32 v172, v172
  v_exp_f32 v173, v173
  v_perm_b32 v133, v171, v170, s15
  v_exp_f32 v174, v174
  v_exp_f32 v175, v175
  v_perm_b32 v134, v173, v172, s15
  v_exp_f32 v176, v176
  v_exp_f32 v177, v177
  v_perm_b32 v135, v175, v174, s15
  v_mfma_f32_32x32x16_bf16 v[60:75], v[196:199], v[128:131], v[60:75]
  ds_read_b128 v[200:203], v12 offset:6240
  ds_read_b128 v[204:207], v13 offset:6240
  v_exp_f32 v178, v178
  v_exp_f32 v179, v179
  v_perm_b32 v136, v177, v176, s15
  v_exp_f32 v180, v180
  v_exp_f32 v181, v181
  v_perm_b32 v137, v179, v178, s15
  v_mfma_f32_32x32x16_bf16 v[76:91], v[192:195], v[132:135], v[76:91]
  buffer_load_dwordx4 v4, s[52:55], s86 offen sc1 lds
  buffer_load_dwordx4 v4, s[52:55], s86 offen offset:1024 sc1 lds
  v_exp_f32 v182, v182
  v_exp_f32 v183, v183
  v_perm_b32 v138, v181, v180, s15
  v_exp_f32 v152, v152
  v_exp_f32 v153, v153
  v_perm_b32 v139, v183, v182, s15
  v_exp_f32 v154, v154
  v_exp_f32 v155, v155
  v_perm_b32 v124, v153, v152, s15
  v_mfma_f32_32x32x16_bf16 v[168:183], v[184:187], v[52:55], 0
  v_exp_f32 v156, v156
  v_exp_f32 v157, v157
  v_perm_b32 v125, v155, v154, s15
  v_exp_f32 v158, v158
  v_exp_f32 v159, v159
  v_perm_b32 v126, v157, v156, s15
  v_exp_f32 v160, v160
  v_exp_f32 v161, v161
  v_perm_b32 v127, v159, v158, s15
  v_mfma_f32_32x32x16_bf16 v[76:91], v[196:199], v[136:139], v[76:91]
  buffer_load_dwordx4 a[0:3], v23, s[28:31], s76 offen offset:0
  buffer_load_dwordx4 a[4:7], v23, s[28:31], s76 offen offset:64
  v_exp_f32 v162, v162
  v_exp_f32 v163, v163
  v_perm_b32 v128, v161, v160, s15
  v_exp_f32 v164, v164
  v_exp_f32 v165, v165
  v_perm_b32 v129, v163, v162, s15
  v_mfma_f32_32x32x16_bf16 v[92:107], v[192:195], v[124:127], v[92:107]
  s_waitcnt lgkmcnt(0)
  v_exp_f32 v166, v166
  v_exp_f32_e64 v167, v167
  v_perm_b32 v130, v165, v164, s15
  v_exp_f32 v168, v168
  v_exp_f32 v169, v169
  v_perm_b32 v131, v167, v166, s15
  v_exp_f32 v170, v170
  v_exp_f32 v171, v171
  v_perm_b32 v132, v169, v168, s15
  v_mfma_f32_32x32x16_bf16 v[152:167], v[188:191], v[40:43], 0
  s_xor_b32 s86, s57, 4
  s_lshl_b32 s86, s86, 13
  s_add_u32 s86, s86, s2
  s_add_u32 m0, s92, 33280
  v_exp_f32 v172, v172
  v_exp_f32_e64 v173, v173
  v_perm_b32 v133, v171, v170, s15
  v_exp_f32 v174, v174
  v_exp_f32 v175, v175
  v_perm_b32 v134, v173, v172, s15
  v_exp_f32 v176, v176
  v_exp_f32 v177, v177
  v_perm_b32 v135, v175, v174, s15
  v_mfma_f32_32x32x16_bf16 v[92:107], v[196:199], v[128:131], v[92:107]
  buffer_load_dwordx4 v4, s[52:55], s86 offen sc1 lds
  buffer_load_dwordx4 v4, s[52:55], s86 offen offset:1024 sc1 lds
  v_exp_f32 v178, v178
  v_exp_f32 v179, v179
  v_perm_b32 v136, v177, v176, s15
  v_exp_f32 v180, v180
  v_exp_f32 v181, v181
  v_perm_b32 v137, v179, v178, s15
  v_mfma_f32_32x32x16_bf16 v[108:123], v[192:195], v[132:135], v[108:123]
  v_exp_f32 v182, v182
  v_exp_f32 v183, v183
  v_perm_b32 v138, v181, v180, s15
  v_exp_f32 v152, v152
  v_exp_f32 v153, v153
  v_perm_b32 v139, v183, v182, s15
  v_exp_f32 v154, v154
  v_exp_f32 v155, v155
  v_perm_b32 v124, v153, v152, s15
  v_mfma_f32_32x32x16_bf16 v[168:183], v[188:191], v[44:47], 0
  s_waitcnt vmcnt(12)
  s_barrier
  v_exp_f32 v156, v156
  v_exp_f32 v157, v157
  v_perm_b32 v125, v155, v154, s15
  v_exp_f32 v158, v158
  v_exp_f32 v159, v159
  v_perm_b32 v126, v157, v156, s15
  v_exp_f32 v160, v160
  v_exp_f32 v161, v161
  v_perm_b32 v127, v159, v158, s15
  v_mfma_f32_32x32x16_bf16 v[108:123], v[196:199], v[136:139], v[108:123]
  ds_read_b128 v[184:187], v11 offset:8320
  v_exp_f32 v162, v162
  v_exp_f32 v163, v163
  v_perm_b32 v128, v161, v160, s15
  v_exp_f32 v164, v164
  v_exp_f32 v165, v165
  v_perm_b32 v129, v163, v162, s15
  v_mfma_f32_32x32x16_bf16 v[60:75], v[200:203], v[124:127], v[60:75]
  v_exp_f32 v166, v166
  v_exp_f32 v167, v167
  v_perm_b32 v130, v165, v164, s15
  v_exp_f32 v168, v168
  v_exp_f32 v169, v169
  v_perm_b32 v131, v167, v166, s15
  v_exp_f32 v170, v170
  v_exp_f32 v171, v171
  v_perm_b32 v132, v169, v168, s15
  v_mfma_f32_32x32x16_bf16 v[152:167], v[188:191], v[48:51], 0
  s_add_u32 s86, s86, 4096
  s_add_u32 m0, s92, 37440
  v_exp_f32 v172, v172
  v_exp_f32 v173, v173
  v_perm_b32 v133, v171, v170, s15
  v_exp_f32 v174, v174
  v_exp_f32 v175, v175
  v_perm_b32 v134, v173, v172, s15
  v_exp_f32 v176, v176
  v_exp_f32 v177, v177
  v_perm_b32 v135, v175, v174, s15
  v_mfma_f32_32x32x16_bf16 v[60:75], v[204:207], v[128:131], v[60:75]
  ds_read_b128 v[192:195], v12 offset:8320
  ds_read_b128 v[196:199], v13 offset:8320
  v_exp_f32 v178, v178
  v_exp_f32 v179, v179
  v_perm_b32 v136, v177, v176, s15
  v_exp_f32 v180, v180
  v_exp_f32 v181, v181
  v_perm_b32 v137, v179, v178, s15
  v_mfma_f32_32x32x16_bf16 v[76:91], v[200:203], v[132:135], v[76:91]
  buffer_load_dwordx4 v4, s[52:55], s86 offen sc1 lds
  buffer_load_dwordx4 v4, s[52:55], s86 offen offset:1024 sc1 lds
  v_exp_f32 v182, v182
  v_exp_f32 v183, v183
  v_perm_b32 v138, v181, v180, s15
  v_exp_f32 v152, v152
  v_exp_f32 v153, v153
  v_perm_b32 v139, v183, v182, s15
  v_exp_f32 v154, v154
  v_exp_f32 v155, v155
  v_perm_b32 v124, v153, v152, s15
  v_mfma_f32_32x32x16_bf16 v[168:183], v[188:191], v[52:55], 0
  v_exp_f32 v156, v156
  v_exp_f32 v157, v157
  v_perm_b32 v125, v155, v154, s15
  v_exp_f32 v158, v158
  v_exp_f32 v159, v159
  v_perm_b32 v126, v157, v156, s15
  v_exp_f32 v160, v160
  v_exp_f32 v161, v161
  v_perm_b32 v127, v159, v158, s15
  v_mfma_f32_32x32x16_bf16 v[76:91], v[204:207], v[136:139], v[76:91]
  buffer_load_dwordx4 a[64:67], v24, s[28:31], s76 offen offset:0
  buffer_load_dwordx4 a[68:71], v24, s[28:31], s76 offen offset:64
  v_exp_f32 v162, v162
  v_exp_f32 v163, v163
  v_perm_b32 v128, v161, v160, s15
  v_exp_f32 v164, v164
  v_exp_f32 v165, v165
  v_perm_b32 v129, v163, v162, s15
  v_mfma_f32_32x32x16_bf16 v[92:107], v[200:203], v[124:127], v[92:107]
  s_waitcnt lgkmcnt(0)
  v_exp_f32 v166, v166
  v_exp_f32_e64 v167, v167
  v_perm_b32 v130, v165, v164, s15
  v_exp_f32 v168, v168
  v_exp_f32 v169, v169
  v_perm_b32 v131, v167, v166, s15
  v_exp_f32 v170, v170
  v_exp_f32 v171, v171
  v_perm_b32 v132, v169, v168, s15
  v_mfma_f32_32x32x16_bf16 v[152:167], v[184:187], v[40:43], 0
  s_xor_b32 s86, s57, 5
  s_lshl_b32 s86, s86, 13
  s_add_u32 s86, s86, s2
  s_add_u32 m0, s92, 41600
  v_exp_f32 v172, v172
  v_exp_f32_e64 v173, v173
  v_perm_b32 v133, v171, v170, s15
  v_exp_f32 v174, v174
  v_exp_f32 v175, v175
  v_perm_b32 v134, v173, v172, s15
  v_exp_f32 v176, v176
  v_exp_f32 v177, v177
  v_perm_b32 v135, v175, v174, s15
  v_mfma_f32_32x32x16_bf16 v[92:107], v[204:207], v[128:131], v[92:107]
  buffer_load_dwordx4 v4, s[52:55], s86 offen sc1 lds
  buffer_load_dwordx4 v4, s[52:55], s86 offen offset:1024 sc1 lds
  v_exp_f32 v178, v178
  v_exp_f32 v179, v179
  v_perm_b32 v136, v177, v176, s15
  v_exp_f32 v180, v180
  v_exp_f32 v181, v181
  v_perm_b32 v137, v179, v178, s15
  v_mfma_f32_32x32x16_bf16 v[108:123], v[200:203], v[132:135], v[108:123]
  v_exp_f32 v182, v182
  v_exp_f32 v183, v183
  v_perm_b32 v138, v181, v180, s15
  v_exp_f32 v152, v152
  v_exp_f32 v153, v153
  v_perm_b32 v139, v183, v182, s15
  v_exp_f32 v154, v154
  v_exp_f32 v155, v155
  v_perm_b32 v124, v153, v152, s15
  v_mfma_f32_32x32x16_bf16 v[168:183], v[184:187], v[44:47], 0
  v_exp_f32 v156, v156
  v_exp_f32 v157, v157
  v_perm_b32 v125, v155, v154, s15
  v_exp_f32 v158, v158
  v_exp_f32 v159, v159
  v_perm_b32 v126, v157, v156, s15
  v_exp_f32 v160, v160
  v_exp_f32 v161, v161
  v_perm_b32 v127, v159, v158, s15
  v_mfma_f32_32x32x16_bf16 v[108:123], v[204:207], v[136:139], v[108:123]
  ds_read_b128 v[188:191], v11 offset:10400
  v_exp_f32 v162, v162
  v_exp_f32 v163, v163
  v_perm_b32 v128, v161, v160, s15
  v_exp_f32 v164, v164
  v_exp_f32 v165, v165
  v_perm_b32 v129, v163, v162, s15
  v_mfma_f32_32x32x16_bf16 v[60:75], v[192:195], v[124:127], v[60:75]
  v_exp_f32 v166, v166
  v_exp_f32 v167, v167
  v_perm_b32 v130, v165, v164, s15
  v_exp_f32 v168, v168
  v_exp_f32 v169, v169
  v_perm_b32 v131, v167, v166, s15
  v_exp_f32 v170, v170
  v_exp_f32 v171, v171
  v_perm_b32 v132, v169, v168, s15
  v_mfma_f32_32x32x16_bf16 v[152:167], v[184:187], v[48:51], 0
  s_add_u32 s86, s86, 4096
  s_add_u32 m0, s92, 45760
  v_exp_f32 v172, v172
  v_exp_f32 v173, v173
  v_perm_b32 v133, v171, v170, s15
  v_exp_f32 v174, v174
  v_exp_f32 v175, v175
  v_perm_b32 v134, v173, v172, s15
  v_exp_f32 v176, v176
  v_exp_f32 v177, v177
  v_perm_b32 v135, v175, v174, s15
  v_mfma_f32_32x32x16_bf16 v[60:75], v[196:199], v[128:131], v[60:75]
  ds_read_b128 v[200:203], v12 offset:10400
  ds_read_b128 v[204:207], v13 offset:10400
  v_exp_f32 v178, v178
  v_exp_f32 v179, v179
  v_perm_b32 v136, v177, v176, s15
  v_exp_f32 v180, v180
  v_exp_f32 v181, v181
  v_perm_b32 v137, v179, v178, s15
  v_mfma_f32_32x32x16_bf16 v[76:91], v[192:195], v[132:135], v[76:91]
  buffer_load_dwordx4 v4, s[52:55], s86 offen sc1 lds
  buffer_load_dwordx4 v4, s[52:55], s86 offen offset:1024 sc1 lds
  v_exp_f32 v182, v182
  v_exp_f32 v183, v183
  v_perm_b32 v138, v181, v180, s15
  v_exp_f32 v152, v152
  v_exp_f32 v153, v153
  v_perm_b32 v139, v183, v182, s15
  v_exp_f32 v154, v154
  v_exp_f32 v155, v155
  v_perm_b32 v124, v153, v152, s15
  v_mfma_f32_32x32x16_bf16 v[168:183], v[184:187], v[52:55], 0
  v_exp_f32 v156, v156
  v_exp_f32 v157, v157
  v_perm_b32 v125, v155, v154, s15
  v_exp_f32 v158, v158
  v_exp_f32 v159, v159
  v_perm_b32 v126, v157, v156, s15
  v_exp_f32 v160, v160
  v_exp_f32 v161, v161
  v_perm_b32 v127, v159, v158, s15
  v_mfma_f32_32x32x16_bf16 v[76:91], v[196:199], v[136:139], v[76:91]
  buffer_load_dwordx4 a[128:131], v25, s[28:31], s76 offen offset:0
  buffer_load_dwordx4 a[132:135], v25, s[28:31], s76 offen offset:64
  v_exp_f32 v162, v162
  v_exp_f32 v163, v163
  v_perm_b32 v128, v161, v160, s15
  v_exp_f32 v164, v164
  v_exp_f32 v165, v165
  v_perm_b32 v129, v163, v162, s15
  v_mfma_f32_32x32x16_bf16 v[92:107], v[192:195], v[124:127], v[92:107]
  s_waitcnt lgkmcnt(0)
  v_exp_f32 v166, v166
  v_exp_f32_e64 v167, v167
  v_perm_b32 v130, v165, v164, s15
  v_exp_f32 v168, v168
  v_exp_f32 v169, v169
  v_perm_b32 v131, v167, v166, s15
  v_exp_f32 v170, v170
  v_exp_f32 v171, v171
  v_perm_b32 v132, v169, v168, s15
  v_mfma_f32_32x32x16_bf16 v[152:167], v[188:191], v[40:43], 0
  s_xor_b32 s86, s57, 6
  s_lshl_b32 s86, s86, 13
  s_add_u32 s86, s86, s2
  s_add_u32 m0, s92, 49920
  v_exp_f32 v172, v172
  v_exp_f32_e64 v173, v173
  v_perm_b32 v133, v171, v170, s15
  v_exp_f32 v174, v174
  v_exp_f32 v175, v175
  v_perm_b32 v134, v173, v172, s15
  v_exp_f32 v176, v176
  v_exp_f32 v177, v177
  v_perm_b32 v135, v175, v174, s15
  v_mfma_f32_32x32x16_bf16 v[92:107], v[196:199], v[128:131], v[92:107]
  buffer_load_dwordx4 v4, s[52:55], s86 offen sc1 lds
  buffer_load_dwordx4 v4, s[52:55], s86 offen offset:1024 sc1 lds
  v_exp_f32 v178, v178
  v_exp_f32 v179, v179
  v_perm_b32 v136, v177, v176, s15
  v_exp_f32 v180, v180
  v_exp_f32 v181, v181
  v_perm_b32 v137, v179, v178, s15
  v_mfma_f32_32x32x16_bf16 v[108:123], v[192:195], v[132:135], v[108:123]
  v_exp_f32 v182, v182
  v_exp_f32 v183, v183
  v_perm_b32 v138, v181, v180, s15
  v_exp_f32 v152, v152
  v_exp_f32 v153, v153
  v_perm_b32 v139, v183, v182, s15
  v_exp_f32 v154, v154
  v_exp_f32 v155, v155
  v_perm_b32 v124, v153, v152, s15
  v_mfma_f32_32x32x16_bf16 v[168:183], v[188:191], v[44:47], 0
  buffer_load_dwordx4 a[192:195], v26, s[28:31], s76 offen offset:0
  buffer_load_dwordx4 a[196:199], v26, s[28:31], s76 offen offset:64
  v_exp_f32 v156, v156
  v_exp_f32 v157, v157
  v_perm_b32 v125, v155, v154, s15
  v_exp_f32 v158, v158
  v_exp_f32 v159, v159
  v_perm_b32 v126, v157, v156, s15
  v_exp_f32 v160, v160
  v_exp_f32 v161, v161
  v_perm_b32 v127, v159, v158, s15
  v_mfma_f32_32x32x16_bf16 v[108:123], v[196:199], v[136:139], v[108:123]
  ds_read_b128 v[184:187], v11 offset:12480
  v_exp_f32 v162, v162
  v_exp_f32 v163, v163
  v_perm_b32 v128, v161, v160, s15
  v_exp_f32 v164, v164
  v_exp_f32 v165, v165
  v_perm_b32 v129, v163, v162, s15
  v_mfma_f32_32x32x16_bf16 v[60:75], v[200:203], v[124:127], v[60:75]
  v_exp_f32 v166, v166
  v_exp_f32 v167, v167
  v_perm_b32 v130, v165, v164, s15
  v_exp_f32 v168, v168
  v_exp_f32 v169, v169
  v_perm_b32 v131, v167, v166, s15
  v_exp_f32 v170, v170
  v_exp_f32 v171, v171
  v_perm_b32 v132, v169, v168, s15
  v_mfma_f32_32x32x16_bf16 v[152:167], v[188:191], v[48:51], 0
  s_add_u32 s86, s86, 4096
  s_add_u32 m0, s92, 54080
  v_exp_f32 v172, v172
  v_exp_f32 v173, v173
  v_perm_b32 v133, v171, v170, s15
  v_exp_f32 v174, v174
  v_exp_f32 v175, v175
  v_perm_b32 v134, v173, v172, s15
  v_exp_f32 v176, v176
  v_exp_f32 v177, v177
  v_perm_b32 v135, v175, v174, s15
  v_mfma_f32_32x32x16_bf16 v[60:75], v[204:207], v[128:131], v[60:75]
  ds_read_b128 v[192:195], v12 offset:12480
  ds_read_b128 v[196:199], v13 offset:12480
  v_exp_f32 v178, v178
  v_exp_f32 v179, v179
  v_perm_b32 v136, v177, v176, s15
  v_exp_f32 v180, v180
  v_exp_f32 v181, v181
  v_perm_b32 v137, v179, v178, s15
  v_mfma_f32_32x32x16_bf16 v[76:91], v[200:203], v[132:135], v[76:91]
  buffer_load_dwordx4 v4, s[52:55], s86 offen sc1 lds
  buffer_load_dwordx4 v4, s[52:55], s86 offen offset:1024 sc1 lds
  v_exp_f32 v182, v182
  v_exp_f32 v183, v183
  v_perm_b32 v138, v181, v180, s15
  v_exp_f32 v152, v152
  v_exp_f32 v153, v153
  v_perm_b32 v139, v183, v182, s15
  v_exp_f32 v154, v154
  v_exp_f32 v155, v155
  v_perm_b32 v124, v153, v152, s15
  v_mfma_f32_32x32x16_bf16 v[168:183], v[188:191], v[52:55], 0
  v_exp_f32 v156, v156
  v_exp_f32 v157, v157
  v_perm_b32 v125, v155, v154, s15
  v_exp_f32 v158, v158
  v_exp_f32 v159, v159
  v_perm_b32 v126, v157, v156, s15
  v_exp_f32 v160, v160
  v_exp_f32 v161, v161
  v_perm_b32 v127, v159, v158, s15
  v_mfma_f32_32x32x16_bf16 v[76:91], v[204:207], v[136:139], v[76:91]
  v_exp_f32 v162, v162
  v_exp_f32 v163, v163
  v_perm_b32 v128, v161, v160, s15
  v_exp_f32 v164, v164
  v_exp_f32 v165, v165
  v_perm_b32 v129, v163, v162, s15
  v_mfma_f32_32x32x16_bf16 v[92:107], v[200:203], v[124:127], v[92:107]
  s_waitcnt lgkmcnt(0)
  v_exp_f32 v166, v166
  v_exp_f32_e64 v167, v167
  v_perm_b32 v130, v165, v164, s15
  v_exp_f32 v168, v168
  v_exp_f32 v169, v169
  v_perm_b32 v131, v167, v166, s15
  v_exp_f32 v170, v170
  v_exp_f32 v171, v171
  v_perm_b32 v132, v169, v168, s15
  v_mfma_f32_32x32x16_bf16 v[152:167], v[184:187], v[40:43], 0
  s_xor_b32 s86, s57, 7
  s_lshl_b32 s86, s86, 13
  s_add_u32 s86, s86, s2
  s_add_u32 m0, s92, 58240
  v_exp_f32 v172, v172
  v_exp_f32_e64 v173, v173
  v_perm_b32 v133, v171, v170, s15
  v_exp_f32 v174, v174
  v_exp_f32 v175, v175
  v_perm_b32 v134, v173, v172, s15
  v_exp_f32 v176, v176
  v_exp_f32 v177, v177
  v_perm_b32 v135, v175, v174, s15
  v_mfma_f32_32x32x16_bf16 v[92:107], v[204:207], v[128:131], v[92:107]
  buffer_load_dwordx4 v4, s[52:55], s86 offen sc1 lds
  buffer_load_dwordx4 v4, s[52:55], s86 offen offset:1024 sc1 lds
  v_exp_f32 v178, v178
  v_exp_f32 v179, v179
  v_perm_b32 v136, v177, v176, s15
  v_exp_f32 v180, v180
  v_exp_f32 v181, v181
  v_perm_b32 v137, v179, v178, s15
  v_mfma_f32_32x32x16_bf16 v[108:123], v[200:203], v[132:135], v[108:123]
  v_exp_f32 v182, v182
  v_exp_f32 v183, v183
  v_perm_b32 v138, v181, v180, s15
  v_exp_f32 v152, v152
  v_exp_f32 v153, v153
  v_perm_b32 v139, v183, v182, s15
  v_exp_f32 v154, v154
  v_exp_f32 v155, v155
  v_perm_b32 v124, v153, v152, s15
  v_mfma_f32_32x32x16_bf16 v[168:183], v[184:187], v[44:47], 0
  buffer_load_dwordx4 a[8:11], v23, s[28:31], s77 offen offset:0
  buffer_load_dwordx4 a[12:15], v23, s[28:31], s77 offen offset:64
  v_exp_f32 v156, v156
  v_exp_f32 v157, v157
  v_perm_b32 v125, v155, v154, s15
  v_exp_f32 v158, v158
  v_exp_f32 v159, v159
  v_perm_b32 v126, v157, v156, s15
  v_exp_f32 v160, v160
  v_exp_f32 v161, v161
  v_perm_b32 v127, v159, v158, s15
  v_mfma_f32_32x32x16_bf16 v[108:123], v[204:207], v[136:139], v[108:123]
  ds_read_b128 v[188:191], v11 offset:14560
  v_exp_f32 v162, v162
  v_exp_f32 v163, v163
  v_perm_b32 v128, v161, v160, s15
  v_exp_f32 v164, v164
  v_exp_f32 v165, v165
  v_perm_b32 v129, v163, v162, s15
  v_mfma_f32_32x32x16_bf16 v[60:75], v[192:195], v[124:127], v[60:75]
  v_exp_f32 v166, v166
  v_exp_f32 v167, v167
  v_perm_b32 v130, v165, v164, s15
  v_exp_f32 v168, v168
  v_exp_f32 v169, v169
  v_perm_b32 v131, v167, v166, s15
  v_exp_f32 v170, v170
  v_exp_f32 v171, v171
  v_perm_b32 v132, v169, v168, s15
  v_mfma_f32_32x32x16_bf16 v[152:167], v[184:187], v[48:51], 0
  s_add_u32 s86, s86, 4096
  s_add_u32 m0, s92, 62400
  v_exp_f32 v172, v172
  v_exp_f32 v173, v173
  v_perm_b32 v133, v171, v170, s15
  v_exp_f32 v174, v174
  v_exp_f32 v175, v175
  v_perm_b32 v134, v173, v172, s15
  v_exp_f32 v176, v176
  v_exp_f32 v177, v177
  v_perm_b32 v135, v175, v174, s15
  v_mfma_f32_32x32x16_bf16 v[60:75], v[196:199], v[128:131], v[60:75]
  ds_read_b128 v[200:203], v12 offset:14560
  ds_read_b128 v[204:207], v13 offset:14560
  v_exp_f32 v178, v178
  v_exp_f32 v179, v179
  v_perm_b32 v136, v177, v176, s15
  v_exp_f32 v180, v180
  v_exp_f32 v181, v181
  v_perm_b32 v137, v179, v178, s15
  v_mfma_f32_32x32x16_bf16 v[76:91], v[192:195], v[132:135], v[76:91]
  buffer_load_dwordx4 v4, s[52:55], s86 offen sc1 lds
  buffer_load_dwordx4 v4, s[52:55], s86 offen offset:1024 sc1 lds
  v_exp_f32 v182, v182
  v_exp_f32 v183, v183
  v_perm_b32 v138, v181, v180, s15
  v_exp_f32 v152, v152
  v_exp_f32 v153, v153
  v_perm_b32 v139, v183, v182, s15
  v_exp_f32 v154, v154
  v_exp_f32 v155, v155
  v_perm_b32 v124, v153, v152, s15
  v_mfma_f32_32x32x16_bf16 v[168:183], v[184:187], v[52:55], 0
  v_dot2c_f32_bf16 v140, v40, v40
  v_dot2c_f32_bf16 v141, v44, v44
  v_dot2c_f32_bf16 v142, v48, v48
  v_dot2c_f32_bf16 v143, v52, v52
  v_dot2c_f32_bf16 v140, v41, v41
  v_dot2c_f32_bf16 v141, v45, v45
  v_dot2c_f32_bf16 v142, v49, v49
  v_dot2c_f32_bf16 v143, v53, v53
  v_dot2c_f32_bf16 v140, v42, v42
  v_dot2c_f32_bf16 v141, v46, v46
  v_dot2c_f32_bf16 v142, v50, v50
  v_dot2c_f32_bf16 v143, v54, v54
  v_dot2c_f32_bf16 v140, v43, v43
  v_dot2c_f32_bf16 v141, v47, v47
  v_dot2c_f32_bf16 v142, v51, v51
  v_dot2c_f32_bf16 v143, v55, v55
  v_max_f32_dpp v57, v57, v57 quad_perm:[1,0,3,2] row_mask:0xf bank_mask:0xf
  s_nop 1
  v_max_f32_dpp v57, v57, v57 quad_perm:[2,3,0,1] row_mask:0xf bank_mask:0xf
  s_nop 1
  v_max_f32_dpp v57, v57, v57 row_half_mirror row_mask:0xf bank_mask:0xf
  v_max3_f32 v7, v140, v141, v142
  v_add_f32 v140, v140, v141
  v_max_f32 v7, v7, v143
  v_add_f32 v142, v142, v143
  v_mul_f32 v7, v7, v57
  v_add_f32 v140, v140, v142
  v_mul_f32 v140, v140, v57
  v_cmp_nge_f32 vcc, 0x454799ce, v7
  v_cmp_u_f32 s[70:71], v140, v140
  s_nop 0
  s_or_b64 s[42:43], vcc, s[70:71]
  s_or_b32 s65, s58, s56
  s_or_b32 s65, s65, s57
  s_cmp_eq_u32 s65, 0
  s_cbranch_scc1 L_rare_65
L_back_66:
  v_exp_f32 v156, v156
  v_exp_f32 v157, v157
  v_perm_b32 v125, v155, v154, s15
  v_exp_f32 v158, v158
  v_exp_f32 v159, v159
  v_perm_b32 v126, v157, v156, s15
  v_exp_f32 v160, v160
  v_exp_f32 v161, v161
  v_perm_b32 v127, v159, v158, s15
  v_mfma_f32_32x32x16_bf16 v[76:91], v[196:199], v[136:139], v[76:91]
  v_exp_f32 v162, v162
  v_exp_f32 v163, v163
  v_perm_b32 v128, v161, v160, s15
  v_exp_f32 v164, v164
  v_exp_f32 v165, v165
  v_perm_b32 v129, v163, v162, s15
  v_mfma_f32_32x32x16_bf16 v[92:107], v[192:195], v[124:127], v[92:107]
  s_waitcnt lgkmcnt(0)
  v_exp_f32 v166, v166
  v_exp_f32_e64 v167, v167
  v_perm_b32 v130, v165, v164, s15
  v_exp_f32 v168, v168
  v_exp_f32 v169, v169
  v_perm_b32 v131, v167, v166, s15
  v_exp_f32 v170, v170
  v_exp_f32 v171, v171
  v_perm_b32 v132, v169, v168, s15
  v_mfma_f32_32x32x16_bf16 v[152:167], v[188:191], v[40:43], 0
  s_getpc_b64 s[8:9]
L_pc2:
  s_lshl_b32 s10, s58, 10
  v_lshrrev_b32 v9, 3, v1
  v_lshlrev_b32 v9, 7, v9
  v_add_u32_e64 v9, s10, v9
  v_add_u32 v9, 8192, v9
  v_min_u32 v9, L_code_end-L_pc2-4, v9
  v_exp_f32 v172, v172
  v_exp_f32 v173, v173
  v_perm_b32 v133, v171, v170, s15
  v_exp_f32 v174, v174
  v_exp_f32 v175, v175
  v_perm_b32 v134, v173, v172, s15
  v_exp_f32 v176, v176
  v_exp_f32 v177, v177
  v_perm_b32 v135, v175, v174, s15
  v_mfma_f32_32x32x16_bf16 v[92:107], v[196:199], v[128:131], v[92:107]
  v_exp_f32 v178, v178
  v_exp_f32 v179, v179
  v_perm_b32 v136, v177, v176, s15
  v_exp_f32 v180, v180
  v_exp_f32 v181, v181
  v_perm_b32 v137, v179, v178, s15
  v_mfma_f32_32x32x16_bf16 v[108:123], v[192:195], v[132:135], v[108:123]
  v_exp_f32 v182, v182
  v_exp_f32 v183, v183
  v_perm_b32 v138, v181, v180, s15
  v_exp_f32 v152, v152
  v_exp_f32 v153, v153
  v_perm_b32 v139, v183, v182, s15
  v_exp_f32 v154, v154
  v_exp_f32 v155, v155
  v_perm_b32 v124, v153, v152, s15
  v_mfma_f32_32x32x16_bf16 v[168:183], v[188:191], v[44:47], 0
  s_waitcnt vmcnt(26)
  s_barrier
  buffer_load_dwordx4 a[72:75], v24, s[28:31], s77 offen offset:0
  buffer_load_dwordx4 a[76:79], v24, s[28:31], s77 offen offset:64
  v_exp_f32 v156, v156
  v_exp_f32 v157, v157
  v_perm_b32 v125, v155, v154, s15
  v_exp_f32 v158, v158
  v_exp_f32 v159, v159
  v_perm_b32 v126, v157, v156, s15
  v_exp_f32 v160, v160
  v_exp_f32 v161, v161
  v_perm_b32 v127, v159, v158, s15
  v_mfma_f32_32x32x16_bf16 v[108:123], v[196:199], v[136:139], v[108:123]
  ds_read_b128 v[184:187], v11 offset:16640
  v_exp_f32 v162, v162
  v_exp_f32 v163, v163
  v_perm_b32 v128, v161, v160, s15
  v_exp_f32 v164, v164
  v_exp_f32 v165, v165
  v_perm_b32 v129, v163, v162, s15
  v_mfma_f32_32x32x16_bf16 v[60:75], v[200:203], v[124:127], v[60:75]
  v_exp_f32 v166, v166
  v_exp_f32 v167, v167
  v_perm_b32 v130, v165, v164, s15
  v_exp_f32 v168, v168
  v_exp_f32 v169, v169
  v_perm_b32 v131, v167, v166, s15
  v_exp_f32 v170, v170
  v_exp_f32 v171, v171
  v_perm_b32 v132, v169, v168, s15
  v_mfma_f32_32x32x16_bf16 v[152:167], v[188:191], v[48:51], 0
  v_exp_f32 v172, v172
  v_exp_f32 v173, v173
  v_perm_b32 v133, v171, v170, s15
  v_exp_f32 v174, v174
  v_exp_f32 v175, v175
  v_perm_b32 v134, v173, v172, s15
  v_exp_f32 v176, v176
  v_exp_f32 v177, v177
  v_perm_b32 v135, v175, v174, s15
  v_mfma_f32_32x32x16_bf16 v[60:75], v[204:207], v[128:131], v[60:75]
  ds_read_b128 v[192:195], v12 offset:16640
  ds_read_b128 v[196:199], v13 offset:16640
  v_exp_f32 v178, v178
  v_exp_f32 v179, v179
  v_perm_b32 v136, v177, v176, s15
  v_exp_f32 v180, v180
  v_exp_f32 v181, v181
  v_perm_b32 v137, v179, v178, s15
  v_mfma_f32_32x32x16_bf16 v[76:91], v[200:203], v[132:135], v[76:91]
  v_exp_f32 v182, v182
  v_exp_f32 v183, v183
  v_perm_b32 v138, v181, v180, s15
  v_exp_f32 v152, v152
  v_exp_f32 v153, v153
  v_perm_b32 v139, v183, v182, s15
  v_exp_f32 v154, v154
  v_exp_f32 v155, v155
  v_perm_b32 v124, v153, v152, s15
  v_mfma_f32_32x32x16_bf16 v[168:183], v[188:191], v[52:55], 0
  s_add_u32 s90, s95, 0
  v_exp_f32 v156, v156
  v_exp_f32_e64 v157, v157
  v_perm_b32 v125, v155, v154, s15
  v_exp_f32 v158, v158
  v_exp_f32 v159, v159
  v_perm_b32 v126, v157, v156, s15
  v_exp_f32 v160, v160
  v_exp_f32 v161, v161
  v_perm_b32 v127, v159, v158, s15
  v_mfma_f32_32x32x16_bf16 v[76:91], v[204:207], v[136:139], v[76:91]
  buffer_load_dword v27, v10, s[24:27], s90 offen
  v_exp_f32 v162, v162
  v_exp_f32 v163, v163
  v_perm_b32 v128, v161, v160, s15
  v_exp_f32 v164, v164
  v_exp_f32 v165, v165
  v_perm_b32 v129, v163, v162, s15
  v_mfma_f32_32x32x16_bf16 v[92:107], v[200:203], v[124:127], v[92:107]
  s_waitcnt lgkmcnt(0)
  v_exp_f32 v166, v166
  v_exp_f32_e64 v167, v167
  v_perm_b32 v130, v165, v164, s15
  v_exp_f32 v168, v168
  v_exp_f32 v169, v169
  v_perm_b32 v131, v167, v166, s15
  v_exp_f32 v170, v170
  v_exp_f32 v171, v171
  v_perm_b32 v132, v169, v168, s15
  v_mfma_f32_32x32x16_bf16 v[152:167], v[184:187], v[40:43], 0
  buffer_load_dwordx2 v[208:209], v37, s[52:55], s84 offen offset:0 sc1
  buffer_load_dwordx2 v[210:211], v37, s[52:55], s84 offen offset:512 sc1
  v_exp_f32 v172, v172
  v_exp_f32 v173, v173
  v_perm_b32 v133, v171, v170, s15
  v_exp_f32 v174, v174
  v_exp_f32 v175, v175
  v_perm_b32 v134, v173, v172, s15
  v_exp_f32 v176, v176
  v_exp_f32 v177, v177
  v_perm_b32 v135, v175, v174, s15
  v_mfma_f32_32x32x16_bf16 v[92:107], v[204:207], v[128:131], v[92:107]
  v_exp_f32 v178, v178
  v_exp_f32 v179, v179
  v_perm_b32 v136, v177, v176, s15
  v_exp_f32 v180, v180
  v_exp_f32 v181, v181
  v_perm_b32 v137, v179, v178, s15
  v_mfma_f32_32x32x16_bf16 v[108:123], v[200:203], v[132:135], v[108:123]
  buffer_load_dwordx4 a[136:139], v25, s[28:31], s77 offen offset:0
  buffer_load_dwordx4 a[140:143], v25, s[28:31], s77 offen offset:64
  v_exp_f32 v182, v182
  v_exp_f32 v183, v183
  v_perm_b32 v138, v181, v180, s15
  v_exp_f32 v152, v152
  v_exp_f32 v153, v153
  v_perm_b32 v139, v183, v182, s15
  v_exp_f32 v154, v154
  v_exp_f32 v155, v155
  v_perm_b32 v124, v153, v152, s15
  v_mfma_f32_32x32x16_bf16 v[168:183], v[184:187], v[44:47], 0
  s_mul_i32 s12, s56, 4608
  s_add_u32 s12, s12, 99840
  v_exp_f32 v156, v156
  v_exp_f32 v157, v157
  v_perm_b32 v125, v155, v154, s15
  v_exp_f32 v158, v158
  v_exp_f32 v159, v159
  v_perm_b32 v126, v157, v156, s15
  v_exp_f32 v160, v160
  v_exp_f32 v161, v161
  v_perm_b32 v127, v159, v158, s15
  v_mfma_f32_32x32x16_bf16 v[108:123], v[204:207], v[136:139], v[108:123]
  ds_read_b128 v[188:191], v11 offset:18720
  v_exp_f32 v162, v162
  v_exp_f32 v163, v163
  v_perm_b32 v128, v161, v160, s15
  v_exp_f32 v164, v164
  v_exp_f32 v165, v165
  v_perm_b32 v129, v163, v162, s15
  v_mfma_f32_32x32x16_bf16 v[60:75], v[192:195], v[124:127], v[60:75]
  buffer_load_dwordx2 v[212:213], v37, s[52:55], s84 offen offset:1024 sc1
  buffer_load_dwordx2 v[214:215], v37, s[52:55], s84 offen offset:1536 sc1
  v_exp_f32 v166, v166
  v_exp_f32 v167, v167
  v_perm_b32 v130, v165, v164, s15
  v_exp_f32 v168, v168
  v_exp_f32 v169, v169
  v_perm_b32 v131, v167, v166, s15
  v_exp_f32 v170, v170
  v_exp_f32 v171, v171
  v_perm_b32 v132, v169, v168, s15
  v_mfma_f32_32x32x16_bf16 v[152:167], v[184:187], v[48:51], 0
  s_xor_b32 s13, s56, 1
  s_mul_i32 s13, s13, 4608
  v_exp_f32 v172, v172
  v_exp_f32_e64 v173, v173
  v_perm_b32 v133, v171, v170, s15
  v_exp_f32 v174, v174
  v_exp_f32 v175, v175
  v_perm_b32 v134, v173, v172, s15
  v_exp_f32 v176, v176
  v_exp_f32 v177, v177
  v_perm_b32 v135, v175, v174, s15
  v_mfma_f32_32x32x16_bf16 v[60:75], v[196:199], v[128:131], v[60:75]
  ds_read_b128 v[200:203], v12 offset:18720
  ds_read_b128 v[204:207], v13 offset:18720
  v_exp_f32 v178, v178
  v_exp_f32 v179, v179
  v_perm_b32 v136, v177, v176, s15
  v_exp_f32 v180, v180
  v_exp_f32 v181, v181
  v_perm_b32 v137, v179, v178, s15
  v_mfma_f32_32x32x16_bf16 v[76:91], v[192:195], v[132:135], v[76:91]
  v_exp_f32 v182, v182
  v_exp_f32 v183, v183
  v_perm_b32 v138, v181, v180, s15
  v_exp_f32 v152, v152
  v_exp_f32 v153, v153
  v_perm_b32 v139, v183, v182, s15
  v_exp_f32 v154, v154
  v_exp_f32 v155, v155
  v_perm_b32 v124, v153, v152, s15
  v_mfma_f32_32x32x16_bf16 v[168:183], v[184:187], v[52:55], 0
  s_add_u32 s13, s13, 99840
  v_add_u32_e64 v36, s12, v4
  v_lshl_add_u32 v39, v1, 2, s12
  v_add_u32_e64 v58, s13, v4
  v_lshl_add_u32 v59, v1, 2, s13
  v_exp_f32 v156, v156
  v_exp_f32 v157, v157
  v_perm_b32 v125, v155, v154, s15
  v_exp_f32 v158, v158
  v_exp_f32 v159, v159
  v_perm_b32 v126, v157, v156, s15
  v_exp_f32 v160, v160
  v_exp_f32 v161, v161
  v_perm_b32 v127, v159, v158, s15
  v_mfma_f32_32x32x16_bf16 v[76:91], v[196:199], v[136:139], v[76:91]
  buffer_load_dwordx2 v[216:217], v37, s[52:55], s84 offen offset:2048 sc1
  buffer_load_dwordx2 v[218:219], v37, s[52:55], s84 offen offset:2560 sc1
  v_exp_f32 v162, v162
  v_exp_f32 v163, v163
  v_perm_b32 v128, v161, v160, s15
  v_exp_f32 v164, v164
  v_exp_f32 v165, v165
  v_perm_b32 v129, v163, v162, s15
  v_mfma_f32_32x32x16_bf16 v[92:107], v[192:195], v[124:127], v[92:107]
  s_waitcnt lgkmcnt(0)
  v_exp_f32 v166, v166
  v_exp_f32_e64 v167, v167
  v_perm_b32 v130, v165, v164, s15
  v_exp_f32 v168, v168
  v_exp_f32 v169, v169
  v_perm_b32 v131, v167, v166, s15
  v_exp_f32 v170, v170
  v_exp_f32 v171, v171
  v_perm_b32 v132, v169, v168, s15
  v_mfma_f32_32x32x16_bf16 v[152:167], v[188:191], v[40:43], 0
  v_and_b32 v144, 1, v3
  v_lshlrev_b32 v144, 14, v144
  v_lshl_add_u32 v144, v2, 4, v144
  v_lshrrev_b32_e64 v7, 5, v1
  v_lshl_add_u32 v144, v7, 8, v144
  v_exp_f32 v172, v172
  v_exp_f32 v173, v173
  v_perm_b32 v133, v171, v170, s15
  v_exp_f32 v174, v174
  v_exp_f32 v175, v175
  v_perm_b32 v134, v173, v172, s15
  v_exp_f32 v176, v176
  v_exp_f32 v177, v177
  v_perm_b32 v135, v175, v174, s15
  v_mfma_f32_32x32x16_bf16 v[92:107], v[196:199], v[128:131], v[92:107]
  buffer_load_dwordx4 a[200:203], v26, s[28:31], s77 offen offset:0
  buffer_load_dwordx4 a[204:207], v26, s[28:31], s77 offen offset:64
  v_exp_f32 v178, v178
  v_exp_f32 v179, v179
  v_perm_b32 v136, v177, v176, s15
  v_exp_f32 v180, v180
  v_exp_f32 v181, v181
  v_perm_b32 v137, v179, v178, s15
  v_mfma_f32_32x32x16_bf16 v[108:123], v[192:195], v[132:135], v[108:123]
  v_exp_f32 v182, v182
  v_exp_f32 v183, v183
  v_perm_b32 v138, v181, v180, s15
  v_exp_f32 v152, v152
  v_exp_f32 v153, v153
  v_perm_b32 v139, v183, v182, s15
  v_exp_f32 v154, v154
  v_exp_f32 v155, v155
  v_perm_b32 v124, v153, v152, s15
  v_mfma_f32_32x32x16_bf16 v[168:183], v[188:191], v[44:47], 0
  s_lshr_b32 s12, s56, 1
  s_lshl_b32 s12, s12, 15
  v_exp_f32 v156, v156
  v_exp_f32 v157, v157
  v_perm_b32 v125, v155, v154, s15
  v_exp_f32 v158, v158
  v_exp_f32 v159, v159
  v_perm_b32 v126, v157, v156, s15
  v_exp_f32 v160, v160
  v_exp_f32 v161, v161
  v_perm_b32 v127, v159, v158, s15
  v_mfma_f32_32x32x16_bf16 v[108:123], v[196:199], v[136:139], v[108:123]
  ds_read_b128 v[184:187], v11 offset:20800
  v_exp_f32 v162, v162
  v_exp_f32 v163, v163
  v_perm_b32 v128, v161, v160, s15
  v_exp_f32 v164, v164
  v_exp_f32 v165, v165
  v_perm_b32 v129, v163, v162, s15
  v_mfma_f32_32x32x16_bf16 v[60:75], v[200:203], v[124:127], v[60:75]
  buffer_load_dwordx2 v[220:221], v37, s[52:55], s84 offen offset:3072 sc1
  buffer_load_dwordx2 v[222:223], v37, s[52:55], s84 offen offset:3584 sc1
  v_exp_f32 v166, v166
  v_exp_f32 v167, v167
  v_perm_b32 v130, v165, v164, s15
  v_exp_f32 v168, v168
  v_exp_f32 v169, v169
  v_perm_b32 v131, v167, v166, s15
  v_exp_f32 v170, v170
  v_exp_f32 v171, v171
  v_perm_b32 v132, v169, v168, s15
  v_mfma_f32_32x32x16_bf16 v[152:167], v[188:191], v[48:51], 0
  s_add_u32 s85, s3, s12
  s_lshl_b32 s12, s59, 11
  v_exp_f32 v172, v172
  v_exp_f32 v173, v173
  v_perm_b32 v133, v171, v170, s15
  v_exp_f32 v174, v174
  v_exp_f32 v175, v175
  v_perm_b32 v134, v173, v172, s15
  v_exp_f32 v176, v176
  v_exp_f32 v177, v177
  v_perm_b32 v135, v175, v174, s15
  v_mfma_f32_32x32x16_bf16 v[60:75], v[204:207], v[128:131], v[60:75]
  ds_read_b128 v[192:195], v12 offset:20800
  ds_read_b128 v[196:199], v13 offset:20800
  v_exp_f32 v178, v178
  v_exp_f32 v179, v179
  v_perm_b32 v136, v177, v176, s15
  v_exp_f32 v180, v180
  v_exp_f32 v181, v181
  v_perm_b32 v137, v179, v178, s15
  v_mfma_f32_32x32x16_bf16 v[76:91], v[200:203], v[132:135], v[76:91]
  v_exp_f32 v182, v182
  v_exp_f32 v183, v183
  v_perm_b32 v138, v181, v180, s15
  v_exp_f32 v152, v152
  v_exp_f32 v153, v153
  v_perm_b32 v139, v183, v182, s15
  v_exp_f32 v154, v154
  v_exp_f32 v155, v155
  v_perm_b32 v124, v153, v152, s15
  v_mfma_f32_32x32x16_bf16 v[168:183], v[188:191], v[52:55], 0
  s_add_u32 s85, s85, s12
  s_and_b32 s12, s56, 1
  v_exp_f32 v156, v156
  v_exp_f32 v157, v157
  v_perm_b32 v125, v155, v154, s15
  v_exp_f32 v158, v158
  v_exp_f32 v159, v159
  v_perm_b32 v126, v157, v156, s15
  v_exp_f32 v160, v160
  v_exp_f32 v161, v161
  v_perm_b32 v127, v159, v158, s15
  v_mfma_f32_32x32x16_bf16 v[76:91], v[204:207], v[136:139], v[76:91]
  buffer_load_dwordx4 a[16:19], v23, s[28:31], s78 offen offset:0
  buffer_load_dwordx4 a[20:23], v23, s[28:31], s78 offen offset:64
  v_exp_f32 v162, v162
  v_exp_f32 v163, v163
  v_perm_b32 v128, v161, v160, s15
  v_exp_f32 v164, v164
  v_exp_f32 v165, v165
  v_perm_b32 v129, v163, v162, s15
  v_mfma_f32_32x32x16_bf16 v[92:107], v[200:203], v[124:127], v[92:107]
  s_waitcnt lgkmcnt(0)
  v_exp_f32 v166, v166
  v_exp_f32_e64 v167, v167
  v_perm_b32 v130, v165, v164, s15
  v_exp_f32 v168, v168
  v_exp_f32 v169, v169
  v_perm_b32 v131, v167, v166, s15
  v_exp_f32 v170, v170
  v_exp_f32 v171, v171
  v_perm_b32 v132, v169, v168, s15
  v_mfma_f32_32x32x16_bf16 v[152:167], v[184:187], v[40:43], 0
  s_lshl_b32 s12, s12, 10
  s_add_u32 s85, s85, s12
  v_exp_f32 v172, v172
  v_exp_f32 v173, v173
  v_perm_b32 v133, v171, v170, s15
  v_exp_f32 v174, v174
  v_exp_f32 v175, v175
  v_perm_b32 v134, v173, v172, s15
  v_exp_f32 v176, v176
  v_exp_f32 v177, v177
  v_perm_b32 v135, v175, v174, s15
  v_mfma_f32_32x32x16_bf16 v[92:107], v[204:207], v[128:131], v[92:107]
  buffer_load_dwordx2 v[28:29], v14, s[4:7], s74 offen offset:0
  buffer_load_dwordx2 v[30:31], v14, s[4:7], s74 offen offset:32
  v_exp_f32 v178, v178
  v_exp_f32 v179, v179
  v_perm_b32 v136, v177, v176, s15
  v_exp_f32 v180, v180
  v_exp_f32 v181, v181
  v_perm_b32 v137, v179, v178, s15
  v_mfma_f32_32x32x16_bf16 v[108:123], v[200:203], v[132:135], v[108:123]
  v_exp_f32 v182, v182
  v_exp_f32 v183, v183
  v_perm_b32 v138, v181, v180, s15
  v_exp_f32 v152, v152
  v_exp_f32 v153, v153
  v_perm_b32 v139, v183, v182, s15
  v_exp_f32 v154, v154
  v_exp_f32 v155, v155
  v_perm_b32 v124, v153, v152, s15
  v_mfma_f32_32x32x16_bf16 v[168:183], v[184:187], v[44:47], 0
  s_add_u32 s85, s85, 0
  s_lshl_b32 s19, s56, 14
  v_exp_f32 v156, v156
  v_exp_f32 v157, v157
  v_perm_b32 v125, v155, v154, s15
  v_exp_f32 v158, v158
  v_exp_f32 v159, v159
  v_perm_b32 v126, v157, v156, s15
  v_exp_f32 v160, v160
  v_exp_f32 v161, v161
  v_perm_b32 v127, v159, v158, s15
  v_mfma_f32_32x32x16_bf16 v[108:123], v[204:207], v[136:139], v[108:123]
  ds_read_b128 v[188:191], v11 offset:22880
  v_exp_f32 v162, v162
  v_exp_f32 v163, v163
  v_perm_b32 v128, v161, v160, s15
  v_exp_f32 v164, v164
  v_exp_f32 v165, v165
  v_perm_b32 v129, v163, v162, s15
  v_mfma_f32_32x32x16_bf16 v[60:75], v[192:195], v[124:127], v[60:75]
  global_load_dword v27, v9, s[8:9]
  v_exp_f32 v166, v166
  v_exp_f32 v167, v167
  v_perm_b32 v130, v165, v164, s15
  v_exp_f32 v168, v168
  v_exp_f32 v169, v169
  v_perm_b32 v131, v167, v166, s15
  v_exp_f32 v170, v170
  v_exp_f32 v171, v171
  v_perm_b32 v132, v169, v168, s15
  v_mfma_f32_32x32x16_bf16 v[152:167], v[184:187], v[48:51], 0
  s_add_u32 s19, s19, s3
  v_exp_f32 v172, v172
  v_exp_f32_e64 v173, v173
  v_perm_b32 v133, v171, v170, s15
  v_exp_f32 v174, v174
  v_exp_f32 v175, v175
  v_perm_b32 v134, v173, v172, s15
  v_exp_f32 v176, v176
  v_exp_f32 v177, v177
  v_perm_b32 v135, v175, v174, s15
  v_mfma_f32_32x32x16_bf16 v[60:75], v[196:199], v[128:131], v[60:75]
  ds_read_b128 v[200:203], v12 offset:22880
  ds_read_b128 v[204:207], v13 offset:22880
  v_exp_f32 v178, v178
  v_exp_f32 v179, v179
  v_perm_b32 v136, v177, v176, s15
  v_exp_f32 v180, v180
  v_exp_f32 v181, v181
  v_perm_b32 v137, v179, v178, s15
  v_mfma_f32_32x32x16_bf16 v[76:91], v[192:195], v[132:135], v[76:91]
  s_add_u32 s90, s95, 262144
  v_exp_f32 v182, v182
  v_exp_f32 v183, v183
  v_perm_b32 v138, v181, v180, s15
  v_exp_f32 v152, v152
  v_exp_f32 v153, v153
  v_perm_b32 v139, v183, v182, s15
  v_exp_f32 v154, v154
  v_exp_f32 v155, v155
  v_perm_b32 v124, v153, v152, s15
  v_mfma_f32_32x32x16_bf16 v[168:183], v[184:187], v[52:55], 0
  buffer_load_dword v27, v10, s[24:27], s90 offen
  v_exp_f32 v156, v156
  v_exp_f32 v157, v157
  v_perm_b32 v125, v155, v154, s15
  v_exp_f32 v158, v158
  v_exp_f32 v159, v159
  v_perm_b32 v126, v157, v156, s15
  v_exp_f32 v160, v160
  v_exp_f32 v161, v161
  v_perm_b32 v127, v159, v158, s15
  v_mfma_f32_32x32x16_bf16 v[76:91], v[196:199], v[136:139], v[76:91]
  v_exp_f32 v162, v162
  v_exp_f32 v163, v163
  v_perm_b32 v128, v161, v160, s15
  v_exp_f32 v164, v164
  v_exp_f32 v165, v165
  v_perm_b32 v129, v163, v162, s15
  v_mfma_f32_32x32x16_bf16 v[92:107], v[192:195], v[124:127], v[92:107]
  s_waitcnt lgkmcnt(0)
  v_exp_f32 v166, v166
  v_exp_f32_e64 v167, v167
  v_perm_b32 v130, v165, v164, s15
  v_exp_f32 v168, v168
  v_exp_f32 v169, v169
  v_perm_b32 v131, v167, v166, s15
  v_exp_f32 v170, v170
  v_exp_f32 v171, v171
  v_perm_b32 v132, v169, v168, s15
  v_mfma_f32_32x32x16_bf16 v[152:167], v[188:191], v[40:43], 0
  buffer_load_dwordx2 v[32:33], v14, s[4:7], s74 offen offset:64
  buffer_load_dwordx2 v[34:35], v14, s[4:7], s74 offen offset:96
  v_exp_f32 v172, v172
  v_exp_f32 v173, v173
  v_perm_b32 v133, v171, v170, s15
  v_exp_f32 v174, v174
  v_exp_f32 v175, v175
  v_perm_b32 v134, v173, v172, s15
  v_exp_f32 v176, v176
  v_exp_f32 v177, v177
  v_perm_b32 v135, v175, v174, s15
  v_mfma_f32_32x32x16_bf16 v[92:107], v[196:199], v[128:131], v[92:107]
  v_exp_f32 v178, v178
  v_exp_f32 v179, v179
  v_perm_b32 v136, v177, v176, s15
  v_exp_f32 v180, v180
  v_exp_f32 v181, v181
  v_perm_b32 v137, v179, v178, s15
  v_mfma_f32_32x32x16_bf16 v[108:123], v[192:195], v[132:135], v[108:123]
  buffer_load_ushort v15, v15, s[32:35], s68 offen
  v_exp_f32 v182, v182
  v_exp_f32 v183, v183
  v_perm_b32 v138, v181, v180, s15
  v_exp_f32 v152, v152
  v_exp_f32 v153, v153
  v_perm_b32 v139, v183, v182, s15
  v_exp_f32 v154, v154
  v_exp_f32 v155, v155
  v_perm_b32 v124, v153, v152, s15
  v_mfma_f32_32x32x16_bf16 v[168:183], v[188:191], v[44:47], 0
  v_exp_f32 v156, v156
  v_exp_f32 v157, v157
  v_perm_b32 v125, v155, v154, s15
  v_exp_f32 v158, v158
  v_exp_f32 v159, v159
  v_perm_b32 v126, v157, v156, s15
  v_exp_f32 v160, v160
  v_exp_f32 v161, v161
  v_perm_b32 v127, v159, v158, s15
  v_mfma_f32_32x32x16_bf16 v[108:123], v[196:199], v[136:139], v[108:123]
  ds_read_b128 v[184:187], v11 offset:24960
  v_exp_f32 v162, v162
  v_exp_f32 v163, v163
  v_perm_b32 v128, v161, v160, s15
  v_exp_f32 v164, v164
  v_exp_f32 v165, v165
  v_perm_b32 v129, v163, v162, s15
  v_mfma_f32_32x32x16_bf16 v[60:75], v[200:203], v[124:127], v[60:75]
  buffer_load_dwordx4 a[80:83], v24, s[28:31], s78 offen offset:0
  buffer_load_dwordx4 a[84:87], v24, s[28:31], s78 offen offset:64
  v_exp_f32 v166, v166
  v_exp_f32 v167, v167
  v_perm_b32 v130, v165, v164, s15
  v_exp_f32 v168, v168
  v_exp_f32 v169, v169
  v_perm_b32 v131, v167, v166, s15
  v_exp_f32 v170, v170
  v_exp_f32 v171, v171
  v_perm_b32 v132, v169, v168, s15
  v_mfma_f32_32x32x16_bf16 v[152:167], v[188:191], v[48:51], 0
  v_exp_f32 v172, v172
  v_exp_f32 v173, v173
  v_perm_b32 v133, v171, v170, s15
  v_exp_f32 v174, v174
  v_exp_f32 v175, v175
  v_perm_b32 v134, v173, v172, s15
  v_exp_f32 v176, v176
  v_exp_f32 v177, v177
  v_perm_b32 v135, v175, v174, s15
  v_mfma_f32_32x32x16_bf16 v[60:75], v[204:207], v[128:131], v[60:75]
  ds_read_b128 v[192:195], v12 offset:24960
  ds_read_b128 v[196:199], v13 offset:24960
  v_exp_f32 v178, v178
  v_exp_f32 v179, v179
  v_perm_b32 v136, v177, v176, s15
  v_exp_f32 v180, v180
  v_exp_f32 v181, v181
  v_perm_b32 v137, v179, v178, s15
  v_mfma_f32_32x32x16_bf16 v[76:91], v[200:203], v[132:135], v[76:91]
  v_exp_f32 v182, v182
  v_exp_f32 v183, v183
  v_perm_b32 v138, v181, v180, s15
  v_exp_f32 v152, v152
  v_exp_f32 v153, v153
  v_perm_b32 v139, v183, v182, s15
  v_exp_f32 v154, v154
  v_exp_f32 v155, v155
  v_perm_b32 v124, v153, v152, s15
  v_mfma_f32_32x32x16_bf16 v[168:183], v[188:191], v[52:55], 0
  buffer_load_dwordx4 a[144:147], v25, s[28:31], s78 offen offset:0
  buffer_load_dwordx4 a[148:151], v25, s[28:31], s78 offen offset:64
  v_exp_f32 v156, v156
  v_exp_f32 v157, v157
  v_perm_b32 v125, v155, v154, s15
  v_exp_f32 v158, v158
  v_exp_f32 v159, v159
  v_perm_b32 v126, v157, v156, s15
  v_exp_f32 v160, v160
  v_exp_f32 v161, v161
  v_perm_b32 v127, v159, v158, s15
  v_mfma_f32_32x32x16_bf16 v[76:91], v[204:207], v[136:139], v[76:91]
  v_exp_f32 v162, v162
  v_exp_f32 v163, v163
  v_perm_b32 v128, v161, v160, s15
  v_exp_f32 v164, v164
  v_exp_f32 v165, v165
  v_perm_b32 v129, v163, v162, s15
  v_mfma_f32_32x32x16_bf16 v[92:107], v[200:203], v[124:127], v[92:107]
  s_waitcnt lgkmcnt(0)
  v_exp_f32 v166, v166
  v_exp_f32_e64 v167, v167
  v_perm_b32 v130, v165, v164, s15
  v_exp_f32 v168, v168
  v_exp_f32 v169, v169
  v_perm_b32 v131, v167, v166, s15
  v_exp_f32 v170, v170
  v_exp_f32 v171, v171
  v_perm_b32 v132, v169, v168, s15
  v_mfma_f32_32x32x16_bf16 v[152:167], v[184:187], v[40:43], 0
  v_exp_f32 v172, v172
  v_exp_f32 v173, v173
  v_perm_b32 v133, v171, v170, s15
  v_exp_f32 v174, v174
  v_exp_f32 v175, v175
  v_perm_b32 v134, v173, v172, s15
  v_exp_f32 v176, v176
  v_exp_f32 v177, v177
  v_perm_b32 v135, v175, v174, s15
  v_mfma_f32_32x32x16_bf16 v[92:107], v[204:207], v[128:131], v[92:107]
  v_exp_f32 v178, v178
  v_exp_f32 v179, v179
  v_perm_b32 v136, v177, v176, s15
  v_exp_f32 v180, v180
  v_exp_f32 v181, v181
  v_perm_b32 v137, v179, v178, s15
  v_mfma_f32_32x32x16_bf16 v[108:123], v[200:203], v[132:135], v[108:123]
  v_exp_f32 v182, v182
  v_exp_f32 v183, v183
  v_perm_b32 v138, v181, v180, s15
  v_exp_f32 v152, v152
  v_exp_f32 v153, v153
  v_perm_b32 v139, v183, v182, s15
  v_exp_f32 v154, v154
  v_exp_f32 v155, v155
  v_perm_b32 v124, v153, v152, s15
  v_mfma_f32_32x32x16_bf16 v[168:183], v[184:187], v[44:47], 0
  v_exp_f32 v156, v156
  v_exp_f32 v157, v157
  v_perm_b32 v125, v155, v154, s15
  v_exp_f32 v158, v158
  v_exp_f32 v159, v159
  v_perm_b32 v126, v157, v156, s15
  v_exp_f32 v160, v160
  v_exp_f32 v161, v161
  v_perm_b32 v127, v159, v158, s15
  v_mfma_f32_32x32x16_bf16 v[108:123], v[204:207], v[136:139], v[108:123]
  ds_read_b128 v[188:191], v11 offset:27040
  v_exp_f32 v162, v162
  v_exp_f32 v163, v163
  v_perm_b32 v128, v161, v160, s15
  v_exp_f32 v164, v164
  v_exp_f32 v165, v165
  v_perm_b32 v129, v163, v162, s15
  v_mfma_f32_32x32x16_bf16 v[60:75], v[192:195], v[124:127], v[60:75]
  v_exp_f32 v166, v166
  v_exp_f32 v167, v167
  v_perm_b32 v130, v165, v164, s15
  v_exp_f32 v168, v168
  v_exp_f32 v169, v169
  v_perm_b32 v131, v167, v166, s15
  v_exp_f32 v170, v170
  v_exp_f32 v171, v171
  v_perm_b32 v132, v169, v168, s15
  v_mfma_f32_32x32x16_bf16 v[152:167], v[184:187], v[48:51], 0
  buffer_load_dwordx4 a[208:211], v26, s[28:31], s78 offen offset:0
  buffer_load_dwordx4 a[212:215], v26, s[28:31], s78 offen offset:64
  v_exp_f32 v172, v172
  v_exp_f32 v173, v173
  v_perm_b32 v133, v171, v170, s15
  v_exp_f32 v174, v174
  v_exp_f32 v175, v175
  v_perm_b32 v134, v173, v172, s15
  v_exp_f32 v176, v176
  v_exp_f32 v177, v177
  v_perm_b32 v135, v175, v174, s15
  v_mfma_f32_32x32x16_bf16 v[60:75], v[196:199], v[128:131], v[60:75]
  ds_read_b128 v[200:203], v12 offset:27040
  ds_read_b128 v[204:207], v13 offset:27040
  v_exp_f32 v178, v178
  v_exp_f32 v179, v179
  v_perm_b32 v136, v177, v176, s15
  v_exp_f32 v180, v180
  v_exp_f32 v181, v181
  v_perm_b32 v137, v179, v178, s15
  v_mfma_f32_32x32x16_bf16 v[76:91], v[192:195], v[132:135], v[76:91]
  v_exp_f32 v182, v182
  v_exp_f32 v183, v183
  v_perm_b32 v138, v181, v180, s15
  v_exp_f32 v152, v152
  v_exp_f32 v153, v153
  v_perm_b32 v139, v183, v182, s15
  v_exp_f32 v154, v154
  v_exp_f32 v155, v155
  v_perm_b32 v124, v153, v152, s15
  v_mfma_f32_32x32x16_bf16 v[168:183], v[184:187], v[52:55], 0
  s_add_u32 s90, s95, 524288
  v_exp_f32 v156, v156
  v_exp_f32 v157, v157
  v_perm_b32 v125, v155, v154, s15
  v_exp_f32 v158, v158
  v_exp_f32 v159, v159
  v_perm_b32 v126, v157, v156, s15
  v_exp_f32 v160, v160
  v_exp_f32 v161, v161
  v_perm_b32 v127, v159, v158, s15
  v_mfma_f32_32x32x16_bf16 v[76:91], v[196:199], v[136:139], v[76:91]
  buffer_load_dword v27, v10, s[24:27], s90 offen
  v_exp_f32 v162, v162
  v_exp_f32 v163, v163
  v_perm_b32 v128, v161, v160, s15
  v_exp_f32 v164, v164
  v_exp_f32 v165, v165
  v_perm_b32 v129, v163, v162, s15
  v_mfma_f32_32x32x16_bf16 v[92:107], v[192:195], v[124:127], v[92:107]
  s_waitcnt lgkmcnt(0)
  v_exp_f32 v166, v166
  v_exp_f32_e64 v167, v167
  v_perm_b32 v130, v165, v164, s15
  v_exp_f32 v168, v168
  v_exp_f32 v169, v169
  v_perm_b32 v131, v167, v166, s15
  v_exp_f32 v170, v170
  v_exp_f32 v171, v171
  v_perm_b32 v132, v169, v168, s15
  v_mfma_f32_32x32x16_bf16 v[152:167], v[188:191], v[40:43], 0
  v_exp_f32 v172, v172
  v_exp_f32 v173, v173
  v_perm_b32 v133, v171, v170, s15
  v_exp_f32 v174, v174
  v_exp_f32 v175, v175
  v_perm_b32 v134, v173, v172, s15
  v_exp_f32 v176, v176
  v_exp_f32 v177, v177
  v_perm_b32 v135, v175, v174, s15
  v_mfma_f32_32x32x16_bf16 v[92:107], v[196:199], v[128:131], v[92:107]
  v_exp_f32 v178, v178
  v_exp_f32 v179, v179
  v_perm_b32 v136, v177, v176, s15
  v_exp_f32 v180, v180
  v_exp_f32 v181, v181
  v_perm_b32 v137, v179, v178, s15
  v_mfma_f32_32x32x16_bf16 v[108:123], v[192:195], v[132:135], v[108:123]
  v_exp_f32 v182, v182
  v_exp_f32 v183, v183
  v_perm_b32 v138, v181, v180, s15
  v_exp_f32 v152, v152
  v_exp_f32 v153, v153
  v_perm_b32 v139, v183, v182, s15
  v_exp_f32 v154, v154
  v_exp_f32 v155, v155
  v_perm_b32 v124, v153, v152, s15
  v_mfma_f32_32x32x16_bf16 v[168:183], v[188:191], v[44:47], 0
  v_exp_f32 v156, v156
  v_exp_f32 v157, v157
  v_perm_b32 v125, v155, v154, s15
  v_exp_f32 v158, v158
  v_exp_f32 v159, v159
  v_perm_b32 v126, v157, v156, s15
  v_exp_f32 v160, v160
  v_exp_f32 v161, v161
  v_perm_b32 v127, v159, v158, s15
  v_mfma_f32_32x32x16_bf16 v[108:123], v[196:199], v[136:139], v[108:123]
  ds_read_b128 v[184:187], v11 offset:29120
  v_exp_f32 v162, v162
  v_exp_f32 v163, v163
  v_perm_b32 v128, v161, v160, s15
  v_exp_f32 v164, v164
  v_exp_f32 v165, v165
  v_perm_b32 v129, v163, v162, s15
  v_mfma_f32_32x32x16_bf16 v[60:75], v[200:203], v[124:127], v[60:75]
  v_exp_f32 v166, v166
  v_exp_f32 v167, v167
  v_perm_b32 v130, v165, v164, s15
  v_exp_f32 v168, v168
  v_exp_f32 v169, v169
  v_perm_b32 v131, v167, v166, s15
  v_exp_f32 v170, v170
  v_exp_f32 v171, v171
  v_perm_b32 v132, v169, v168, s15
  v_mfma_f32_32x32x16_bf16 v[152:167], v[188:191], v[48:51], 0
  buffer_load_dwordx4 a[24:27], v23, s[28:31], s79 offen offset:0
  buffer_load_dwordx4 a[28:31], v23, s[28:31], s79 offen offset:64
  v_exp_f32 v172, v172
  v_exp_f32 v173, v173
  v_perm_b32 v133, v171, v170, s15
  v_exp_f32 v174, v174
  v_exp_f32 v175, v175
  v_perm_b32 v134, v173, v172, s15
  v_exp_f32 v176, v176
  v_exp_f32 v177, v177
  v_perm_b32 v135, v175, v174, s15
  v_mfma_f32_32x32x16_bf16 v[60:75], v[204:207], v[128:131], v[60:75]
  ds_read_b128 v[192:195], v12 offset:29120
  ds_read_b128 v[196:199], v13 offset:29120
  v_exp_f32 v178, v178
  v_exp_f32 v179, v179
  v_perm_b32 v136, v177, v176, s15
  v_exp_f32 v180, v180
  v_exp_f32 v181, v181
  v_perm_b32 v137, v179, v178, s15
  v_mfma_f32_32x32x16_bf16 v[76:91], v[200:203], v[132:135], v[76:91]
  v_exp_f32 v182, v182
  v_exp_f32 v183, v183
  v_perm_b32 v138, v181, v180, s15
  v_exp_f32 v152, v152
  v_exp_f32 v153, v153
  v_perm_b32 v139, v183, v182, s15
  v_exp_f32 v154, v154
  v_exp_f32 v155, v155
  v_perm_b32 v124, v153, v152, s15
  v_mfma_f32_32x32x16_bf16 v[168:183], v[188:191], v[52:55], 0
  v_exp_f32 v156, v156
  v_exp_f32 v157, v157
  v_perm_b32 v125, v155, v154, s15
  v_exp_f32 v158, v158
  v_exp_f32 v159, v159
  v_perm_b32 v126, v157, v156, s15
  v_exp_f32 v160, v160
  v_exp_f32 v161, v161
  v_perm_b32 v127, v159, v158, s15
  v_mfma_f32_32x32x16_bf16 v[76:91], v[204:207], v[136:139], v[76:91]
  v_exp_f32 v162, v162
  v_exp_f32 v163, v163
  v_perm_b32 v128, v161, v160, s15
  v_exp_f32 v164, v164
  v_exp_f32 v165, v165
  v_perm_b32 v129, v163, v162, s15
  v_mfma_f32_32x32x16_bf16 v[92:107], v[200:203], v[124:127], v[92:107]
  s_waitcnt lgkmcnt(0)
  v_exp_f32 v166, v166
  v_exp_f32_e64 v167, v167
  v_perm_b32 v130, v165, v164, s15
  v_exp_f32 v168, v168
  v_exp_f32 v169, v169
  v_perm_b32 v131, v167, v166, s15
  v_exp_f32 v170, v170
  v_exp_f32 v171, v171
  v_perm_b32 v132, v169, v168, s15
  v_mfma_f32_32x32x16_bf16 v[152:167], v[184:187], v[40:43], 0
  v_exp_f32 v172, v172
  v_exp_f32 v173, v173
  v_perm_b32 v133, v171, v170, s15
  v_exp_f32 v174, v174
  v_exp_f32 v175, v175
  v_perm_b32 v134, v173, v172, s15
  v_exp_f32 v176, v176
  v_exp_f32 v177, v177
  v_perm_b32 v135, v175, v174, s15
  v_mfma_f32_32x32x16_bf16 v[92:107], v[204:207], v[128:131], v[92:107]
  v_exp_f32 v178, v178
  v_exp_f32 v179, v179
  v_perm_b32 v136, v177, v176, s15
  v_exp_f32 v180, v180
  v_exp_f32 v181, v181
  v_perm_b32 v137, v179, v178, s15
  v_mfma_f32_32x32x16_bf16 v[108:123], v[200:203], v[132:135], v[108:123]
  v_exp_f32 v182, v182
  v_exp_f32 v183, v183
  v_perm_b32 v138, v181, v180, s15
  v_exp_f32 v152, v152
  v_exp_f32 v153, v153
  v_perm_b32 v139, v183, v182, s15
  v_exp_f32 v154, v154
  v_exp_f32 v155, v155
  v_perm_b32 v124, v153, v152, s15
  v_mfma_f32_32x32x16_bf16 v[168:183], v[184:187], v[44:47], 0
  buffer_load_dwordx4 a[88:91], v24, s[28:31], s79 offen offset:0
  buffer_load_dwordx4 a[92:95], v24, s[28:31], s79 offen offset:64
  v_exp_f32 v156, v156
  v_exp_f32 v157, v157
  v_perm_b32 v125, v155, v154, s15
  v_exp_f32 v158, v158
  v_exp_f32 v159, v159
  v_perm_b32 v126, v157, v156, s15
  v_exp_f32 v160, v160
  v_exp_f32 v161, v161
  v_perm_b32 v127, v159, v158, s15
  v_mfma_f32_32x32x16_bf16 v[108:123], v[204:207], v[136:139], v[108:123]
  ds_read_b128 v[188:191], v11 offset:31200
  v_exp_f32 v162, v162
  v_exp_f32 v163, v163
  v_perm_b32 v128, v161, v160, s15
  v_exp_f32 v164, v164
  v_exp_f32 v165, v165
  v_perm_b32 v129, v163, v162, s15
  v_mfma_f32_32x32x16_bf16 v[60:75], v[192:195], v[124:127], v[60:75]
  v_exp_f32 v166, v166
  v_exp_f32 v167, v167
  v_perm_b32 v130, v165, v164, s15
  v_exp_f32 v168, v168
  v_exp_f32 v169, v169
  v_perm_b32 v131, v167, v166, s15
  v_exp_f32 v170, v170
  v_exp_f32 v171, v171
  v_perm_b32 v132, v169, v168, s15
  v_mfma_f32_32x32x16_bf16 v[152:167], v[184:187], v[48:51], 0
  v_exp_f32 v172, v172
  v_exp_f32 v173, v173
  v_perm_b32 v133, v171, v170, s15
  v_exp_f32 v174, v174
  v_exp_f32 v175, v175
  v_perm_b32 v134, v173, v172, s15
  v_exp_f32 v176, v176
  v_exp_f32 v177, v177
  v_perm_b32 v135, v175, v174, s15
  v_mfma_f32_32x32x16_bf16 v[60:75], v[196:199], v[128:131], v[60:75]
  ds_read_b128 v[200:203], v12 offset:31200
  ds_read_b128 v[204:207], v13 offset:31200
  v_exp_f32 v178, v178
  v_exp_f32 v179, v179
  v_perm_b32 v136, v177, v176, s15
  v_exp_f32 v180, v180
  v_exp_f32 v181, v181
  v_perm_b32 v137, v179, v178, s15
  v_mfma_f32_32x32x16_bf16 v[76:91], v[192:195], v[132:135], v[76:91]
  v_exp_f32 v182, v182
  v_exp_f32 v183, v183
  v_perm_b32 v138, v181, v180, s15
  v_exp_f32 v152, v152
  v_exp_f32 v153, v153
  v_perm_b32 v139, v183, v182, s15
  v_exp_f32 v154, v154
  v_exp_f32 v155, v155
  v_perm_b32 v124, v153, v152, s15
  v_mfma_f32_32x32x16_bf16 v[168:183], v[184:187], v[52:55], 0
  v_exp_f32 v156, v156
  v_exp_f32 v157, v157
  v_perm_b32 v125, v155, v154, s15
  v_exp_f32 v158, v158
  v_exp_f32 v159, v159
  v_perm_b32 v126, v157, v156, s15
  v_exp_f32 v160, v160
  v_exp_f32 v161, v161
  v_perm_b32 v127, v159, v158, s15
  v_mfma_f32_32x32x16_bf16 v[76:91], v[196:199], v[136:139], v[76:91]
  v_exp_f32 v162, v162
  v_exp_f32 v163, v163
  v_perm_b32 v128, v161, v160, s15
  v_exp_f32 v164, v164
  v_exp_f32 v165, v165
  v_perm_b32 v129, v163, v162, s15
  v_mfma_f32_32x32x16_bf16 v[92:107], v[192:195], v[124:127], v[92:107]
  s_waitcnt lgkmcnt(0)
  v_exp_f32 v166, v166
  v_exp_f32_e64 v167, v167
  v_perm_b32 v130, v165, v164, s15
  v_exp_f32 v168, v168
  v_exp_f32 v169, v169
  v_perm_b32 v131, v167, v166, s15
  v_exp_f32 v170, v170
  v_exp_f32 v171, v171
  v_perm_b32 v132, v169, v168, s15
  v_mfma_f32_32x32x16_bf16 v[152:167], v[188:191], v[40:43], 0
  v_exp_f32 v172, v172
  v_exp_f32 v173, v173
  v_perm_b32 v133, v171, v170, s15
  v_exp_f32 v174, v174
  v_exp_f32 v175, v175
  v_perm_b32 v134, v173, v172, s15
  v_exp_f32 v176, v176
  v_exp_f32 v177, v177
  v_perm_b32 v135, v175, v174, s15
  v_mfma_f32_32x32x16_bf16 v[92:107], v[196:199], v[128:131], v[92:107]
  v_exp_f32 v178, v178
  v_exp_f32 v179, v179
  v_perm_b32 v136, v177, v176, s15
  v_exp_f32 v180, v180
  v_exp_f32 v181, v181
  v_perm_b32 v137, v179, v178, s15
  v_mfma_f32_32x32x16_bf16 v[108:123], v[192:195], v[132:135], v[108:123]
  v_exp_f32 v182, v182
  v_exp_f32 v183, v183
  v_perm_b32 v138, v181, v180, s15
  v_exp_f32 v152, v152
  v_exp_f32 v153, v153
  v_perm_b32 v139, v183, v182, s15
  v_exp_f32 v154, v154
  v_exp_f32 v155, v155
  v_perm_b32 v124, v153, v152, s15
  v_mfma_f32_32x32x16_bf16 v[168:183], v[188:191], v[44:47], 0
  s_waitcnt vmcnt(35)
  s_barrier
  s_add_u32 s90, s95, 786432
  v_exp_f32 v156, v156
  v_exp_f32 v157, v157
  v_perm_b32 v125, v155, v154, s15
  v_exp_f32 v158, v158
  v_exp_f32 v159, v159
  v_perm_b32 v126, v157, v156, s15
  v_exp_f32 v160, v160
  v_exp_f32 v161, v161
  v_perm_b32 v127, v159, v158, s15
  v_mfma_f32_32x32x16_bf16 v[108:123], v[196:199], v[136:139], v[108:123]
  ds_read_b128 v[184:187], v11 offset:33280
  v_exp_f32 v162, v162
  v_exp_f32 v163, v163
  v_perm_b32 v128, v161, v160, s15
  v_exp_f32 v164, v164
  v_exp_f32 v165, v165
  v_perm_b32 v129, v163, v162, s15
  v_mfma_f32_32x32x16_bf16 v[60:75], v[200:203], v[124:127], v[60:75]
  buffer_load_dword v27, v10, s[24:27], s90 offen
  v_exp_f32 v166, v166
  v_exp_f32 v167, v167
  v_perm_b32 v130, v165, v164, s15
  v_exp_f32 v168, v168
  v_exp_f32 v169, v169
  v_perm_b32 v131, v167, v166, s15
  v_exp_f32 v170, v170
  v_exp_f32 v171, v171
  v_perm_b32 v132, v169, v168, s15
  v_mfma_f32_32x32x16_bf16 v[152:167], v[188:191], v[48:51], 0
  v_exp_f32 v172, v172
  v_exp_f32 v173, v173
  v_perm_b32 v133, v171, v170, s15
  v_exp_f32 v174, v174
  v_exp_f32 v175, v175
  v_perm_b32 v134, v173, v172, s15
  v_exp_f32 v176, v176
  v_exp_f32 v177, v177
  v_perm_b32 v135, v175, v174, s15
  v_mfma_f32_32x32x16_bf16 v[60:75], v[204:207], v[128:131], v[60:75]
  ds_read_b128 v[192:195], v12 offset:33280
  ds_read_b128 v[196:199], v13 offset:33280
  v_exp_f32 v178, v178
  v_exp_f32 v179, v179
  v_perm_b32 v136, v177, v176, s15
  v_exp_f32 v180, v180
  v_exp_f32 v181, v181
  v_perm_b32 v137, v179, v178, s15
  v_mfma_f32_32x32x16_bf16 v[76:91], v[200:203], v[132:135], v[76:91]
  buffer_load_dwordx4 a[152:155], v25, s[28:31], s79 offen offset:0
  buffer_load_dwordx4 a[156:159], v25, s[28:31], s79 offen offset:64
  v_exp_f32 v182, v182
  v_exp_f32 v183, v183
  v_perm_b32 v138, v181, v180, s15
  v_exp_f32 v152, v152
  v_exp_f32 v153, v153
  v_perm_b32 v139, v183, v182, s15
  v_exp_f32 v154, v154
  v_exp_f32 v155, v155
  v_perm_b32 v124, v153, v152, s15
  v_mfma_f32_32x32x16_bf16 v[168:183], v[188:191], v[52:55], 0
  s_add_u32 m0, s94, 0
  s_add_u32 s65, s91, 0
  v_exp_f32 v156, v156
  v_exp_f32 v157, v157
  v_perm_b32 v125, v155, v154, s15
  v_exp_f32 v158, v158
  v_exp_f32 v159, v159
  v_perm_b32 v126, v157, v156, s15
  v_exp_f32 v160, v160
  v_exp_f32 v161, v161
  v_perm_b32 v127, v159, v158, s15
  v_mfma_f32_32x32x16_bf16 v[76:91], v[204:207], v[136:139], v[76:91]
  buffer_load_dwordx4 v5, s[20:23], s65 offen  lds
  v_exp_f32 v162, v162
  v_exp_f32 v163, v163
  v_perm_b32 v128, v161, v160, s15
  v_exp_f32 v164, v164
  v_exp_f32 v165, v165
  v_perm_b32 v129, v163, v162, s15
  v_mfma_f32_32x32x16_bf16 v[92:107], v[200:203], v[124:127], v[92:107]
  s_waitcnt lgkmcnt(0)
  v_exp_f32 v166, v166
  v_exp_f32_e64 v167, v167
  v_perm_b32 v130, v165, v164, s15
  v_exp_f32 v168, v168
  v_exp_f32 v169, v169
  v_perm_b32 v131, v167, v166, s15
  v_exp_f32 v170, v170
  v_exp_f32 v171, v171
  v_perm_b32 v132, v169, v168, s15
  v_mfma_f32_32x32x16_bf16 v[152:167], v[184:187], v[40:43], 0
  v_exp_f32 v172, v172
  v_exp_f32 v173, v173
  v_perm_b32 v133, v171, v170, s15
  v_exp_f32 v174, v174
  v_exp_f32 v175, v175
  v_perm_b32 v134, v173, v172, s15
  v_exp_f32 v176, v176
  v_exp_f32 v177, v177
  v_perm_b32 v135, v175, v174, s15
  v_mfma_f32_32x32x16_bf16 v[92:107], v[204:207], v[128:131], v[92:107]
  v_exp_f32 v178, v178
  v_exp_f32 v179, v179
  v_perm_b32 v136, v177, v176, s15
  v_exp_f32 v180, v180
  v_exp_f32 v181, v181
  v_perm_b32 v137, v179, v178, s15
  v_mfma_f32_32x32x16_bf16 v[108:123], v[200:203], v[132:135], v[108:123]
  v_exp_f32 v182, v182
  v_exp_f32 v183, v183
  v_perm_b32 v138, v181, v180, s15
  v_exp_f32 v152, v152
  v_exp_f32 v153, v153
  v_perm_b32 v139, v183, v182, s15
  v_exp_f32 v154, v154
  v_exp_f32 v155, v155
  v_perm_b32 v124, v153, v152, s15
  v_mfma_f32_32x32x16_bf16 v[168:183], v[184:187], v[44:47], 0
  s_add_u32 m0, s94, 1024
  s_add_u32 s65, s91, 8192
  v_exp_f32 v156, v156
  v_exp_f32 v157, v157
  v_perm_b32 v125, v155, v154, s15
  v_exp_f32 v158, v158
  v_exp_f32 v159, v159
  v_perm_b32 v126, v157, v156, s15
  v_exp_f32 v160, v160
  v_exp_f32 v161, v161
  v_perm_b32 v127, v159, v158, s15
  v_mfma_f32_32x32x16_bf16 v[108:123], v[204:207], v[136:139], v[108:123]
  ds_read_b128 v[188:191], v11 offset:35360
  v_exp_f32 v162, v162
  v_exp_f32 v163, v163
  v_perm_b32 v128, v161, v160, s15
  v_exp_f32 v164, v164
  v_exp_f32 v165, v165
  v_perm_b32 v129, v163, v162, s15
  v_mfma_f32_32x32x16_bf16 v[60:75], v[192:195], v[124:127], v[60:75]
  buffer_load_dwordx4 v5, s[20:23], s65 offen  lds
  v_exp_f32 v166, v166
  v_exp_f32 v167, v167
  v_perm_b32 v130, v165, v164, s15
  v_exp_f32 v168, v168
  v_exp_f32 v169, v169
  v_perm_b32 v131, v167, v166, s15
  v_exp_f32 v170, v170
  v_exp_f32 v171, v171
  v_perm_b32 v132, v169, v168, s15
  v_mfma_f32_32x32x16_bf16 v[152:167], v[184:187], v[48:51], 0
  v_exp_f32 v172, v172
  v_exp_f32 v173, v173
  v_perm_b32 v133, v171, v170, s15
  v_exp_f32 v174, v174
  v_exp_f32 v175, v175
  v_perm_b32 v134, v173, v172, s15
  v_exp_f32 v176, v176
  v_exp_f32 v177, v177
  v_perm_b32 v135, v175, v174, s15
  v_mfma_f32_32x32x16_bf16 v[60:75], v[196:199], v[128:131], v[60:75]
  ds_read_b128 v[200:203], v12 offset:35360
  ds_read_b128 v[204:207], v13 offset:35360
  v_exp_f32 v178, v178
  v_exp_f32 v179, v179
  v_perm_b32 v136, v177, v176, s15
  v_exp_f32 v180, v180
  v_exp_f32 v181, v181
  v_perm_b32 v137, v179, v178, s15
  v_mfma_f32_32x32x16_bf16 v[76:91], v[192:195], v[132:135], v[76:91]
  buffer_load_dwordx4 a[216:219], v26, s[28:31], s79 offen offset:0
  buffer_load_dwordx4 a[220:223], v26, s[28:31], s79 offen offset:64
  v_exp_f32 v182, v182
  v_exp_f32 v183, v183
  v_perm_b32 v138, v181, v180, s15
  v_exp_f32 v152, v152
  v_exp_f32 v153, v153
  v_perm_b32 v139, v183, v182, s15
  v_exp_f32 v154, v154
  v_exp_f32 v155, v155
  v_perm_b32 v124, v153, v152, s15
  v_mfma_f32_32x32x16_bf16 v[168:183], v[184:187], v[52:55], 0
  s_add_u32 m0, s94, 2048
  s_add_u32 s65, s91, 16384
  v_exp_f32 v156, v156
  v_exp_f32 v157, v157
  v_perm_b32 v125, v155, v154, s15
  v_exp_f32 v158, v158
  v_exp_f32 v159, v159
  v_perm_b32 v126, v157, v156, s15
  v_exp_f32 v160, v160
  v_exp_f32 v161, v161
  v_perm_b32 v127, v159, v158, s15
  v_mfma_f32_32x32x16_bf16 v[76:91], v[196:199], v[136:139], v[76:91]
  buffer_load_dwordx4 v5, s[20:23], s65 offen  lds
  v_exp_f32 v162, v162
  v_exp_f32 v163, v163
  v_perm_b32 v128, v161, v160, s15
  v_exp_f32 v164, v164
  v_exp_f32 v165, v165
  v_perm_b32 v129, v163, v162, s15
  v_mfma_f32_32x32x16_bf16 v[92:107], v[192:195], v[124:127], v[92:107]
  s_waitcnt lgkmcnt(0)
  v_exp_f32 v166, v166
  v_exp_f32_e64 v167, v167
  v_perm_b32 v130, v165, v164, s15
  v_exp_f32 v168, v168
  v_exp_f32 v169, v169
  v_perm_b32 v131, v167, v166, s15
  v_exp_f32 v170, v170
  v_exp_f32 v171, v171
  v_perm_b32 v132, v169, v168, s15
  v_mfma_f32_32x32x16_bf16 v[152:167], v[188:191], v[40:43], 0
  buffer_load_dwordx4 a[32:35], v23, s[28:31], s80 offen offset:0
  buffer_load_dwordx4 a[36:39], v23, s[28:31], s80 offen offset:64
  v_exp_f32 v172, v172
  v_exp_f32 v173, v173
  v_perm_b32 v133, v171, v170, s15
  v_exp_f32 v174, v174
  v_exp_f32 v175, v175
  v_perm_b32 v134, v173, v172, s15
  v_exp_f32 v176, v176
  v_exp_f32 v177, v177
  v_perm_b32 v135, v175, v174, s15
  v_mfma_f32_32x32x16_bf16 v[92:107], v[196:199], v[128:131], v[92:107]
  v_exp_f32 v178, v178
  v_exp_f32 v179, v179
  v_perm_b32 v136, v177, v176, s15
  v_exp_f32 v180, v180
  v_exp_f32 v181, v181
  v_perm_b32 v137, v179, v178, s15
  v_mfma_f32_32x32x16_bf16 v[108:123], v[192:195], v[132:135], v[108:123]
  v_exp_f32 v182, v182
  v_exp_f32 v183, v183
  v_perm_b32 v138, v181, v180, s15
  v_exp_f32 v152, v152
  v_exp_f32 v153, v153
  v_perm_b32 v139, v183, v182, s15
  v_exp_f32 v154, v154
  v_exp_f32 v155, v155
  v_perm_b32 v124, v153, v152, s15
  v_mfma_f32_32x32x16_bf16 v[168:183], v[188:191], v[44:47], 0
  v_exp_f32 v156, v156
  v_exp_f32 v157, v157
  v_perm_b32 v125, v155, v154, s15
  v_exp_f32 v158, v158
  v_exp_f32 v159, v159
  v_perm_b32 v126, v157, v156, s15
  v_exp_f32 v160, v160
  v_exp_f32 v161, v161
  v_perm_b32 v127, v159, v158, s15
  v_mfma_f32_32x32x16_bf16 v[108:123], v[196:199], v[136:139], v[108:123]
  ds_read_b128 v[184:187], v11 offset:37440
  v_exp_f32 v162, v162
  v_exp_f32 v163, v163
  v_perm_b32 v128, v161, v160, s15
  v_exp_f32 v164, v164
  v_exp_f32 v165, v165
  v_perm_b32 v129, v163, v162, s15
  v_mfma_f32_32x32x16_bf16 v[60:75], v[200:203], v[124:127], v[60:75]
  v_exp_f32 v166, v166
  v_exp_f32 v167, v167
  v_perm_b32 v130, v165, v164, s15
  v_exp_f32 v168, v168
  v_exp_f32 v169, v169
  v_perm_b32 v131, v167, v166, s15
  v_exp_f32 v170, v170
  v_exp_f32 v171, v171
  v_perm_b32 v132, v169, v168, s15
  v_mfma_f32_32x32x16_bf16 v[152:167], v[188:191], v[48:51], 0
  s_add_u32 m0, s94, 3072
  s_add_u32 s65, s91, 24576
  v_exp_f32 v172, v172
  v_exp_f32 v173, v173
  v_perm_b32 v133, v171, v170, s15
  v_exp_f32 v174, v174
  v_exp_f32 v175, v175
  v_perm_b32 v134, v173, v172, s15
  v_exp_f32 v176, v176
  v_exp_f32 v177, v177
  v_perm_b32 v135, v175, v174, s15
  v_mfma_f32_32x32x16_bf16 v[60:75], v[204:207], v[128:131], v[60:75]
  ds_read_b128 v[192:195], v12 offset:37440
  ds_read_b128 v[196:199], v13 offset:37440
  v_exp_f32 v178, v178
  v_exp_f32 v179, v179
  v_perm_b32 v136, v177, v176, s15
  v_exp_f32 v180, v180
  v_exp_f32 v181, v181
  v_perm_b32 v137, v179, v178, s15
  v_mfma_f32_32x32x16_bf16 v[76:91], v[200:203], v[132:135], v[76:91]
  buffer_load_dwordx4 v5, s[20:23], s65 offen  lds
  v_exp_f32 v182, v182
  v_exp_f32 v183, v183
  v_perm_b32 v138, v181, v180, s15
  v_exp_f32 v152, v152
  v_exp_f32 v153, v153
  v_perm_b32 v139, v183, v182, s15
  v_exp_f32 v154, v154
  v_exp_f32 v155, v155
  v_perm_b32 v124, v153, v152, s15
  v_mfma_f32_32x32x16_bf16 v[168:183], v[188:191], v[52:55], 0
  s_add_u32 s90, s95, 1048576
  v_exp_f32 v156, v156
  v_exp_f32 v157, v157
  v_perm_b32 v125, v155, v154, s15
  v_exp_f32 v158, v158
  v_exp_f32 v159, v159
  v_perm_b32 v126, v157, v156, s15
  v_exp_f32 v160, v160
  v_exp_f32 v161, v161
  v_perm_b32 v127, v159, v158, s15
  v_mfma_f32_32x32x16_bf16 v[76:91], v[204:207], v[136:139], v[76:91]
  buffer_load_dword v27, v10, s[24:27], s90 offen
  v_exp_f32 v162, v162
  v_exp_f32 v163, v163
  v_perm_b32 v128, v161, v160, s15
  v_exp_f32 v164, v164
  v_exp_f32 v165, v165
  v_perm_b32 v129, v163, v162, s15
  v_mfma_f32_32x32x16_bf16 v[92:107], v[200:203], v[124:127], v[92:107]
  s_waitcnt lgkmcnt(0)
  v_exp_f32 v166, v166
  v_exp_f32_e64 v167, v167
  v_perm_b32 v130, v165, v164, s15
  v_exp_f32 v168, v168
  v_exp_f32 v169, v169
  v_perm_b32 v131, v167, v166, s15
  v_exp_f32 v170, v170
  v_exp_f32 v171, v171
  v_perm_b32 v132, v169, v168, s15
  v_mfma_f32_32x32x16_bf16 v[152:167], v[184:187], v[40:43], 0
  s_add_u32 m0, s94, 4096
  s_add_u32 s65, s91, 32768
  v_exp_f32 v172, v172
  v_exp_f32 v173, v173
  v_perm_b32 v133, v171, v170, s15
  v_exp_f32 v174, v174
  v_exp_f32 v175, v175
  v_perm_b32 v134, v173, v172, s15
  v_exp_f32 v176, v176
  v_exp_f32 v177, v177
  v_perm_b32 v135, v175, v174, s15
  v_mfma_f32_32x32x16_bf16 v[92:107], v[204:207], v[128:131], v[92:107]
  buffer_load_dwordx4 v5, s[20:23], s65 offen  lds
  v_exp_f32 v178, v178
  v_exp_f32 v179, v179
  v_perm_b32 v136, v177, v176, s15
  v_exp_f32 v180, v180
  v_exp_f32 v181, v181
  v_perm_b32 v137, v179, v178, s15
  v_mfma_f32_32x32x16_bf16 v[108:123], v[200:203], v[132:135], v[108:123]
  v_exp_f32 v182, v182
  v_exp_f32 v183, v183
  v_perm_b32 v138, v181, v180, s15
  v_exp_f32 v152, v152
  v_exp_f32 v153, v153
  v_perm_b32 v139, v183, v182, s15
  v_exp_f32 v154, v154
  v_exp_f32 v155, v155
  v_perm_b32 v124, v153, v152, s15
  v_mfma_f32_32x32x16_bf16 v[168:183], v[184:187], v[44:47], 0
  buffer_load_dwordx4 a[96:99], v24, s[28:31], s80 offen offset:0
  buffer_load_dwordx4 a[100:103], v24, s[28:31], s80 offen offset:64
  v_exp_f32 v156, v156
  v_exp_f32 v157, v157
  v_perm_b32 v125, v155, v154, s15
  v_exp_f32 v158, v158
  v_exp_f32 v159, v159
  v_perm_b32 v126, v157, v156, s15
  v_exp_f32 v160, v160
  v_exp_f32 v161, v161
  v_perm_b32 v127, v159, v158, s15
  v_mfma_f32_32x32x16_bf16 v[108:123], v[204:207], v[136:139], v[108:123]
  ds_read_b128 v[188:191], v11 offset:39520
  v_exp_f32 v162, v162
  v_exp_f32 v163, v163
  v_perm_b32 v128, v161, v160, s15
  v_exp_f32 v164, v164
  v_exp_f32 v165, v165
  v_perm_b32 v129, v163, v162, s15
  v_mfma_f32_32x32x16_bf16 v[60:75], v[192:195], v[124:127], v[60:75]
  v_exp_f32 v166, v166
  v_exp_f32 v167, v167
  v_perm_b32 v130, v165, v164, s15
  v_exp_f32 v168, v168
  v_exp_f32 v169, v169
  v_perm_b32 v131, v167, v166, s15
  v_exp_f32 v170, v170
  v_exp_f32 v171, v171
  v_perm_b32 v132, v169, v168, s15
  v_mfma_f32_32x32x16_bf16 v[152:167], v[184:187], v[48:51], 0
  v_exp_f32 v172, v172
  v_exp_f32 v173, v173
  v_perm_b32 v133, v171, v170, s15
  v_exp_f32 v174, v174
  v_exp_f32 v175, v175
  v_perm_b32 v134, v173, v172, s15
  v_exp_f32 v176, v176
  v_exp_f32 v177, v177
  v_perm_b32 v135, v175, v174, s15
  v_mfma_f32_32x32x16_bf16 v[60:75], v[196:199], v[128:131], v[60:75]
  ds_read_b128 v[200:203], v12 offset:39520
  ds_read_b128 v[204:207], v13 offset:39520
  v_exp_f32 v178, v178
  v_exp_f32 v179, v179
  v_perm_b32 v136, v177, v176, s15
  v_exp_f32 v180, v180
  v_exp_f32 v181, v181
  v_perm_b32 v137, v179, v178, s15
  v_mfma_f32_32x32x16_bf16 v[76:91], v[192:195], v[132:135], v[76:91]
  v_exp_f32 v182, v182
  v_exp_f32 v183, v183
  v_perm_b32 v138, v181, v180, s15
  v_exp_f32 v152, v152
  v_exp_f32 v153, v153
  v_perm_b32 v139, v183, v182, s15
  v_exp_f32 v154, v154
  v_exp_f32 v155, v155
  v_perm_b32 v124, v153, v152, s15
  v_mfma_f32_32x32x16_bf16 v[168:183], v[184:187], v[52:55], 0
  s_add_u32 m0, s94, 5120
  s_add_u32 s65, s91, 40960
  v_exp_f32 v156, v156
  v_exp_f32 v157, v157
  v_perm_b32 v125, v155, v154, s15
  v_exp_f32 v158, v158
  v_exp_f32 v159, v159
  v_perm_b32 v126, v157, v156, s15
  v_exp_f32 v160, v160
  v_exp_f32 v161, v161
  v_perm_b32 v127, v159, v158, s15
  v_mfma_f32_32x32x16_bf16 v[76:91], v[196:199], v[136:139], v[76:91]
  buffer_load_dwordx4 v5, s[20:23], s65 offen  lds
  v_exp_f32 v162, v162
  v_exp_f32 v163, v163
  v_perm_b32 v128, v161, v160, s15
  v_exp_f32 v164, v164
  v_exp_f32 v165, v165
  v_perm_b32 v129, v163, v162, s15
  v_mfma_f32_32x32x16_bf16 v[92:107], v[192:195], v[124:127], v[92:107]
  s_waitcnt lgkmcnt(0)
  v_exp_f32 v166, v166
  v_exp_f32_e64 v167, v167
  v_perm_b32 v130, v165, v164, s15
  v_exp_f32 v168, v168
  v_exp_f32 v169, v169
  v_perm_b32 v131, v167, v166, s15
  v_exp_f32 v170, v170
  v_exp_f32 v171, v171
  v_perm_b32 v132, v169, v168, s15
  v_mfma_f32_32x32x16_bf16 v[152:167], v[188:191], v[40:43], 0
  buffer_load_dwordx4 a[160:163], v25, s[28:31], s80 offen offset:0
  buffer_load_dwordx4 a[164:167], v25, s[28:31], s80 offen offset:64
  v_exp_f32 v172, v172
  v_exp_f32 v173, v173
  v_perm_b32 v133, v171, v170, s15
  v_exp_f32 v174, v174
  v_exp_f32 v175, v175
  v_perm_b32 v134, v173, v172, s15
  v_exp_f32 v176, v176
  v_exp_f32 v177, v177
  v_perm_b32 v135, v175, v174, s15
  v_mfma_f32_32x32x16_bf16 v[92:107], v[196:199], v[128:131], v[92:107]
  v_exp_f32 v178, v178
  v_exp_f32 v179, v179
  v_perm_b32 v136, v177, v176, s15
  v_exp_f32 v180, v180
  v_exp_f32 v181, v181
  v_perm_b32 v137, v179, v178, s15
  v_mfma_f32_32x32x16_bf16 v[108:123], v[192:195], v[132:135], v[108:123]
  v_exp_f32 v182, v182
  v_exp_f32 v183, v183
  v_perm_b32 v138, v181, v180, s15
  v_exp_f32 v152, v152
  v_exp_f32 v153, v153
  v_perm_b32 v139, v183, v182, s15
  v_exp_f32 v154, v154
  v_exp_f32 v155, v155
  v_perm_b32 v124, v153, v152, s15
  v_mfma_f32_32x32x16_bf16 v[168:183], v[188:191], v[44:47], 0
  s_add_u32 m0, s94, 6144
  s_add_u32 s65, s91, 49152
  v_exp_f32 v156, v156
  v_exp_f32 v157, v157
  v_perm_b32 v125, v155, v154, s15
  v_exp_f32 v158, v158
  v_exp_f32 v159, v159
  v_perm_b32 v126, v157, v156, s15
  v_exp_f32 v160, v160
  v_exp_f32 v161, v161
  v_perm_b32 v127, v159, v158, s15
  v_mfma_f32_32x32x16_bf16 v[108:123], v[196:199], v[136:139], v[108:123]
  ds_read_b128 v[184:187], v11 offset:41600
  v_exp_f32 v162, v162
  v_exp_f32 v163, v163
  v_perm_b32 v128, v161, v160, s15
  v_exp_f32 v164, v164
  v_exp_f32 v165, v165
  v_perm_b32 v129, v163, v162, s15
  v_mfma_f32_32x32x16_bf16 v[60:75], v[200:203], v[124:127], v[60:75]
  buffer_load_dwordx4 v5, s[20:23], s65 offen  lds
  v_exp_f32 v166, v166
  v_exp_f32 v167, v167
  v_perm_b32 v130, v165, v164, s15
  v_exp_f32 v168, v168
  v_exp_f32 v169, v169
  v_perm_b32 v131, v167, v166, s15
  v_exp_f32 v170, v170
  v_exp_f32 v171, v171
  v_perm_b32 v132, v169, v168, s15
  v_mfma_f32_32x32x16_bf16 v[152:167], v[188:191], v[48:51], 0
  v_exp_f32 v172, v172
  v_exp_f32 v173, v173
  v_perm_b32 v133, v171, v170, s15
  v_exp_f32 v174, v174
  v_exp_f32 v175, v175
  v_perm_b32 v134, v173, v172, s15
  v_exp_f32 v176, v176
  v_exp_f32 v177, v177
  v_perm_b32 v135, v175, v174, s15
  v_mfma_f32_32x32x16_bf16 v[60:75], v[204:207], v[128:131], v[60:75]
  ds_read_b128 v[192:195], v12 offset:41600
  ds_read_b128 v[196:199], v13 offset:41600
  v_exp_f32 v178, v178
  v_exp_f32 v179, v179
  v_perm_b32 v136, v177, v176, s15
  v_exp_f32 v180, v180
  v_exp_f32 v181, v181
  v_perm_b32 v137, v179, v178, s15
  v_mfma_f32_32x32x16_bf16 v[76:91], v[200:203], v[132:135], v[76:91]
  v_exp_f32 v182, v182
  v_exp_f32 v183, v183
  v_perm_b32 v138, v181, v180, s15
  v_exp_f32 v152, v152
  v_exp_f32 v153, v153
  v_perm_b32 v139, v183, v182, s15
  v_exp_f32 v154, v154
  v_exp_f32 v155, v155
  v_perm_b32 v124, v153, v152, s15
  v_mfma_f32_32x32x16_bf16 v[168:183], v[188:191], v[52:55], 0
  buffer_load_dwordx4 a[224:227], v26, s[28:31], s80 offen offset:0
  buffer_load_dwordx4 a[228:231], v26, s[28:31], s80 offen offset:64
  v_exp_f32 v156, v156
  v_exp_f32 v157, v157
  v_perm_b32 v125, v155, v154, s15
  v_exp_f32 v158, v158
  v_exp_f32 v159, v159
  v_perm_b32 v126, v157, v156, s15
  v_exp_f32 v160, v160
  v_exp_f32 v161, v161
  v_perm_b32 v127, v159, v158, s15
  v_mfma_f32_32x32x16_bf16 v[76:91], v[204:207], v[136:139], v[76:91]
  v_exp_f32 v162, v162
  v_exp_f32 v163, v163
  v_perm_b32 v128, v161, v160, s15
  v_exp_f32 v164, v164
  v_exp_f32 v165, v165
  v_perm_b32 v129, v163, v162, s15
  v_mfma_f32_32x32x16_bf16 v[92:107], v[200:203], v[124:127], v[92:107]
  s_waitcnt lgkmcnt(0)
  v_exp_f32 v166, v166
  v_exp_f32_e64 v167, v167
  v_perm_b32 v130, v165, v164, s15
  v_exp_f32 v168, v168
  v_exp_f32 v169, v169
  v_perm_b32 v131, v167, v166, s15
  v_exp_f32 v170, v170
  v_exp_f32 v171, v171
  v_perm_b32 v132, v169, v168, s15
  v_mfma_f32_32x32x16_bf16 v[152:167], v[184:187], v[40:43], 0
  s_add_u32 m0, s94, 7168
  s_add_u32 s65, s91, 57344
  v_exp_f32 v172, v172
  v_exp_f32 v173, v173
  v_perm_b32 v133, v171, v170, s15
  v_exp_f32 v174, v174
  v_exp_f32 v175, v175
  v_perm_b32 v134, v173, v172, s15
  v_exp_f32 v176, v176
  v_exp_f32 v177, v177
  v_perm_b32 v135, v175, v174, s15
  v_mfma_f32_32x32x16_bf16 v[92:107], v[204:207], v[128:131], v[92:107]
  buffer_load_dwordx4 v5, s[20:23], s65 offen  lds
  v_exp_f32 v178, v178
  v_exp_f32 v179, v179
  v_perm_b32 v136, v177, v176, s15
  v_exp_f32 v180, v180
  v_exp_f32 v181, v181
  v_perm_b32 v137, v179, v178, s15
  v_mfma_f32_32x32x16_bf16 v[108:123], v[200:203], v[132:135], v[108:123]
  v_exp_f32 v182, v182
  v_exp_f32 v183, v183
  v_perm_b32 v138, v181, v180, s15
  v_exp_f32 v152, v152
  v_exp_f32 v153, v153
  v_perm_b32 v139, v183, v182, s15
  v_exp_f32 v154, v154
  v_exp_f32 v155, v155
  v_perm_b32 v124, v153, v152, s15
  v_mfma_f32_32x32x16_bf16 v[168:183], v[184:187], v[44:47], 0
  s_add_u32 s90, s95, 1310720
  v_exp_f32 v156, v156
  v_exp_f32 v157, v157
  v_perm_b32 v125, v155, v154, s15
  v_exp_f32 v158, v158
  v_exp_f32 v159, v159
  v_perm_b32 v126, v157, v156, s15
  v_exp_f32 v160, v160
  v_exp_f32 v161, v161
  v_perm_b32 v127, v159, v158, s15
  v_mfma_f32_32x32x16_bf16 v[108:123], v[204:207], v[136:139], v[108:123]
  ds_read_b128 v[188:191], v11 offset:43680
  v_exp_f32 v162, v162
  v_exp_f32 v163, v163
  v_perm_b32 v128, v161, v160, s15
  v_exp_f32 v164, v164
  v_exp_f32 v165, v165
  v_perm_b32 v129, v163, v162, s15
  v_mfma_f32_32x32x16_bf16 v[60:75], v[192:195], v[124:127], v[60:75]
  buffer_load_dword v27, v10, s[24:27], s90 offen
  v_exp_f32 v166, v166
  v_exp_f32 v167, v167
  v_perm_b32 v130, v165, v164, s15
  v_exp_f32 v168, v168
  v_exp_f32 v169, v169
  v_perm_b32 v131, v167, v166, s15
  v_exp_f32 v170, v170
  v_exp_f32 v171, v171
  v_perm_b32 v132, v169, v168, s15
  v_mfma_f32_32x32x16_bf16 v[152:167], v[184:187], v[48:51], 0
  s_add_u32 m0, s94, 66560
  s_add_u32 s65, s91, 262144
  v_exp_f32 v172, v172
  v_exp_f32 v173, v173
  v_perm_b32 v133, v171, v170, s15
  v_exp_f32 v174, v174
  v_exp_f32 v175, v175
  v_perm_b32 v134, v173, v172, s15
  v_exp_f32 v176, v176
  v_exp_f32 v177, v177
  v_perm_b32 v135, v175, v174, s15
  v_mfma_f32_32x32x16_bf16 v[60:75], v[196:199], v[128:131], v[60:75]
  ds_read_b128 v[200:203], v12 offset:43680
  ds_read_b128 v[204:207], v13 offset:43680
  v_exp_f32 v178, v178
  v_exp_f32 v179, v179
  v_perm_b32 v136, v177, v176, s15
  v_exp_f32 v180, v180
  v_exp_f32 v181, v181
  v_perm_b32 v137, v179, v178, s15
  v_mfma_f32_32x32x16_bf16 v[76:91], v[192:195], v[132:135], v[76:91]
  buffer_load_dwordx4 v5, s[20:23], s65 offen  lds
  v_exp_f32 v182, v182
  v_exp_f32 v183, v183
  v_perm_b32 v138, v181, v180, s15
  v_exp_f32 v152, v152
  v_exp_f32 v153, v153
  v_perm_b32 v139, v183, v182, s15
  v_exp_f32 v154, v154
  v_exp_f32 v155, v155
  v_perm_b32 v124, v153, v152, s15
  v_mfma_f32_32x32x16_bf16 v[168:183], v[184:187], v[52:55], 0
  v_exp_f32 v156, v156
  v_exp_f32 v157, v157
  v_perm_b32 v125, v155, v154, s15
  v_exp_f32 v158, v158
  v_exp_f32 v159, v159
  v_perm_b32 v126, v157, v156, s15
  v_exp_f32 v160, v160
  v_exp_f32 v161, v161
  v_perm_b32 v127, v159, v158, s15
  v_mfma_f32_32x32x16_bf16 v[76:91], v[196:199], v[136:139], v[76:91]
  buffer_load_dwordx4 a[40:43], v23, s[28:31], s81 offen offset:0
  buffer_load_dwordx4 a[44:47], v23, s[28:31], s81 offen offset:64
  v_exp_f32 v162, v162
  v_exp_f32 v163, v163
  v_perm_b32 v128, v161, v160, s15
  v_exp_f32 v164, v164
  v_exp_f32 v165, v165
  v_perm_b32 v129, v163, v162, s15
  v_mfma_f32_32x32x16_bf16 v[92:107], v[192:195], v[124:127], v[92:107]
  s_waitcnt lgkmcnt(0)
  v_exp_f32 v166, v166
  v_exp_f32_e64 v167, v167
  v_perm_b32 v130, v165, v164, s15
  v_exp_f32 v168, v168
  v_exp_f32 v169, v169
  v_perm_b32 v131, v167, v166, s15
  v_exp_f32 v170, v170
  v_exp_f32 v171, v171
  v_perm_b32 v132, v169, v168, s15
  v_mfma_f32_32x32x16_bf16 v[152:167], v[188:191], v[40:43], 0
  v_exp_f32 v172, v172
  v_exp_f32 v173, v173
  v_perm_b32 v133, v171, v170, s15
  v_exp_f32 v174, v174
  v_exp_f32 v175, v175
  v_perm_b32 v134, v173, v172, s15
  v_exp_f32 v176, v176
  v_exp_f32 v177, v177
  v_perm_b32 v135, v175, v174, s15
  v_mfma_f32_32x32x16_bf16 v[92:107], v[196:199], v[128:131], v[92:107]
  v_exp_f32 v178, v178
  v_exp_f32 v179, v179
  v_perm_b32 v136, v177, v176, s15
  v_exp_f32 v180, v180
  v_exp_f32 v181, v181
  v_perm_b32 v137, v179, v178, s15
  v_mfma_f32_32x32x16_bf16 v[108:123], v[192:195], v[132:135], v[108:123]
  v_exp_f32 v182, v182
  v_exp_f32 v183, v183
  v_perm_b32 v138, v181, v180, s15
  v_exp_f32 v152, v152
  v_exp_f32 v153, v153
  v_perm_b32 v139, v183, v182, s15
  v_exp_f32 v154, v154
  v_exp_f32 v155, v155
  v_perm_b32 v124, v153, v152, s15
  v_mfma_f32_32x32x16_bf16 v[168:183], v[188:191], v[44:47], 0
  s_add_u32 m0, s94, 67584
  s_add_u32 s65, s91, 270336
  v_exp_f32 v156, v156
  v_exp_f32 v157, v157
  v_perm_b32 v125, v155, v154, s15
  v_exp_f32 v158, v158
  v_exp_f32 v159, v159
  v_perm_b32 v126, v157, v156, s15
  v_exp_f32 v160, v160
  v_exp_f32 v161, v161
  v_perm_b32 v127, v159, v158, s15
  v_mfma_f32_32x32x16_bf16 v[108:123], v[196:199], v[136:139], v[108:123]
  ds_read_b128 v[184:187], v11 offset:45760
  v_exp_f32 v162, v162
  v_exp_f32 v163, v163
  v_perm_b32 v128, v161, v160, s15
  v_exp_f32 v164, v164
  v_exp_f32 v165, v165
  v_perm_b32 v129, v163, v162, s15
  v_mfma_f32_32x32x16_bf16 v[60:75], v[200:203], v[124:127], v[60:75]
  buffer_load_dwordx4 v5, s[20:23], s65 offen  lds
  v_exp_f32 v166, v166
  v_exp_f32 v167, v167
  v_perm_b32 v130, v165, v164, s15
  v_exp_f32 v168, v168
  v_exp_f32 v169, v169
  v_perm_b32 v131, v167, v166, s15
  v_exp_f32 v170, v170
  v_exp_f32 v171, v171
  v_perm_b32 v132, v169, v168, s15
  v_mfma_f32_32x32x16_bf16 v[152:167], v[188:191], v[48:51], 0
  v_exp_f32 v172, v172
  v_exp_f32 v173, v173
  v_perm_b32 v133, v171, v170, s15
  v_exp_f32 v174, v174
  v_exp_f32 v175, v175
  v_perm_b32 v134, v173, v172, s15
  v_exp_f32 v176, v176
  v_exp_f32 v177, v177
  v_perm_b32 v135, v175, v174, s15
  v_mfma_f32_32x32x16_bf16 v[60:75], v[204:207], v[128:131], v[60:75]
  ds_read_b128 v[192:195], v12 offset:45760
  ds_read_b128 v[196:199], v13 offset:45760
  v_exp_f32 v178, v178
  v_exp_f32 v179, v179
  v_perm_b32 v136, v177, v176, s15
  v_exp_f32 v180, v180
  v_exp_f32 v181, v181
  v_perm_b32 v137, v179, v178, s15
  v_mfma_f32_32x32x16_bf16 v[76:91], v[200:203], v[132:135], v[76:91]
  buffer_load_dwordx4 a[104:107], v24, s[28:31], s81 offen offset:0
  buffer_load_dwordx4 a[108:111], v24, s[28:31], s81 offen offset:64
  v_exp_f32 v182, v182
  v_exp_f32 v183, v183
  v_perm_b32 v138, v181, v180, s15
  v_exp_f32 v152, v152
  v_exp_f32 v153, v153
  v_perm_b32 v139, v183, v182, s15
  v_exp_f32 v154, v154
  v_exp_f32 v155, v155
  v_perm_b32 v124, v153, v152, s15
  v_mfma_f32_32x32x16_bf16 v[168:183], v[188:191], v[52:55], 0
  s_add_u32 m0, s94, 68608
  s_add_u32 s65, s91, 278528
  v_exp_f32 v156, v156
  v_exp_f32 v157, v157
  v_perm_b32 v125, v155, v154, s15
  v_exp_f32 v158, v158
  v_exp_f32 v159, v159
  v_perm_b32 v126, v157, v156, s15
  v_exp_f32 v160, v160
  v_exp_f32 v161, v161
  v_perm_b32 v127, v159, v158, s15
  v_mfma_f32_32x32x16_bf16 v[76:91], v[204:207], v[136:139], v[76:91]
  buffer_load_dwordx4 v5, s[20:23], s65 offen  lds
  v_exp_f32 v162, v162
  v_exp_f32 v163, v163
  v_perm_b32 v128, v161, v160, s15
  v_exp_f32 v164, v164
  v_exp_f32 v165, v165
  v_perm_b32 v129, v163, v162, s15
  v_mfma_f32_32x32x16_bf16 v[92:107], v[200:203], v[124:127], v[92:107]
  s_waitcnt lgkmcnt(0)
  v_exp_f32 v166, v166
  v_exp_f32_e64 v167, v167
  v_perm_b32 v130, v165, v164, s15
  v_exp_f32 v168, v168
  v_exp_f32 v169, v169
  v_perm_b32 v131, v167, v166, s15
  v_exp_f32 v170, v170
  v_exp_f32 v171, v171
  v_perm_b32 v132, v169, v168, s15
  v_mfma_f32_32x32x16_bf16 v[152:167], v[184:187], v[40:43], 0
  v_exp_f32 v172, v172
  v_exp_f32 v173, v173
  v_perm_b32 v133, v171, v170, s15
  v_exp_f32 v174, v174
  v_exp_f32 v175, v175
  v_perm_b32 v134, v173, v172, s15
  v_exp_f32 v176, v176
  v_exp_f32 v177, v177
  v_perm_b32 v135, v175, v174, s15
  v_mfma_f32_32x32x16_bf16 v[92:107], v[204:207], v[128:131], v[92:107]
  v_exp_f32 v178, v178
  v_exp_f32 v179, v179
  v_perm_b32 v136, v177, v176, s15
  v_exp_f32 v180, v180
  v_exp_f32 v181, v181
  v_perm_b32 v137, v179, v178, s15
  v_mfma_f32_32x32x16_bf16 v[108:123], v[200:203], v[132:135], v[108:123]
  v_exp_f32 v182, v182
  v_exp_f32 v183, v183
  v_perm_b32 v138, v181, v180, s15
  v_exp_f32 v152, v152
  v_exp_f32 v153, v153
  v_perm_b32 v139, v183, v182, s15
  v_exp_f32 v154, v154
  v_exp_f32 v155, v155
  v_perm_b32 v124, v153, v152, s15
  v_mfma_f32_32x32x16_bf16 v[168:183], v[184:187], v[44:47], 0
  v_exp_f32 v156, v156
  v_exp_f32 v157, v157
  v_perm_b32 v125, v155, v154, s15
  v_exp_f32 v158, v158
  v_exp_f32 v159, v159
  v_perm_b32 v126, v157, v156, s15
  v_exp_f32 v160, v160
  v_exp_f32 v161, v161
  v_perm_b32 v127, v159, v158, s15
  v_mfma_f32_32x32x16_bf16 v[108:123], v[204:207], v[136:139], v[108:123]
  ds_read_b128 v[188:191], v11 offset:47840
  v_exp_f32 v162, v162
  v_exp_f32 v163, v163
  v_perm_b32 v128, v161, v160, s15
  v_exp_f32 v164, v164
  v_exp_f32 v165, v165
  v_perm_b32 v129, v163, v162, s15
  v_mfma_f32_32x32x16_bf16 v[60:75], v[192:195], v[124:127], v[60:75]
  v_exp_f32 v166, v166
  v_exp_f32 v167, v167
  v_perm_b32 v130, v165, v164, s15
  v_exp_f32 v168, v168
  v_exp_f32 v169, v169
  v_perm_b32 v131, v167, v166, s15
  v_exp_f32 v170, v170
  v_exp_f32 v171, v171
  v_perm_b32 v132, v169, v168, s15
  v_mfma_f32_32x32x16_bf16 v[152:167], v[184:187], v[48:51], 0
  s_add_u32 m0, s94, 69632
  s_add_u32 s65, s91, 286720
  v_exp_f32 v172, v172
  v_exp_f32 v173, v173
  v_perm_b32 v133, v171, v170, s15
  v_exp_f32 v174, v174
  v_exp_f32 v175, v175
  v_perm_b32 v134, v173, v172, s15
  v_exp_f32 v176, v176
  v_exp_f32 v177, v177
  v_perm_b32 v135, v175, v174, s15
  v_mfma_f32_32x32x16_bf16 v[60:75], v[196:199], v[128:131], v[60:75]
  ds_read_b128 v[200:203], v12 offset:47840
  ds_read_b128 v[204:207], v13 offset:47840
  v_exp_f32 v178, v178
  v_exp_f32 v179, v179
  v_perm_b32 v136, v177, v176, s15
  v_exp_f32 v180, v180
  v_exp_f32 v181, v181
  v_perm_b32 v137, v179, v178, s15
  v_mfma_f32_32x32x16_bf16 v[76:91], v[192:195], v[132:135], v[76:91]
  buffer_load_dwordx4 v5, s[20:23], s65 offen  lds
  v_exp_f32 v182, v182
  v_exp_f32 v183, v183
  v_perm_b32 v138, v181, v180, s15
  v_exp_f32 v152, v152
  v_exp_f32 v153, v153
  v_perm_b32 v139, v183, v182, s15
  v_exp_f32 v154, v154
  v_exp_f32 v155, v155
  v_perm_b32 v124, v153, v152, s15
  v_mfma_f32_32x32x16_bf16 v[168:183], v[184:187], v[52:55], 0
  s_add_u32 s90, s95, 1572864
  v_exp_f32 v156, v156
  v_exp_f32 v157, v157
  v_perm_b32 v125, v155, v154, s15
  v_exp_f32 v158, v158
  v_exp_f32 v159, v159
  v_perm_b32 v126, v157, v156, s15
  v_exp_f32 v160, v160
  v_exp_f32 v161, v161
  v_perm_b32 v127, v159, v158, s15
  v_mfma_f32_32x32x16_bf16 v[76:91], v[196:199], v[136:139], v[76:91]
  buffer_load_dword v27, v10, s[24:27], s90 offen
  v_exp_f32 v162, v162
  v_exp_f32 v163, v163
  v_perm_b32 v128, v161, v160, s15
  v_exp_f32 v164, v164
  v_exp_f32 v165, v165
  v_perm_b32 v129, v163, v162, s15
  v_mfma_f32_32x32x16_bf16 v[92:107], v[192:195], v[124:127], v[92:107]
  s_waitcnt lgkmcnt(0)
  v_exp_f32 v166, v166
  v_exp_f32_e64 v167, v167
  v_perm_b32 v130, v165, v164, s15
  v_exp_f32 v168, v168
  v_exp_f32 v169, v169
  v_perm_b32 v131, v167, v166, s15
  v_exp_f32 v170, v170
  v_exp_f32 v171, v171
  v_perm_b32 v132, v169, v168, s15
  v_mfma_f32_32x32x16_bf16 v[152:167], v[188:191], v[40:43], 0
  s_add_u32 m0, s94, 70656
  s_add_u32 s65, s91, 294912
  v_exp_f32 v172, v172
  v_exp_f32 v173, v173
  v_perm_b32 v133, v171, v170, s15
  v_exp_f32 v174, v174
  v_exp_f32 v175, v175
  v_perm_b32 v134, v173, v172, s15
  v_exp_f32 v176, v176
  v_exp_f32 v177, v177
  v_perm_b32 v135, v175, v174, s15
  v_mfma_f32_32x32x16_bf16 v[92:107], v[196:199], v[128:131], v[92:107]
  buffer_load_dwordx4 v5, s[20:23], s65 offen  lds
  v_exp_f32 v178, v178
  v_exp_f32 v179, v179
  v_perm_b32 v136, v177, v176, s15
  v_exp_f32 v180, v180
  v_exp_f32 v181, v181
  v_perm_b32 v137, v179, v178, s15
  v_mfma_f32_32x32x16_bf16 v[108:123], v[192:195], v[132:135], v[108:123]
  v_exp_f32 v182, v182
  v_exp_f32 v183, v183
  v_perm_b32 v138, v181, v180, s15
  v_exp_f32 v152, v152
  v_exp_f32 v153, v153
  v_perm_b32 v139, v183, v182, s15
  v_exp_f32 v154, v154
  v_exp_f32 v155, v155
  v_perm_b32 v124, v153, v152, s15
  v_mfma_f32_32x32x16_bf16 v[168:183], v[188:191], v[44:47], 0
  buffer_load_dwordx4 a[168:171], v25, s[28:31], s81 offen offset:0
  buffer_load_dwordx4 a[172:175], v25, s[28:31], s81 offen offset:64
  v_exp_f32 v156, v156
  v_exp_f32 v157, v157
  v_perm_b32 v125, v155, v154, s15
  v_exp_f32 v158, v158
  v_exp_f32 v159, v159
  v_perm_b32 v126, v157, v156, s15
  v_exp_f32 v160, v160
  v_exp_f32 v161, v161
  v_perm_b32 v127, v159, v158, s15
  v_mfma_f32_32x32x16_bf16 v[108:123], v[196:199], v[136:139], v[108:123]
  ds_read_b128 v[184:187], v11 offset:49920
  v_exp_f32 v162, v162
  v_exp_f32 v163, v163
  v_perm_b32 v128, v161, v160, s15
  v_exp_f32 v164, v164
  v_exp_f32 v165, v165
  v_perm_b32 v129, v163, v162, s15
  v_mfma_f32_32x32x16_bf16 v[60:75], v[200:203], v[124:127], v[60:75]
  v_exp_f32 v166, v166
  v_exp_f32 v167, v167
  v_perm_b32 v130, v165, v164, s15
  v_exp_f32 v168, v168
  v_exp_f32 v169, v169
  v_perm_b32 v131, v167, v166, s15
  v_exp_f32 v170, v170
  v_exp_f32 v171, v171
  v_perm_b32 v132, v169, v168, s15
  v_mfma_f32_32x32x16_bf16 v[152:167], v[188:191], v[48:51], 0
  s_add_u32 m0, s94, 71680
  s_add_u32 s65, s91, 303104
  v_exp_f32 v172, v172
  v_exp_f32 v173, v173
  v_perm_b32 v133, v171, v170, s15
  v_exp_f32 v174, v174
  v_exp_f32 v175, v175
  v_perm_b32 v134, v173, v172, s15
  v_exp_f32 v176, v176
  v_exp_f32 v177, v177
  v_perm_b32 v135, v175, v174, s15
  v_mfma_f32_32x32x16_bf16 v[60:75], v[204:207], v[128:131], v[60:75]
  ds_read_b128 v[192:195], v12 offset:49920
  ds_read_b128 v[196:199], v13 offset:49920
  v_exp_f32 v178, v178
  v_exp_f32 v179, v179
  v_perm_b32 v136, v177, v176, s15
  v_exp_f32 v180, v180
  v_exp_f32 v181, v181
  v_perm_b32 v137, v179, v178, s15
  v_mfma_f32_32x32x16_bf16 v[76:91], v[200:203], v[132:135], v[76:91]
  buffer_load_dwordx4 v5, s[20:23], s65 offen  lds
  v_exp_f32 v182, v182
  v_exp_f32 v183, v183
  v_perm_b32 v138, v181, v180, s15
  v_exp_f32 v152, v152
  v_exp_f32 v153, v153
  v_perm_b32 v139, v183, v182, s15
  v_exp_f32 v154, v154
  v_exp_f32 v155, v155
  v_perm_b32 v124, v153, v152, s15
  v_mfma_f32_32x32x16_bf16 v[168:183], v[188:191], v[52:55], 0
  v_exp_f32 v156, v156
  v_exp_f32 v157, v157
  v_perm_b32 v125, v155, v154, s15
  v_exp_f32 v158, v158
  v_exp_f32 v159, v159
  v_perm_b32 v126, v157, v156, s15
  v_exp_f32 v160, v160
  v_exp_f32 v161, v161
  v_perm_b32 v127, v159, v158, s15
  v_mfma_f32_32x32x16_bf16 v[76:91], v[204:207], v[136:139], v[76:91]
  buffer_load_dwordx4 a[232:235], v26, s[28:31], s81 offen offset:0
  buffer_load_dwordx4 a[236:239], v26, s[28:31], s81 offen offset:64
  v_exp_f32 v162, v162
  v_exp_f32 v163, v163
  v_perm_b32 v128, v161, v160, s15
  v_exp_f32 v164, v164
  v_exp_f32 v165, v165
  v_perm_b32 v129, v163, v162, s15
  v_mfma_f32_32x32x16_bf16 v[92:107], v[200:203], v[124:127], v[92:107]
  s_waitcnt lgkmcnt(0)
  v_exp_f32 v166, v166
  v_exp_f32_e64 v167, v167
  v_perm_b32 v130, v165, v164, s15
  v_exp_f32 v168, v168
  v_exp_f32 v169, v169
  v_perm_b32 v131, v167, v166, s15
  v_exp_f32 v170, v170
  v_exp_f32 v171, v171
  v_perm_b32 v132, v169, v168, s15
  v_mfma_f32_32x32x16_bf16 v[152:167], v[184:187], v[40:43], 0
  v_exp_f32 v172, v172
  v_exp_f32 v173, v173
  v_perm_b32 v133, v171, v170, s15
  v_exp_f32 v174, v174
  v_exp_f32 v175, v175
  v_perm_b32 v134, v173, v172, s15
  v_exp_f32 v176, v176
  v_exp_f32 v177, v177
  v_perm_b32 v135, v175, v174, s15
  v_mfma_f32_32x32x16_bf16 v[92:107], v[204:207], v[128:131], v[92:107]
  v_exp_f32 v178, v178
  v_exp_f32 v179, v179
  v_perm_b32 v136, v177, v176, s15
  v_exp_f32 v180, v180
  v_exp_f32 v181, v181
  v_perm_b32 v137, v179, v178, s15
  v_mfma_f32_32x32x16_bf16 v[108:123], v[200:203], v[132:135], v[108:123]
  v_exp_f32 v182, v182
  v_exp_f32 v183, v183
  v_perm_b32 v138, v181, v180, s15
  v_exp_f32 v152, v152
  v_exp_f32 v153, v153
  v_perm_b32 v139, v183, v182, s15
  v_exp_f32 v154, v154
  v_exp_f32 v155, v155
  v_perm_b32 v124, v153, v152, s15
  v_mfma_f32_32x32x16_bf16 v[168:183], v[184:187], v[44:47], 0
  s_add_u32 m0, s94, 72704
  s_add_u32 s65, s91, 311296
  v_exp_f32 v156, v156
  v_exp_f32 v157, v157
  v_perm_b32 v125, v155, v154, s15
  v_exp_f32 v158, v158
  v_exp_f32 v159, v159
  v_perm_b32 v126, v157, v156, s15
  v_exp_f32 v160, v160
  v_exp_f32 v161, v161
  v_perm_b32 v127, v159, v158, s15
  v_mfma_f32_32x32x16_bf16 v[108:123], v[204:207], v[136:139], v[108:123]
  ds_read_b128 v[188:191], v11 offset:52000
  v_exp_f32 v162, v162
  v_exp_f32 v163, v163
  v_perm_b32 v128, v161, v160, s15
  v_exp_f32 v164, v164
  v_exp_f32 v165, v165
  v_perm_b32 v129, v163, v162, s15
  v_mfma_f32_32x32x16_bf16 v[60:75], v[192:195], v[124:127], v[60:75]
  buffer_load_dwordx4 v5, s[20:23], s65 offen  lds
  v_exp_f32 v166, v166
  v_exp_f32 v167, v167
  v_perm_b32 v130, v165, v164, s15
  v_exp_f32 v168, v168
  v_exp_f32 v169, v169
  v_perm_b32 v131, v167, v166, s15
  v_exp_f32 v170, v170
  v_exp_f32 v171, v171
  v_perm_b32 v132, v169, v168, s15
  v_mfma_f32_32x32x16_bf16 v[152:167], v[184:187], v[48:51], 0
  v_exp_f32 v172, v172
  v_exp_f32 v173, v173
  v_perm_b32 v133, v171, v170, s15
  v_exp_f32 v174, v174
  v_exp_f32 v175, v175
  v_perm_b32 v134, v173, v172, s15
  v_exp_f32 v176, v176
  v_exp_f32 v177, v177
  v_perm_b32 v135, v175, v174, s15
  v_mfma_f32_32x32x16_bf16 v[60:75], v[196:199], v[128:131], v[60:75]
  ds_read_b128 v[200:203], v12 offset:52000
  ds_read_b128 v[204:207], v13 offset:52000
  v_exp_f32 v178, v178
  v_exp_f32 v179, v179
  v_perm_b32 v136, v177, v176, s15
  v_exp_f32 v180, v180
  v_exp_f32 v181, v181
  v_perm_b32 v137, v179, v178, s15
  v_mfma_f32_32x32x16_bf16 v[76:91], v[192:195], v[132:135], v[76:91]
  buffer_load_dwordx4 a[48:51], v23, s[28:31], s82 offen offset:0
  buffer_load_dwordx4 a[52:55], v23, s[28:31], s82 offen offset:64
  v_exp_f32 v182, v182
  v_exp_f32 v183, v183
  v_perm_b32 v138, v181, v180, s15
  v_exp_f32 v152, v152
  v_exp_f32 v153, v153
  v_perm_b32 v139, v183, v182, s15
  v_exp_f32 v154, v154
  v_exp_f32 v155, v155
  v_perm_b32 v124, v153, v152, s15
  v_mfma_f32_32x32x16_bf16 v[168:183], v[184:187], v[52:55], 0
  s_add_u32 m0, s94, 73728
  s_add_u32 s65, s91, 319488
  v_exp_f32 v156, v156
  v_exp_f32 v157, v157
  v_perm_b32 v125, v155, v154, s15
  v_exp_f32 v158, v158
  v_exp_f32 v159, v159
  v_perm_b32 v126, v157, v156, s15
  v_exp_f32 v160, v160
  v_exp_f32 v161, v161
  v_perm_b32 v127, v159, v158, s15
  v_mfma_f32_32x32x16_bf16 v[76:91], v[196:199], v[136:139], v[76:91]
  buffer_load_dwordx4 v5, s[20:23], s65 offen  lds
  v_exp_f32 v162, v162
  v_exp_f32 v163, v163
  v_perm_b32 v128, v161, v160, s15
  v_exp_f32 v164, v164
  v_exp_f32 v165, v165
  v_perm_b32 v129, v163, v162, s15
  v_mfma_f32_32x32x16_bf16 v[92:107], v[192:195], v[124:127], v[92:107]
  s_waitcnt lgkmcnt(0)
  v_exp_f32 v166, v166
  v_exp_f32_e64 v167, v167
  v_perm_b32 v130, v165, v164, s15
  v_exp_f32 v168, v168
  v_exp_f32 v169, v169
  v_perm_b32 v131, v167, v166, s15
  v_exp_f32 v170, v170
  v_exp_f32 v171, v171
  v_perm_b32 v132, v169, v168, s15
  v_mfma_f32_32x32x16_bf16 v[152:167], v[188:191], v[40:43], 0
  v_exp_f32 v172, v172
  v_exp_f32 v173, v173
  v_perm_b32 v133, v171, v170, s15
  v_exp_f32 v174, v174
  v_exp_f32 v175, v175
  v_perm_b32 v134, v173, v172, s15
  v_exp_f32 v176, v176
  v_exp_f32 v177, v177
  v_perm_b32 v135, v175, v174, s15
  v_mfma_f32_32x32x16_bf16 v[92:107], v[196:199], v[128:131], v[92:107]
  v_exp_f32 v178, v178
  v_exp_f32 v179, v179
  v_perm_b32 v136, v177, v176, s15
  v_exp_f32 v180, v180
  v_exp_f32 v181, v181
  v_perm_b32 v137, v179, v178, s15
  v_mfma_f32_32x32x16_bf16 v[108:123], v[192:195], v[132:135], v[108:123]
  v_exp_f32 v182, v182
  v_exp_f32 v183, v183
  v_perm_b32 v138, v181, v180, s15
  v_exp_f32 v152, v152
  v_exp_f32 v153, v153
  v_perm_b32 v139, v183, v182, s15
  v_exp_f32 v154, v154
  v_exp_f32 v155, v155
  v_perm_b32 v124, v153, v152, s15
  v_mfma_f32_32x32x16_bf16 v[168:183], v[188:191], v[44:47], 0
  s_lshl_b32 s90, s59, 14
  s_add_u32 s90, s90, s3
  v_exp_f32 v156, v156
  v_exp_f32 v157, v157
  v_perm_b32 v125, v155, v154, s15
  v_exp_f32 v158, v158
  v_exp_f32 v159, v159
  v_perm_b32 v126, v157, v156, s15
  v_exp_f32 v160, v160
  v_exp_f32 v161, v161
  v_perm_b32 v127, v159, v158, s15
  v_mfma_f32_32x32x16_bf16 v[108:123], v[196:199], v[136:139], v[108:123]
  ds_read_b128 v[184:187], v11 offset:54080
  v_exp_f32 v162, v162
  v_exp_f32 v163, v163
  v_perm_b32 v128, v161, v160, s15
  v_exp_f32 v164, v164
  v_exp_f32 v165, v165
  v_perm_b32 v129, v163, v162, s15
  v_mfma_f32_32x32x16_bf16 v[60:75], v[200:203], v[124:127], v[60:75]
  s_lshl_b32 s66, s56, 12
  s_add_u32 s90, s90, s66
  v_exp_f32 v166, v166
  v_exp_f32 v167, v167
  v_perm_b32 v130, v165, v164, s15
  v_exp_f32 v168, v168
  v_exp_f32 v169, v169
  v_perm_b32 v131, v167, v166, s15
  v_exp_f32 v170, v170
  v_exp_f32 v171, v171
  v_perm_b32 v132, v169, v168, s15
  v_mfma_f32_32x32x16_bf16 v[152:167], v[188:191], v[48:51], 0
  buffer_load_dword v27, v10, s[52:55], s90 offen offset:0
  v_exp_f32 v172, v172
  v_exp_f32 v173, v173
  v_perm_b32 v133, v171, v170, s15
  v_exp_f32 v174, v174
  v_exp_f32 v175, v175
  v_perm_b32 v134, v173, v172, s15
  v_exp_f32 v176, v176
  v_exp_f32 v177, v177
  v_perm_b32 v135, v175, v174, s15
  v_mfma_f32_32x32x16_bf16 v[60:75], v[204:207], v[128:131], v[60:75]
  ds_read_b128 v[192:195], v12 offset:54080
  ds_read_b128 v[196:199], v13 offset:54080
  v_exp_f32 v178, v178
  v_exp_f32 v179, v179
  v_perm_b32 v136, v177, v176, s15
  v_exp_f32 v180, v180
  v_exp_f32 v181, v181
  v_perm_b32 v137, v179, v178, s15
  v_mfma_f32_32x32x16_bf16 v[76:91], v[200:203], v[132:135], v[76:91]
  s_add_u32 m0, s89, 133120
  s_add_u32 s67, s88, 1792
  v_exp_f32 v182, v182
  v_exp_f32 v183, v183
  v_perm_b32 v138, v181, v180, s15
  v_exp_f32 v152, v152
  v_exp_f32 v153, v153
  v_perm_b32 v139, v183, v182, s15
  v_exp_f32 v154, v154
  v_exp_f32 v155, v155
  v_perm_b32 v124, v153, v152, s15
  v_mfma_f32_32x32x16_bf16 v[168:183], v[188:191], v[52:55], 0
  buffer_load_dwordx4 v16, s[24:27], s67 offen  lds
  v_exp_f32 v156, v156
  v_exp_f32 v157, v157
  v_perm_b32 v125, v155, v154, s15
  v_exp_f32 v158, v158
  v_exp_f32 v159, v159
  v_perm_b32 v126, v157, v156, s15
  v_exp_f32 v160, v160
  v_exp_f32 v161, v161
  v_perm_b32 v127, v159, v158, s15
  v_mfma_f32_32x32x16_bf16 v[76:91], v[204:207], v[136:139], v[76:91]
  v_exp_f32 v162, v162
  v_exp_f32 v163, v163
  v_perm_b32 v128, v161, v160, s15
  v_exp_f32 v164, v164
  v_exp_f32 v165, v165
  v_perm_b32 v129, v163, v162, s15
  v_mfma_f32_32x32x16_bf16 v[92:107], v[200:203], v[124:127], v[92:107]
  s_waitcnt lgkmcnt(0)
  v_exp_f32 v166, v166
  v_exp_f32_e64 v167, v167
  v_perm_b32 v130, v165, v164, s15
  v_exp_f32 v168, v168
  v_exp_f32 v169, v169
  v_perm_b32 v131, v167, v166, s15
  v_exp_f32 v170, v170
  v_exp_f32 v171, v171
  v_perm_b32 v132, v169, v168, s15
  v_mfma_f32_32x32x16_bf16 v[152:167], v[184:187], v[40:43], 0
  s_add_u32 m0, s89, 134144
  v_exp_f32 v172, v172
  v_exp_f32 v173, v173
  v_perm_b32 v133, v171, v170, s15
  v_exp_f32 v174, v174
  v_exp_f32 v175, v175
  v_perm_b32 v134, v173, v172, s15
  v_exp_f32 v176, v176
  v_exp_f32 v177, v177
  v_perm_b32 v135, v175, v174, s15
  v_mfma_f32_32x32x16_bf16 v[92:107], v[204:207], v[128:131], v[92:107]
  buffer_load_dwordx4 v17, s[24:27], s67 offen  lds
  v_exp_f32 v178, v178
  v_exp_f32 v179, v179
  v_perm_b32 v136, v177, v176, s15
  v_exp_f32 v180, v180
  v_exp_f32 v181, v181
  v_perm_b32 v137, v179, v178, s15
  v_mfma_f32_32x32x16_bf16 v[108:123], v[200:203], v[132:135], v[108:123]
  v_exp_f32 v182, v182
  v_exp_f32 v183, v183
  v_perm_b32 v138, v181, v180, s15
  v_exp_f32 v152, v152
  v_exp_f32 v153, v153
  v_perm_b32 v139, v183, v182, s15
  v_exp_f32 v154, v154
  v_exp_f32 v155, v155
  v_perm_b32 v124, v153, v152, s15
  v_mfma_f32_32x32x16_bf16 v[168:183], v[184:187], v[44:47], 0
  buffer_load_dwordx4 a[112:115], v24, s[28:31], s82 offen offset:0
  buffer_load_dwordx4 a[116:119], v24, s[28:31], s82 offen offset:64
  v_exp_f32 v156, v156
  v_exp_f32 v157, v157
  v_perm_b32 v125, v155, v154, s15
  v_exp_f32 v158, v158
  v_exp_f32 v159, v159
  v_perm_b32 v126, v157, v156, s15
  v_exp_f32 v160, v160
  v_exp_f32 v161, v161
  v_perm_b32 v127, v159, v158, s15
  v_mfma_f32_32x32x16_bf16 v[108:123], v[204:207], v[136:139], v[108:123]
  ds_read_b128 v[188:191], v11 offset:56160
  v_exp_f32 v162, v162
  v_exp_f32 v163, v163
  v_perm_b32 v128, v161, v160, s15
  v_exp_f32 v164, v164
  v_exp_f32 v165, v165
  v_perm_b32 v129, v163, v162, s15
  v_mfma_f32_32x32x16_bf16 v[60:75], v[192:195], v[124:127], v[60:75]
  buffer_load_dwordx4 a[176:179], v25, s[28:31], s82 offen offset:0
  buffer_load_dwordx4 a[180:183], v25, s[28:31], s82 offen offset:64
  v_exp_f32 v166, v166
  v_exp_f32 v167, v167
  v_perm_b32 v130, v165, v164, s15
  v_exp_f32 v168, v168
  v_exp_f32 v169, v169
  v_perm_b32 v131, v167, v166, s15
  v_exp_f32 v170, v170
  v_exp_f32 v171, v171
  v_perm_b32 v132, v169, v168, s15
  v_mfma_f32_32x32x16_bf16 v[152:167], v[184:187], v[48:51], 0
  v_exp_f32 v172, v172
  v_exp_f32 v173, v173
  v_perm_b32 v133, v171, v170, s15
  v_exp_f32 v174, v174
  v_exp_f32 v175, v175
  v_perm_b32 v134, v173, v172, s15
  v_exp_f32 v176, v176
  v_exp_f32 v177, v177
  v_perm_b32 v135, v175, v174, s15
  v_mfma_f32_32x32x16_bf16 v[60:75], v[196:199], v[128:131], v[60:75]
  ds_read_b128 v[200:203], v12 offset:56160
  ds_read_b128 v[204:207], v13 offset:56160
  v_exp_f32 v178, v178
  v_exp_f32 v179, v179
  v_perm_b32 v136, v177, v176, s15
  v_exp_f32 v180, v180
  v_exp_f32 v181, v181
  v_perm_b32 v137, v179, v178, s15
  v_mfma_f32_32x32x16_bf16 v[76:91], v[192:195], v[132:135], v[76:91]
  v_exp_f32 v182, v182
  v_exp_f32 v183, v183
  v_perm_b32 v138, v181, v180, s15
  v_exp_f32 v152, v152
  v_exp_f32 v153, v153
  v_perm_b32 v139, v183, v182, s15
  v_exp_f32 v154, v154
  v_exp_f32 v155, v155
  v_perm_b32 v124, v153, v152, s15
  v_mfma_f32_32x32x16_bf16 v[168:183], v[184:187], v[52:55], 0
  s_add_u32 m0, s89, 135168
  v_exp_f32 v156, v156
  v_exp_f32 v157, v157
  v_perm_b32 v125, v155, v154, s15
  v_exp_f32 v158, v158
  v_exp_f32 v159, v159
  v_perm_b32 v126, v157, v156, s15
  v_exp_f32 v160, v160
  v_exp_f32 v161, v161
  v_perm_b32 v127, v159, v158, s15
  v_mfma_f32_32x32x16_bf16 v[76:91], v[196:199], v[136:139], v[76:91]
  buffer_load_dwordx4 v18, s[24:27], s67 offen  lds
  v_exp_f32 v162, v162
  v_exp_f32 v163, v163
  v_perm_b32 v128, v161, v160, s15
  v_exp_f32 v164, v164
  v_exp_f32 v165, v165
  v_perm_b32 v129, v163, v162, s15
  v_mfma_f32_32x32x16_bf16 v[92:107], v[192:195], v[124:127], v[92:107]
  s_waitcnt lgkmcnt(0)
  v_exp_f32 v166, v166
  v_exp_f32_e64 v167, v167
  v_perm_b32 v130, v165, v164, s15
  v_exp_f32 v168, v168
  v_exp_f32 v169, v169
  v_perm_b32 v131, v167, v166, s15
  v_exp_f32 v170, v170
  v_exp_f32 v171, v171
  v_perm_b32 v132, v169, v168, s15
  v_mfma_f32_32x32x16_bf16 v[152:167], v[188:191], v[40:43], 0
  buffer_load_dwordx4 a[240:243], v26, s[28:31], s82 offen offset:0
  buffer_load_dwordx4 a[244:247], v26, s[28:31], s82 offen offset:64
  v_exp_f32 v172, v172
  v_exp_f32 v173, v173
  v_perm_b32 v133, v171, v170, s15
  v_exp_f32 v174, v174
  v_exp_f32 v175, v175
  v_perm_b32 v134, v173, v172, s15
  v_exp_f32 v176, v176
  v_exp_f32 v177, v177
  v_perm_b32 v135, v175, v174, s15
  v_mfma_f32_32x32x16_bf16 v[92:107], v[196:199], v[128:131], v[92:107]
  v_exp_f32 v178, v178
  v_exp_f32 v179, v179
  v_perm_b32 v136, v177, v176, s15
  v_exp_f32 v180, v180
  v_exp_f32 v181, v181
  v_perm_b32 v137, v179, v178, s15
  v_mfma_f32_32x32x16_bf16 v[108:123], v[192:195], v[132:135], v[108:123]
  v_exp_f32 v182, v182
  v_exp_f32 v183, v183
  v_perm_b32 v138, v181, v180, s15
  v_exp_f32 v152, v152
  v_exp_f32 v153, v153
  v_perm_b32 v139, v183, v182, s15
  v_exp_f32 v154, v154
  v_exp_f32 v155, v155
  v_perm_b32 v124, v153, v152, s15
  v_mfma_f32_32x32x16_bf16 v[168:183], v[188:191], v[44:47], 0
  s_add_u32 m0, s89, 136192
  v_exp_f32 v156, v156
  v_exp_f32 v157, v157
  v_perm_b32 v125, v155, v154, s15
  v_exp_f32 v158, v158
  v_exp_f32 v159, v159
  v_perm_b32 v126, v157, v156, s15
  v_exp_f32 v160, v160
  v_exp_f32 v161, v161
  v_perm_b32 v127, v159, v158, s15
  v_mfma_f32_32x32x16_bf16 v[108:123], v[196:199], v[136:139], v[108:123]
  ds_read_b128 v[184:187], v11 offset:58240
  v_exp_f32 v162, v162
  v_exp_f32 v163, v163
  v_perm_b32 v128, v161, v160, s15
  v_exp_f32 v164, v164
  v_exp_f32 v165, v165
  v_perm_b32 v129, v163, v162, s15
  v_mfma_f32_32x32x16_bf16 v[60:75], v[200:203], v[124:127], v[60:75]
  buffer_load_dwordx4 v19, s[24:27], s67 offen  lds
  v_exp_f32 v166, v166
  v_exp_f32 v167, v167
  v_perm_b32 v130, v165, v164, s15
  v_exp_f32 v168, v168
  v_exp_f32 v169, v169
  v_perm_b32 v131, v167, v166, s15
  v_exp_f32 v170, v170
  v_exp_f32 v171, v171
  v_perm_b32 v132, v169, v168, s15
  v_mfma_f32_32x32x16_bf16 v[152:167], v[188:191], v[48:51], 0
  v_exp_f32 v172, v172
  v_exp_f32 v173, v173
  v_perm_b32 v133, v171, v170, s15
  v_exp_f32 v174, v174
  v_exp_f32 v175, v175
  v_perm_b32 v134, v173, v172, s15
  v_exp_f32 v176, v176
  v_exp_f32 v177, v177
  v_perm_b32 v135, v175, v174, s15
  v_mfma_f32_32x32x16_bf16 v[60:75], v[204:207], v[128:131], v[60:75]
  ds_read_b128 v[192:195], v12 offset:58240
  ds_read_b128 v[196:199], v13 offset:58240
  v_exp_f32 v178, v178
  v_exp_f32 v179, v179
  v_perm_b32 v136, v177, v176, s15
  v_exp_f32 v180, v180
  v_exp_f32 v181, v181
  v_perm_b32 v137, v179, v178, s15
  v_mfma_f32_32x32x16_bf16 v[76:91], v[200:203], v[132:135], v[76:91]
  v_exp_f32 v182, v182
  v_exp_f32 v183, v183
  v_perm_b32 v138, v181, v180, s15
  v_exp_f32 v152, v152
  v_exp_f32 v153, v153
  v_perm_b32 v139, v183, v182, s15
  v_exp_f32 v154, v154
  v_exp_f32 v155, v155
  v_perm_b32 v124, v153, v152, s15
  v_mfma_f32_32x32x16_bf16 v[168:183], v[188:191], v[52:55], 0
  s_lshl_b32 s90, s59, 14
  s_add_u32 s90, s90, s3
  v_exp_f32 v156, v156
  v_exp_f32 v157, v157
  v_perm_b32 v125, v155, v154, s15
  v_exp_f32 v158, v158
  v_exp_f32 v159, v159
  v_perm_b32 v126, v157, v156, s15
  v_exp_f32 v160, v160
  v_exp_f32 v161, v161
  v_perm_b32 v127, v159, v158, s15
  v_mfma_f32_32x32x16_bf16 v[76:91], v[204:207], v[136:139], v[76:91]
  s_lshl_b32 s66, s56, 12
  s_add_u32 s90, s90, s66
  v_exp_f32 v162, v162
  v_exp_f32 v163, v163
  v_perm_b32 v128, v161, v160, s15
  v_exp_f32 v164, v164
  v_exp_f32 v165, v165
  v_perm_b32 v129, v163, v162, s15
  v_mfma_f32_32x32x16_bf16 v[92:107], v[200:203], v[124:127], v[92:107]
  s_waitcnt lgkmcnt(0)
  v_exp_f32 v166, v166
  v_exp_f32_e64 v167, v167
  v_perm_b32 v130, v165, v164, s15
  v_exp_f32 v168, v168
  v_exp_f32 v169, v169
  v_perm_b32 v131, v167, v166, s15
  v_exp_f32 v170, v170
  v_exp_f32 v171, v171
  v_perm_b32 v132, v169, v168, s15
  v_mfma_f32_32x32x16_bf16 v[152:167], v[184:187], v[40:43], 0
  buffer_load_dword v27, v10, s[52:55], s90 offen offset:2048
  v_exp_f32 v172, v172
  v_exp_f32 v173, v173
  v_perm_b32 v133, v171, v170, s15
  v_exp_f32 v174, v174
  v_exp_f32 v175, v175
  v_perm_b32 v134, v173, v172, s15
  v_exp_f32 v176, v176
  v_exp_f32 v177, v177
  v_perm_b32 v135, v175, v174, s15
  v_mfma_f32_32x32x16_bf16 v[92:107], v[204:207], v[128:131], v[92:107]
  s_add_u32 m0, s89, 137216
  v_exp_f32 v178, v178
  v_exp_f32 v179, v179
  v_perm_b32 v136, v177, v176, s15
  v_exp_f32 v180, v180
  v_exp_f32 v181, v181
  v_perm_b32 v137, v179, v178, s15
  v_mfma_f32_32x32x16_bf16 v[108:123], v[200:203], v[132:135], v[108:123]
  buffer_load_dwordx4 v20, s[24:27], s67 offen  lds
  v_exp_f32 v182, v182
  v_exp_f32 v183, v183
  v_perm_b32 v138, v181, v180, s15
  v_exp_f32 v152, v152
  v_exp_f32 v153, v153
  v_perm_b32 v139, v183, v182, s15
  v_exp_f32 v154, v154
  v_exp_f32 v155, v155
  v_perm_b32 v124, v153, v152, s15
  v_mfma_f32_32x32x16_bf16 v[168:183], v[184:187], v[44:47], 0
  v_exp_f32 v156, v156
  v_exp_f32 v157, v157
  v_perm_b32 v125, v155, v154, s15
  v_exp_f32 v158, v158
  v_exp_f32 v159, v159
  v_perm_b32 v126, v157, v156, s15
  v_exp_f32 v160, v160
  v_exp_f32 v161, v161
  v_perm_b32 v127, v159, v158, s15
  v_mfma_f32_32x32x16_bf16 v[108:123], v[204:207], v[136:139], v[108:123]
  ds_read_b128 v[188:191], v11 offset:60320
  v_exp_f32 v162, v162
  v_exp_f32 v163, v163
  v_perm_b32 v128, v161, v160, s15
  v_exp_f32 v164, v164
  v_exp_f32 v165, v165
  v_perm_b32 v129, v163, v162, s15
  v_mfma_f32_32x32x16_bf16 v[60:75], v[192:195], v[124:127], v[60:75]
  buffer_load_dwordx4 a[56:59], v23, s[28:31], s83 offen offset:0
  buffer_load_dwordx4 a[60:63], v23, s[28:31], s83 offen offset:64
  v_exp_f32 v166, v166
  v_exp_f32 v167, v167
  v_perm_b32 v130, v165, v164, s15
  v_exp_f32 v168, v168
  v_exp_f32 v169, v169
  v_perm_b32 v131, v167, v166, s15
  v_exp_f32 v170, v170
  v_exp_f32 v171, v171
  v_perm_b32 v132, v169, v168, s15
  v_mfma_f32_32x32x16_bf16 v[152:167], v[184:187], v[48:51], 0
  s_add_u32 m0, s89, 138240
  v_exp_f32 v172, v172
  v_exp_f32 v173, v173
  v_perm_b32 v133, v171, v170, s15
  v_exp_f32 v174, v174
  v_exp_f32 v175, v175
  v_perm_b32 v134, v173, v172, s15
  v_exp_f32 v176, v176
  v_exp_f32 v177, v177
  v_perm_b32 v135, v175, v174, s15
  v_mfma_f32_32x32x16_bf16 v[60:75], v[196:199], v[128:131], v[60:75]
  ds_read_b128 v[200:203], v12 offset:60320
  ds_read_b128 v[204:207], v13 offset:60320
  v_exp_f32 v178, v178
  v_exp_f32 v179, v179
  v_perm_b32 v136, v177, v176, s15
  v_exp_f32 v180, v180
  v_exp_f32 v181, v181
  v_perm_b32 v137, v179, v178, s15
  v_mfma_f32_32x32x16_bf16 v[76:91], v[192:195], v[132:135], v[76:91]
  buffer_load_dwordx4 v21, s[24:27], s67 offen  lds
  v_exp_f32 v182, v182
  v_exp_f32 v183, v183
  v_perm_b32 v138, v181, v180, s15
  v_exp_f32 v152, v152
  v_exp_f32 v153, v153
  v_perm_b32 v139, v183, v182, s15
  v_exp_f32 v154, v154
  v_exp_f32 v155, v155
  v_perm_b32 v124, v153, v152, s15
  v_mfma_f32_32x32x16_bf16 v[168:183], v[184:187], v[52:55], 0
  v_exp_f32 v156, v156
  v_exp_f32 v157, v157
  v_perm_b32 v125, v155, v154, s15
  v_exp_f32 v158, v158
  v_exp_f32 v159, v159
  v_perm_b32 v126, v157, v156, s15
  v_exp_f32 v160, v160
  v_exp_f32 v161, v161
  v_perm_b32 v127, v159, v158, s15
  v_mfma_f32_32x32x16_bf16 v[76:91], v[196:199], v[136:139], v[76:91]
  buffer_load_dwordx4 a[120:123], v24, s[28:31], s83 offen offset:0
  buffer_load_dwordx4 a[124:127], v24, s[28:31], s83 offen offset:64
  v_exp_f32 v162, v162
  v_exp_f32 v163, v163
  v_perm_b32 v128, v161, v160, s15
  v_exp_f32 v164, v164
  v_exp_f32 v165, v165
  v_perm_b32 v129, v163, v162, s15
  v_mfma_f32_32x32x16_bf16 v[92:107], v[192:195], v[124:127], v[92:107]
  s_waitcnt lgkmcnt(0)
  v_exp_f32 v166, v166
  v_exp_f32_e64 v167, v167
  v_perm_b32 v130, v165, v164, s15
  v_exp_f32 v168, v168
  v_exp_f32 v169, v169
  v_perm_b32 v131, v167, v166, s15
  v_exp_f32 v170, v170
  v_exp_f32 v171, v171
  v_perm_b32 v132, v169, v168, s15
  v_mfma_f32_32x32x16_bf16 v[152:167], v[188:191], v[40:43], 0
  v_exp_f32 v172, v172
  v_exp_f32 v173, v173
  v_perm_b32 v133, v171, v170, s15
  v_exp_f32 v174, v174
  v_exp_f32 v175, v175
  v_perm_b32 v134, v173, v172, s15
  v_exp_f32 v176, v176
  v_exp_f32 v177, v177
  v_perm_b32 v135, v175, v174, s15
  v_mfma_f32_32x32x16_bf16 v[92:107], v[196:199], v[128:131], v[92:107]
  v_exp_f32 v178, v178
  v_exp_f32 v179, v179
  v_perm_b32 v136, v177, v176, s15
  v_exp_f32 v180, v180
  v_exp_f32 v181, v181
  v_perm_b32 v137, v179, v178, s15
  v_mfma_f32_32x32x16_bf16 v[108:123], v[192:195], v[132:135], v[108:123]
  v_exp_f32 v182, v182
  v_exp_f32 v183, v183
  v_perm_b32 v138, v181, v180, s15
  v_exp_f32 v152, v152
  v_exp_f32 v153, v153
  v_perm_b32 v139, v183, v182, s15
  v_exp_f32 v154, v154
  v_exp_f32 v155, v155
  v_perm_b32 v124, v153, v152, s15
  v_mfma_f32_32x32x16_bf16 v[168:183], v[188:191], v[44:47], 0
  s_barrier
  s_add_u32 m0, s89, 139264
  v_exp_f32 v156, v156
  v_exp_f32_e64 v157, v157
  v_perm_b32 v125, v155, v154, s15
  v_exp_f32 v158, v158
  v_exp_f32 v159, v159
  v_perm_b32 v126, v157, v156, s15
  v_exp_f32 v160, v160
  v_exp_f32 v161, v161
  v_perm_b32 v127, v159, v158, s15
  v_mfma_f32_32x32x16_bf16 v[108:123], v[196:199], v[136:139], v[108:123]
  ds_read_b128 v[184:187], v11 offset:62400
  v_exp_f32 v162, v162
  v_exp_f32 v163, v163
  v_perm_b32 v128, v161, v160, s15
  v_exp_f32 v164, v164
  v_exp_f32 v165, v165
  v_perm_b32 v129, v163, v162, s15
  v_mfma_f32_32x32x16_bf16 v[60:75], v[200:203], v[124:127], v[60:75]
  buffer_load_dwordx4 v22, s[24:27], s67 offen  lds
  v_exp_f32 v166, v166
  v_exp_f32 v167, v167
  v_perm_b32 v130, v165, v164, s15
  v_exp_f32 v168, v168
  v_exp_f32 v169, v169
  v_perm_b32 v131, v167, v166, s15
  v_exp_f32 v170, v170
  v_exp_f32 v171, v171
  v_perm_b32 v132, v169, v168, s15
  v_mfma_f32_32x32x16_bf16 v[152:167], v[188:191], v[48:51], 0
  s_add_u32 m0, s89, 33280
  s_add_u32 s67, s88, 460544
  v_exp_f32 v172, v172
  v_exp_f32 v173, v173
  v_perm_b32 v133, v171, v170, s15
  v_exp_f32 v174, v174
  v_exp_f32 v175, v175
  v_perm_b32 v134, v173, v172, s15
  v_exp_f32 v176, v176
  v_exp_f32 v177, v177
  v_perm_b32 v135, v175, v174, s15
  v_mfma_f32_32x32x16_bf16 v[60:75], v[204:207], v[128:131], v[60:75]
  ds_read_b128 v[192:195], v12 offset:62400
  ds_read_b128 v[196:199], v13 offset:62400
  v_exp_f32 v178, v178
  v_exp_f32 v179, v179
  v_perm_b32 v136, v177, v176, s15
  v_exp_f32 v180, v180
  v_exp_f32 v181, v181
  v_perm_b32 v137, v179, v178, s15
  v_mfma_f32_32x32x16_bf16 v[76:91], v[200:203], v[132:135], v[76:91]
  buffer_load_dwordx4 v16, s[24:27], s67 offen  lds
  v_exp_f32 v182, v182
  v_exp_f32 v183, v183
  v_perm_b32 v138, v181, v180, s15
  v_exp_f32 v152, v152
  v_exp_f32 v153, v153
  v_perm_b32 v139, v183, v182, s15
  v_exp_f32 v154, v154
  v_exp_f32 v155, v155
  v_perm_b32 v124, v153, v152, s15
  v_mfma_f32_32x32x16_bf16 v[168:183], v[188:191], v[52:55], 0
  s_add_u32 m0, s89, 34304
  v_exp_f32 v156, v156
  v_exp_f32 v157, v157
  v_perm_b32 v125, v155, v154, s15
  v_exp_f32 v158, v158
  v_exp_f32 v159, v159
  v_perm_b32 v126, v157, v156, s15
  v_exp_f32 v160, v160
  v_exp_f32 v161, v161
  v_perm_b32 v127, v159, v158, s15
  v_mfma_f32_32x32x16_bf16 v[76:91], v[204:207], v[136:139], v[76:91]
  buffer_load_dwordx4 v17, s[24:27], s67 offen  lds
  v_exp_f32 v162, v162
  v_exp_f32 v163, v163
  v_perm_b32 v128, v161, v160, s15
  v_exp_f32 v164, v164
  v_exp_f32 v165, v165
  v_perm_b32 v129, v163, v162, s15
  v_mfma_f32_32x32x16_bf16 v[92:107], v[200:203], v[124:127], v[92:107]
  s_waitcnt lgkmcnt(0)
  v_exp_f32 v166, v166
  v_exp_f32_e64 v167, v167
  v_perm_b32 v130, v165, v164, s15
  v_exp_f32 v168, v168
  v_exp_f32 v169, v169
  v_perm_b32 v131, v167, v166, s15
  v_exp_f32 v170, v170
  v_exp_f32 v171, v171
  v_perm_b32 v132, v169, v168, s15
  v_mfma_f32_32x32x16_bf16 v[152:167], v[184:187], v[40:43], 0
  s_add_u32 m0, s89, 35328
  v_exp_f32 v172, v172
  v_exp_f32 v173, v173
  v_perm_b32 v133, v171, v170, s15
  v_exp_f32 v174, v174
  v_exp_f32 v175, v175
  v_perm_b32 v134, v173, v172, s15
  v_exp_f32 v176, v176
  v_exp_f32 v177, v177
  v_perm_b32 v135, v175, v174, s15
  v_mfma_f32_32x32x16_bf16 v[92:107], v[204:207], v[128:131], v[92:107]
  buffer_load_dwordx4 v18, s[24:27], s67 offen  lds
  v_exp_f32 v178, v178
  v_exp_f32 v179, v179
  v_perm_b32 v136, v177, v176, s15
  v_exp_f32 v180, v180
  v_exp_f32 v181, v181
  v_perm_b32 v137, v179, v178, s15
  v_mfma_f32_32x32x16_bf16 v[108:123], v[200:203], v[132:135], v[108:123]
  s_add_u32 m0, s89, 36352
  v_exp_f32 v182, v182
  v_exp_f32 v183, v183
  v_perm_b32 v138, v181, v180, s15
  v_exp_f32 v152, v152
  v_exp_f32 v153, v153
  v_perm_b32 v139, v183, v182, s15
  v_exp_f32 v154, v154
  v_exp_f32 v155, v155
  v_perm_b32 v124, v153, v152, s15
  v_mfma_f32_32x32x16_bf16 v[168:183], v[184:187], v[44:47], 0
  buffer_load_dwordx4 v19, s[24:27], s67 offen  lds
  v_exp_f32 v156, v156
  v_exp_f32 v157, v157
  v_perm_b32 v125, v155, v154, s15
  v_exp_f32 v158, v158
  v_exp_f32 v159, v159
  v_perm_b32 v126, v157, v156, s15
  v_exp_f32 v160, v160
  v_exp_f32 v161, v161
  v_perm_b32 v127, v159, v158, s15
  v_mfma_f32_32x32x16_bf16 v[108:123], v[204:207], v[136:139], v[108:123]
  ds_read_b128 v[188:191], v11 offset:64480
  v_exp_f32 v162, v162
  v_exp_f32 v163, v163
  v_perm_b32 v128, v161, v160, s15
  v_exp_f32 v164, v164
  v_exp_f32 v165, v165
  v_perm_b32 v129, v163, v162, s15
  v_mfma_f32_32x32x16_bf16 v[60:75], v[192:195], v[124:127], v[60:75]
  s_add_u32 m0, s89, 37376
  v_exp_f32 v166, v166
  v_exp_f32 v167, v167
  v_perm_b32 v130, v165, v164, s15
  v_exp_f32 v168, v168
  v_exp_f32 v169, v169
  v_perm_b32 v131, v167, v166, s15
  v_exp_f32 v170, v170
  v_exp_f32 v171, v171
  v_perm_b32 v132, v169, v168, s15
  v_mfma_f32_32x32x16_bf16 v[152:167], v[184:187], v[48:51], 0
  buffer_load_dwordx4 v20, s[24:27], s67 offen  lds
  v_exp_f32 v172, v172
  v_exp_f32 v173, v173
  v_perm_b32 v133, v171, v170, s15
  v_exp_f32 v174, v174
  v_exp_f32 v175, v175
  v_perm_b32 v134, v173, v172, s15
  v_exp_f32 v176, v176
  v_exp_f32 v177, v177
  v_perm_b32 v135, v175, v174, s15
  v_mfma_f32_32x32x16_bf16 v[60:75], v[196:199], v[128:131], v[60:75]
  ds_read_b128 v[200:203], v12 offset:64480
  ds_read_b128 v[204:207], v13 offset:64480
  v_exp_f32 v178, v178
  v_exp_f32 v179, v179
  v_perm_b32 v136, v177, v176, s15
  v_exp_f32 v180, v180
  v_exp_f32 v181, v181
  v_perm_b32 v137, v179, v178, s15
  v_mfma_f32_32x32x16_bf16 v[76:91], v[192:195], v[132:135], v[76:91]
  s_add_u32 m0, s89, 38400
  v_exp_f32 v182, v182
  v_exp_f32 v183, v183
  v_perm_b32 v138, v181, v180, s15
  v_exp_f32 v152, v152
  v_exp_f32 v153, v153
  v_perm_b32 v139, v183, v182, s15
  v_exp_f32 v154, v154
  v_exp_f32 v155, v155
  v_perm_b32 v124, v153, v152, s15
  v_mfma_f32_32x32x16_bf16 v[168:183], v[184:187], v[52:55], 0
  buffer_load_dwordx4 v21, s[24:27], s67 offen  lds
  v_exp_f32 v156, v156
  v_exp_f32 v157, v157
  v_perm_b32 v125, v155, v154, s15
  v_exp_f32 v158, v158
  v_exp_f32 v159, v159
  v_perm_b32 v126, v157, v156, s15
  v_exp_f32 v160, v160
  v_exp_f32 v161, v161
  v_perm_b32 v127, v159, v158, s15
  v_mfma_f32_32x32x16_bf16 v[76:91], v[196:199], v[136:139], v[76:91]
  s_add_u32 m0, s89, 39424
  v_exp_f32 v162, v162
  v_exp_f32 v163, v163
  v_perm_b32 v128, v161, v160, s15
  v_exp_f32 v164, v164
  v_exp_f32 v165, v165
  v_perm_b32 v129, v163, v162, s15
  v_mfma_f32_32x32x16_bf16 v[92:107], v[192:195], v[124:127], v[92:107]
  s_waitcnt lgkmcnt(0)
  v_exp_f32 v166, v166
  v_exp_f32_e64 v167, v167
  v_perm_b32 v130, v165, v164, s15
  v_exp_f32 v168, v168
  v_exp_f32 v169, v169
  v_perm_b32 v131, v167, v166, s15
  v_exp_f32 v170, v170
  v_exp_f32 v171, v171
  v_perm_b32 v132, v169, v168, s15
  v_mfma_f32_32x32x16_bf16 v[152:167], v[188:191], v[40:43], 0
  buffer_load_dwordx4 v22, s[24:27], s67 offen  lds
  v_exp_f32 v172, v172
  v_exp_f32 v173, v173
  v_perm_b32 v133, v171, v170, s15
  v_exp_f32 v174, v174
  v_exp_f32 v175, v175
  v_perm_b32 v134, v173, v172, s15
  v_exp_f32 v176, v176
  v_exp_f32 v177, v177
  v_perm_b32 v135, v175, v174, s15
  v_mfma_f32_32x32x16_bf16 v[92:107], v[196:199], v[128:131], v[92:107]
  v_exp_f32 v178, v178
  v_exp_f32 v179, v179
  v_perm_b32 v136, v177, v176, s15
  v_exp_f32 v180, v180
  v_exp_f32 v181, v181
  v_perm_b32 v137, v179, v178, s15
  v_mfma_f32_32x32x16_bf16 v[108:123], v[192:195], v[132:135], v[108:123]
  buffer_load_dwordx4 a[184:187], v25, s[28:31], s83 offen offset:0
  buffer_load_dwordx4 a[188:191], v25, s[28:31], s83 offen offset:64
  v_exp_f32 v182, v182
  v_exp_f32 v183, v183
  v_perm_b32 v138, v181, v180, s15
  v_exp_f32 v152, v152
  v_exp_f32 v153, v153
  v_perm_b32 v139, v183, v182, s15
  v_exp_f32 v154, v154
  v_exp_f32 v155, v155
  v_perm_b32 v124, v153, v152, s15
  v_mfma_f32_32x32x16_bf16 v[168:183], v[188:191], v[44:47], 0
  v_exp_f32 v156, v156
  v_exp_f32 v157, v157
  v_perm_b32 v125, v155, v154, s15
  v_exp_f32 v158, v158
  v_exp_f32 v159, v159
  v_perm_b32 v126, v157, v156, s15
  v_exp_f32 v160, v160
  v_exp_f32 v161, v161
  v_perm_b32 v127, v159, v158, s15
  v_mfma_f32_32x32x16_bf16 v[108:123], v[196:199], v[136:139], v[108:123]
  v_exp_f32 v162, v162
  v_exp_f32 v163, v163
  v_perm_b32 v128, v161, v160, s15
  v_exp_f32 v164, v164
  v_exp_f32 v165, v165
  v_perm_b32 v129, v163, v162, s15
  v_mfma_f32_32x32x16_bf16 v[60:75], v[200:203], v[124:127], v[60:75]
  buffer_load_dwordx4 a[248:251], v26, s[28:31], s83 offen offset:0
  buffer_load_dwordx4 a[252:255], v26, s[28:31], s83 offen offset:64
  v_exp_f32 v166, v166
  v_exp_f32 v167, v167
  v_perm_b32 v130, v165, v164, s15
  v_exp_f32 v168, v168
  v_exp_f32 v169, v169
  v_perm_b32 v131, v167, v166, s15
  v_exp_f32 v170, v170
  v_exp_f32 v171, v171
  v_perm_b32 v132, v169, v168, s15
  v_mfma_f32_32x32x16_bf16 v[152:167], v[188:191], v[48:51], 0
  v_exp_f32 v172, v172
  v_exp_f32 v173, v173
  v_perm_b32 v133, v171, v170, s15
  v_exp_f32 v174, v174
  v_exp_f32 v175, v175
  v_perm_b32 v134, v173, v172, s15
  v_exp_f32 v176, v176
  v_exp_f32 v177, v177
  v_perm_b32 v135, v175, v174, s15
  v_mfma_f32_32x32x16_bf16 v[60:75], v[204:207], v[128:131], v[60:75]
  v_exp_f32 v178, v178
  v_exp_f32 v179, v179
  v_perm_b32 v136, v177, v176, s15
  v_exp_f32 v180, v180
  v_exp_f32 v181, v181
  v_perm_b32 v137, v179, v178, s15
  v_mfma_f32_32x32x16_bf16 v[76:91], v[200:203], v[132:135], v[76:91]
  v_exp_f32 v182, v182
  v_exp_f32 v183, v183
  v_perm_b32 v138, v181, v180, s15
  v_exp_f32 v152, v152
  v_exp_f32 v153, v153
  v_perm_b32 v139, v183, v182, s15
  v_exp_f32 v154, v154
  v_exp_f32 v155, v155
  v_perm_b32 v124, v153, v152, s15
  v_mfma_f32_32x32x16_bf16 v[168:183], v[188:191], v[52:55], 0
  ds_write_b128 v36, v[60:63] offset:0
  ds_write_b128 v36, v[64:67] offset:1024
  ds_write_b32 v39, v68 offset:2048
  v_exp_f32 v156, v156
  v_exp_f32 v157, v157
  v_perm_b32 v125, v155, v154, s15
  v_exp_f32 v158, v158
  v_exp_f32 v159, v159
  v_perm_b32 v126, v157, v156, s15
  v_exp_f32 v160, v160
  v_exp_f32 v161, v161
  v_perm_b32 v127, v159, v158, s15
  v_mfma_f32_32x32x16_bf16 v[76:91], v[204:207], v[136:139], v[76:91]
  v_exp_f32 v162, v162
  v_exp_f32 v163, v163
  v_perm_b32 v128, v161, v160, s15
  v_exp_f32 v164, v164
  v_exp_f32 v165, v165
  v_perm_b32 v129, v163, v162, s15
  v_mfma_f32_32x32x16_bf16 v[92:107], v[200:203], v[124:127], v[92:107]
  s_waitcnt lgkmcnt(0)
  v_exp_f32 v166, v166
  v_exp_f32_e64 v167, v167
  v_perm_b32 v130, v165, v164, s15
  v_exp_f32 v168, v168
  v_exp_f32 v169, v169
  v_perm_b32 v131, v167, v166, s15
  v_exp_f32 v170, v170
  v_exp_f32 v171, v171
  v_perm_b32 v132, v169, v168, s15
  ds_write_b128 v36, v[76:79] offset:2304
  ds_write_b128 v36, v[80:83] offset:3328
  ds_write_b32 v39, v84 offset:4352
  v_exp_f32 v172, v172
  v_exp_f32 v173, v173
  v_perm_b32 v133, v171, v170, s15
  v_exp_f32 v174, v174
  v_exp_f32 v175, v175
  v_perm_b32 v134, v173, v172, s15
  v_exp_f32 v176, v176
  v_exp_f32 v177, v177
  v_perm_b32 v135, v175, v174, s15
  v_mfma_f32_32x32x16_bf16 v[92:107], v[204:207], v[128:131], v[92:107]
  s_waitcnt vmcnt(30) lgkmcnt(0)
  s_barrier
  ds_read_b32 v68, v59 offset:2048
  ds_read_b128 v[60:63], v58 offset:0
  ds_read_b128 v[64:67], v58 offset:1024
  ds_read_b32 v84, v59 offset:4352
  ds_read_b128 v[76:79], v58 offset:2304
  ds_read_b128 v[80:83], v58 offset:3328
  v_exp_f32 v178, v178
  v_exp_f32 v179, v179
  v_perm_b32 v136, v177, v176, s15
  v_exp_f32 v180, v180
  v_exp_f32 v181, v181
  v_perm_b32 v137, v179, v178, s15
  v_mfma_f32_32x32x16_bf16 v[108:123], v[200:203], v[132:135], v[108:123]
  v_exp_f32 v182, v182
  v_exp_f32 v183, v183
  v_perm_b32 v138, v181, v180, s15
  v_perm_b32 v139, v183, v182, s15
  s_nop 1
  v_mfma_f32_32x32x16_bf16 v[108:123], v[204:207], v[136:139], v[108:123]
  s_cmp_lg_u64 s[42:43], 0
  s_cbranch_scc1 L_rare_67
L_back_68:
  s_waitcnt lgkmcnt(0)
  v_add_f32 v100, v100, v68
  v_rcp_f32 v100, v100
  v_pk_add_f32 v[92:93], v[92:93], v[60:61]
  v_pk_add_f32 v[94:95], v[94:95], v[62:63]
  v_pk_add_f32 v[96:97], v[96:97], v[64:65]
  v_pk_add_f32 v[98:99], v[98:99], v[66:67]
  v_pk_mul_f32 v[92:93], v[92:93], v[100:101] op_sel_hi:[1,0]
  v_pk_mul_f32 v[94:95], v[94:95], v[100:101] op_sel_hi:[1,0]
  v_pk_mul_f32 v[96:97], v[96:97], v[100:101] op_sel_hi:[1,0]
  v_pk_mul_f32 v[98:99], v[98:99], v[100:101] op_sel_hi:[1,0]
  v_cvt_pk_bf16_f32 v60, v92, v93
  v_cvt_pk_bf16_f32 v61, v94, v95
  v_cvt_pk_bf16_f32 v62, v96, v97
  v_cvt_pk_bf16_f32 v63, v98, v99
  v_add_f32 v116, v116, v84
  v_rcp_f32 v116, v116
  v_pk_add_f32 v[108:109], v[108:109], v[76:77]
  v_pk_add_f32 v[110:111], v[110:111], v[78:79]
  v_pk_add_f32 v[112:113], v[112:113], v[80:81]
  v_pk_add_f32 v[114:115], v[114:115], v[82:83]
  v_pk_mul_f32 v[108:109], v[108:109], v[116:117] op_sel_hi:[1,0]
  v_pk_mul_f32 v[110:111], v[110:111], v[116:117] op_sel_hi:[1,0]
  v_pk_mul_f32 v[112:113], v[112:113], v[116:117] op_sel_hi:[1,0]
  v_pk_mul_f32 v[114:115], v[114:115], v[116:117] op_sel_hi:[1,0]
  v_cvt_pk_bf16_f32 v76, v108, v109
  v_cvt_pk_bf16_f32 v77, v110, v111
  v_cvt_pk_bf16_f32 v78, v112, v113
  v_cvt_pk_bf16_f32 v79, v114, v115
  s_cmp_eq_u32 s62, 1
  s_cbranch_scc0 L_far_72
  buffer_store_dwordx4 v[60:63], v144, s[52:55], s85 offen
  buffer_store_dwordx4 v[76:79], v144, s[52:55], s85 offen offset:512
L_stored_73:
  s_barrier
  s_add_u32 m0, s89, 99840
  s_add_u32 s67, s88, 919296
  buffer_load_dwordx4 v16, s[24:27], s67 offen  lds
  s_add_u32 m0, s89, 100864
  s_nop 0
  buffer_load_dwordx4 v17, s[24:27], s67 offen  lds
  s_add_u32 m0, s89, 101888
  s_nop 0
  buffer_load_dwordx4 v18, s[24:27], s67 offen  lds
  s_add_u32 m0, s89, 102912
  s_nop 0
  buffer_load_dwordx4 v19, s[24:27], s67 offen  lds
  s_add_u32 m0, s89, 103936
  s_nop 0
  buffer_load_dwordx4 v20, s[24:27], s67 offen  lds
  s_add_u32 m0, s89, 104960
  s_nop 0
  buffer_load_dwordx4 v21, s[24:27], s67 offen  lds
  s_add_u32 m0, s89, 105984
  s_nop 0
  buffer_load_dwordx4 v22, s[24:27], s67 offen  lds
  v_bfe_u32 v6, v1, 3, 2
  v_and_b32 v7, 3, v1
  v_lshlrev_b32 v7, 3, v7
  v_lshrrev_b32 v8, 2, v1
  v_lshl_add_u32 v7, v8, 7, v7
  v_xor_b32_e64 v8, 0, v6
  v_lshl_add_u32 v24, v8, 5, v7
  v_xor_b32_e64 v8, 1, v6
  v_lshl_add_u32 v25, v8, 5, v7
  v_xor_b32_e64 v8, 2, v6
  v_lshl_add_u32 v26, v8, 5, v7
  v_xor_b32_e64 v8, 3, v6
  v_lshl_add_u32 v27, v8, 5, v7
  v_lshrrev_b32 v8, 5, v1
  v_lshlrev_b32 v8, 10, v8
  v_add_u32_e64 v40, v24, v8
  v_add_u32 v44, 66560, v40
  v_add_u32_e64 v41, v25, v8
  v_add_u32 v45, 66560, v41
  v_add_u32_e64 v42, v26, v8
  v_add_u32 v46, 66560, v42
  v_add_u32_e64 v43, v27, v8
  v_add_u32 v47, 66560, v43
  v_lshlrev_b32_e64 v10, 4, v3
  v_add_u32 v10, 161792, v10
  v_lshlrev_b32_e64 v96, 16, v28
  v_and_b32 v97, 0xffff0000, v28
  v_lshlrev_b32_e64 v98, 16, v29
  v_and_b32 v99, 0xffff0000, v29
  v_lshlrev_b32_e64 v100, 16, v30
  v_and_b32 v101, 0xffff0000, v30
  v_lshlrev_b32_e64 v102, 16, v31
  v_and_b32 v103, 0xffff0000, v31
  v_lshlrev_b32_e64 v104, 16, v32
  v_and_b32 v105, 0xffff0000, v32
  v_lshlrev_b32_e64 v106, 16, v33
  v_and_b32 v107, 0xffff0000, v33
  v_lshlrev_b32_e64 v108, 16, v34
  v_and_b32 v109, 0xffff0000, v34
  v_lshlrev_b32_e64 v110, 16, v35
  v_and_b32 v111, 0xffff0000, v35
  s_lshl_b32 s66, s56, 5
  s_add_u32 s66, s66, s101
  s_and_b32 s68, s66, 0xffffffc0
  s_add_u32 s68, s68, 512
  s_lshl_b32 s65, s59, 2
  s_add_u32 s66, s66, s65
  v_mov_b32 v12, s61
  v_and_b32 v13, 15, v1
  v_lshlrev_b32_e64 v13, 2, v13
  s_waitcnt vmcnt(7)
  s_mov_b64 exec, 1
  s_cmp_eq_u32 s62, 1
  s_cbranch_scc0 L_far_74
  buffer_store_dword v12, off, s[52:55], s66 offset:512
L_stored_75:
  s_mov_b64 exec, -1
  v_min3_u32 v6, v209, v211, v213
  v_max3_u32 v7, v209, v211, v213
  v_min3_u32 v6, v6, v215, v217
  v_max3_u32 v7, v7, v215, v217
  v_min3_u32 v6, v6, v219, v221
  v_max3_u32 v7, v7, v219, v221
  v_min_u32 v6, v6, v223
  v_max_u32 v7, v7, v223
  v_xor_b32 v6, s61, v6
  v_xor_b32 v7, s61, v7
  v_or_b32 v6, v6, v7
  v_cmp_ne_u32 vcc, 0, v6
  s_cbranch_vccnz L_rare_76
L_back_77:
  s_cmp_eq_u32 s56, 2
  s_cselect_b32 s65, 1.0, 0
  v_add_f32 v208, v208, v210
  v_add_f32 v212, v212, v214
  v_add_f32 v216, v216, v218
  v_add_f32 v220, v220, v222
  v_add_f32 v208, v208, v212
  v_add_f32 v216, v216, v220
  v_add_f32_e64 v208, v208, v216
  v_cvt_pk_bf16_f32 v208, v208, v208
  v_and_b32 v208, 0xffff0000, v208
  v_add_f32_e64 v208, s65, v208
  v_cvt_pk_bf16_f32 v208, v208, v208
  v_and_b32 v208, 0xffff0000, v208
  v_lshlrev_b32_e64 v11, 2, v0
  v_add_u32 v11, 161792, v11
  ds_write_b32 v11, v208
  ds_read_b64_tr_b16 v[36:37], v40 offset:0
  ds_read_b64_tr_b16 v[38:39], v40 offset:1024
  ds_read_b64_tr_b16 v[60:61], v41 offset:0
  ds_read_b64_tr_b16 v[62:63], v41 offset:1024
  ds_read_b64_tr_b16 v[76:77], v42 offset:0
  ds_read_b64_tr_b16 v[78:79], v42 offset:1024
  ds_read_b64_tr_b16 v[136:137], v43 offset:0
  ds_read_b64_tr_b16 v[138:139], v43 offset:1024
  ds_read_b64_tr_b16 v[140:141], v40 offset:4096
  ds_read_b64_tr_b16 v[142:143], v40 offset:5120
  ds_read_b64_tr_b16 v[144:145], v41 offset:4096
  ds_read_b64_tr_b16 v[146:147], v41 offset:5120
  s_waitcnt lgkmcnt(8)
  ds_read_b64_tr_b16 v[148:149], v42 offset:4096
  ds_read_b64_tr_b16 v[150:151], v42 offset:5120
  ds_read_b64_tr_b16 v[152:153], v43 offset:4096
  ds_read_b64_tr_b16 v[154:155], v43 offset:5120
  ds_read_b64_tr_b16 v[156:157], v40 offset:8192
  ds_read_b64_tr_b16 v[158:159], v40 offset:9216
  s_waitcnt lgkmcnt(8)
  ds_read_b64_tr_b16 v[160:161], v41 offset:8192
  ds_read_b64_tr_b16 v[162:163], v41 offset:9216
  ds_read_b64_tr_b16 v[164:165], v42 offset:8192
  ds_read_b64_tr_b16 v[166:167], v42 offset:9216
  ds_read_b64_tr_b16 v[168:169], v43 offset:8192
  ds_read_b64_tr_b16 v[170:171], v43 offset:9216
  s_waitcnt lgkmcnt(8)
  ds_read_b64_tr_b16 v[172:173], v40 offset:12288
  ds_read_b64_tr_b16 v[174:175], v40 offset:13312
  ds_read_b64_tr_b16 v[176:177], v41 offset:12288
  ds_read_b64_tr_b16 v[178:179], v41 offset:13312
  s_add_u32 s12, s19, 0
  s_add_u32 s13, s19, 4096
  s_add_u32 s14, s19, 8192
  s_add_u32 s15, s19, 12288
  buffer_load_dword v12, v13, s[52:55], s68 offen sc1
  ds_read_b64_tr_b16 v[180:181], v42 offset:12288
  ds_read_b64_tr_b16 v[182:183], v42 offset:13312
  s_waitcnt lgkmcnt(8)
  ds_read_b64_tr_b16 v[184:185], v43 offset:12288
  ds_read_b64_tr_b16 v[186:187], v43 offset:13312
  ds_read_b64_tr_b16 v[188:189], v40 offset:16384
  ds_read_b64_tr_b16 v[190:191], v40 offset:17408
  ds_read_b64_tr_b16 v[192:193], v41 offset:16384
  ds_read_b64_tr_b16 v[194:195], v41 offset:17408
  s_waitcnt lgkmcnt(8)
  ds_read_b64_tr_b16 v[196:197], v42 offset:16384
  ds_read_b64_tr_b16 v[198:199], v42 offset:17408
  ds_read_b64_tr_b16 v[200:201], v43 offset:16384
  ds_read_b64_tr_b16 v[202:203], v43 offset:17408
  ds_read_b64_tr_b16 v[204:205], v40 offset:20480
  ds_read_b64_tr_b16 v[206:207], v40 offset:21504
  s_waitcnt lgkmcnt(8)
  ds_read_b64_tr_b16 v[208:209], v41 offset:20480
  ds_read_b64_tr_b16 v[210:211], v41 offset:21504
  ds_read_b64_tr_b16 v[212:213], v42 offset:20480
  ds_read_b64_tr_b16 v[214:215], v42 offset:21504
  ds_read_b64_tr_b16 v[216:217], v43 offset:20480
  ds_read_b64_tr_b16 v[218:219], v43 offset:21504
  s_waitcnt lgkmcnt(8)
  ds_read_b64_tr_b16 v[220:221], v40 offset:24576
  ds_read_b64_tr_b16 v[222:223], v40 offset:25600
  ds_read_b64_tr_b16 v[224:225], v41 offset:24576
  ds_read_b64_tr_b16 v[226:227], v41 offset:25600
  ds_read_b64_tr_b16 v[228:229], v42 offset:24576
  ds_read_b64_tr_b16 v[230:231], v42 offset:25600
  s_waitcnt lgkmcnt(8)
  ds_read_b64_tr_b16 v[232:233], v43 offset:24576
  ds_read_b64_tr_b16 v[234:235], v43 offset:25600
  s_mov_b32 s64, s63
  s_waitcnt vmcnt(0)
  v_cmp_ne_u32 vcc, s61, v12
  s_cbranch_vccz L_pdone_82
L_again_81:
  buffer_load_dword v12, v13, s[52:55], s68 offen sc1
  s_waitcnt vmcnt(0)
  v_cmp_ne_u32 vcc, s61, v12
  s_cbranch_vccz L_pdone_82
  s_sub_u32 s64, s64, 1
  s_cbranch_scc0 L_again_81
  s_mov_b32 s63, 1
L_pdone_82:
  buffer_load_dwordx4 v[28:31], v4, s[52:55], s12 offen offset:0 sc1
  buffer_load_dwordx4 v[32:35], v4, s[52:55], s12 offen offset:1024 sc1
  buffer_load_dwordx4 v[48:51], v4, s[52:55], s12 offen offset:2048 sc1
  buffer_load_dwordx4 v[52:55], v4, s[52:55], s12 offen offset:3072 sc1
  buffer_load_dwordx4 v[56:59], v4, s[52:55], s13 offen offset:0 sc1
  buffer_load_dwordx4 v[64:67], v4, s[52:55], s13 offen offset:1024 sc1
  buffer_load_dwordx4 v[68:71], v4, s[52:55], s13 offen offset:2048 sc1
  v_mov_b32 v240, 0
  v_mov_b32 v241, 0
  v_mov_b32 v242, s61
  v_mov_b32_e64 v243, s61
  s_lshl_b32 s66, s56, 8
  s_add_u32 s65, s3, s66
  s_add_u32 s85, s65, 114688
  s_lshl_b32 s66, s59, 10
  s_add_u32 s86, s66, s85
  v_lshlrev_b32_e64 v11, 11, v3
  v_lshl_add_u32 v11, v2, 4, v11
  s_waitcnt vmcnt(6)
  v_mfma_f32_16x16x32_bf16 v[112:115], v[36:39], v[28:31], 0
  buffer_load_dwordx4 v[72:75], v4, s[52:55], s13 offen offset:3072 sc1
  ds_read_b64_tr_b16 v[236:237], v40 offset:28672
  ds_read_b64_tr_b16 v[238:239], v40 offset:29696
  v_mfma_f32_16x16x32_bf16 v[116:119], v[60:63], v[28:31], 0
  ds_read_b64_tr_b16 v[36:37], v41 offset:28672
  ds_read_b64_tr_b16 v[38:39], v41 offset:29696
  v_mfma_f32_16x16x32_bf16 v[120:123], v[76:79], v[28:31], 0
  s_waitcnt lgkmcnt(8)
  ds_read_b64_tr_b16 v[60:61], v42 offset:28672
  ds_read_b64_tr_b16 v[62:63], v42 offset:29696
  v_mfma_f32_16x16x32_bf16 v[124:127], v[136:139], v[28:31], 0
  ds_read_b64_tr_b16 v[76:77], v43 offset:28672
  ds_read_b64_tr_b16 v[78:79], v43 offset:29696
  s_waitcnt vmcnt(6)
  v_mfma_f32_16x16x32_bf16 v[112:115], v[140:143], v[32:35], v[112:115]
  buffer_load_dwordx4 v[128:131], v4, s[52:55], s14 offen offset:0 sc1
  ds_read_b64_tr_b16 v[136:137], v44 offset:0
  ds_read_b64_tr_b16 v[138:139], v44 offset:1024
  v_mfma_f32_16x16x32_bf16 v[116:119], v[144:147], v[32:35], v[116:119]
  s_waitcnt lgkmcnt(8)
  ds_read_b64_tr_b16 v[140:141], v45 offset:0
  ds_read_b64_tr_b16 v[142:143], v45 offset:1024
  v_mfma_f32_16x16x32_bf16 v[120:123], v[148:151], v[32:35], v[120:123]
  ds_read_b64_tr_b16 v[144:145], v46 offset:0
  ds_read_b64_tr_b16 v[146:147], v46 offset:1024
  v_mfma_f32_16x16x32_bf16 v[124:127], v[152:155], v[32:35], v[124:127]
  ds_read_b64_tr_b16 v[148:149], v47 offset:0
  ds_read_b64_tr_b16 v[150:151], v47 offset:1024
  s_waitcnt vmcnt(6)
  v_mfma_f32_16x16x32_bf16 v[112:115], v[156:159], v[48:51], v[112:115]
  buffer_load_dwordx4 v[132:135], v4, s[52:55], s14 offen offset:1024 sc1
  s_waitcnt lgkmcnt(8)
  ds_read_b64_tr_b16 v[152:153], v44 offset:4096
  ds_read_b64_tr_b16 v[154:155], v44 offset:5120
  v_mfma_f32_16x16x32_bf16 v[116:119], v[160:163], v[48:51], v[116:119]
  ds_read_b64_tr_b16 v[156:157], v45 offset:4096
  ds_read_b64_tr_b16 v[158:159], v45 offset:5120
  v_mfma_f32_16x16x32_bf16 v[120:123], v[164:167], v[48:51], v[120:123]
  ds_read_b64_tr_b16 v[160:161], v46 offset:4096
  ds_read_b64_tr_b16 v[162:163], v46 offset:5120
  v_mfma_f32_16x16x32_bf16 v[124:127], v[168:171], v[48:51], v[124:127]
  s_waitcnt lgkmcnt(8)
  ds_read_b64_tr_b16 v[164:165], v47 offset:4096
  ds_read_b64_tr_b16 v[166:167], v47 offset:5120
  s_waitcnt vmcnt(6)
  v_mfma_f32_16x16x32_bf16 v[112:115], v[172:175], v[52:55], v[112:115]
  buffer_load_dwordx4 v[28:31], v4, s[52:55], s14 offen offset:2048 sc1
  ds_read_b64_tr_b16 v[168:169], v44 offset:8192
  ds_read_b64_tr_b16 v[170:171], v44 offset:9216
  v_mfma_f32_16x16x32_bf16 v[116:119], v[176:179], v[52:55], v[116:119]
  ds_read_b64_tr_b16 v[172:173], v45 offset:8192
  ds_read_b64_tr_b16 v[174:175], v45 offset:9216
  v_mfma_f32_16x16x32_bf16 v[120:123], v[180:183], v[52:55], v[120:123]
  s_waitcnt lgkmcnt(8)
  ds_read_b64_tr_b16 v[176:177], v46 offset:8192
  ds_read_b64_tr_b16 v[178:179], v46 offset:9216
  v_mfma_f32_16x16x32_bf16 v[124:127], v[184:187], v[52:55], v[124:127]
  ds_read_b64_tr_b16 v[180:181], v47 offset:8192
  ds_read_b64_tr_b16 v[182:183], v47 offset:9216
  s_waitcnt vmcnt(6)
  v_mfma_f32_16x16x32_bf16 v[112:115], v[188:191], v[56:59], v[112:115]
  buffer_load_dwordx4 v[32:35], v4, s[52:55], s14 offen offset:3072 sc1
  ds_read_b64_tr_b16 v[184:185], v44 offset:12288
  ds_read_b64_tr_b16 v[186:187], v44 offset:13312
  v_mfma_f32_16x16x32_bf16 v[116:119], v[192:195], v[56:59], v[116:119]
  s_waitcnt lgkmcnt(8)
  ds_read_b64_tr_b16 v[188:189], v45 offset:12288
  ds_read_b64_tr_b16 v[190:191], v45 offset:13312
  v_mfma_f32_16x16x32_bf16 v[120:123], v[196:199], v[56:59], v[120:123]
  ds_read_b64_tr_b16 v[192:193], v46 offset:12288
  ds_read_b64_tr_b16 v[194:195], v46 offset:13312
  v_mfma_f32_16x16x32_bf16 v[124:127], v[200:203], v[56:59], v[124:127]
  ds_read_b64_tr_b16 v[196:197], v47 offset:12288
  ds_read_b64_tr_b16 v[198:199], v47 offset:13312
  s_waitcnt vmcnt(6)
  v_mfma_f32_16x16x32_bf16 v[112:115], v[204:207], v[64:67], v[112:115]
  buffer_load_dwordx4 v[48:51], v4, s[52:55], s15 offen offset:0 sc1
  s_waitcnt lgkmcnt(8)
  ds_read_b64_tr_b16 v[200:201], v44 offset:16384
  ds_read_b64_tr_b16 v[202:203], v44 offset:17408
  v_mfma_f32_16x16x32_bf16 v[116:119], v[208:211], v[64:67], v[116:119]
  ds_read_b64_tr_b16 v[204:205], v45 offset:16384
  ds_read_b64_tr_b16 v[206:207], v45 offset:17408
  v_mfma_f32_16x16x32_bf16 v[120:123], v[212:215], v[64:67], v[120:123]
  ds_read_b64_tr_b16 v[208:209], v46 offset:16384
  ds_read_b64_tr_b16 v[210:211], v46 offset:17408
  v_mfma_f32_16x16x32_bf16 v[124:127], v[216:219], v[64:67], v[124:127]
  s_waitcnt lgkmcnt(8)
  ds_read_b64_tr_b16 v[212:213], v47 offset:16384
  ds_read_b64_tr_b16 v[214:215], v47 offset:17408
  s_waitcnt vmcnt(6)
  v_mfma_f32_16x16x32_bf16 v[112:115], v[220:223], v[68:71], v[112:115]
  buffer_load_dwordx4 v[52:55], v4, s[52:55], s15 offen offset:1024 sc1
  ds_read_b64_tr_b16 v[216:217], v44 offset:20480
  ds_read_b64_tr_b16 v[218:219], v44 offset:21504
  v_mfma_f32_16x16x32_bf16 v[116:119], v[224:227], v[68:71], v[116:119]
  ds_read_b64_tr_b16 v[220:221], v45 offset:20480
  ds_read_b64_tr_b16 v[222:223], v45 offset:21504
  v_mfma_f32_16x16x32_bf16 v[120:123], v[228:231], v[68:71], v[120:123]
  s_waitcnt lgkmcnt(8)
  ds_read_b64_tr_b16 v[224:225], v46 offset:20480
  ds_read_b64_tr_b16 v[226:227], v46 offset:21504
  v_mfma_f32_16x16x32_bf16 v[124:127], v[232:235], v[68:71], v[124:127]
  ds_read_b64_tr_b16 v[228:229], v47 offset:20480
  ds_read_b64_tr_b16 v[230:231], v47 offset:21504
  s_waitcnt vmcnt(6)
  v_mfma_f32_16x16x32_bf16 v[112:115], v[236:239], v[72:75], v[112:115]
  buffer_load_dwordx4 v[56:59], v4, s[52:55], s15 offen offset:2048 sc1
  ds_read_b64_tr_b16 v[232:233], v44 offset:24576
  ds_read_b64_tr_b16 v[234:235], v44 offset:25600
  v_mfma_f32_16x16x32_bf16 v[116:119], v[36:39], v[72:75], v[116:119]
  s_waitcnt lgkmcnt(8)
  ds_read_b64_tr_b16 v[236:237], v45 offset:24576
  ds_read_b64_tr_b16 v[238:239], v45 offset:25600
  v_mfma_f32_16x16x32_bf16 v[120:123], v[60:63], v[72:75], v[120:123]
  ds_read_b64_tr_b16 v[36:37], v46 offset:24576
  ds_read_b64_tr_b16 v[38:39], v46 offset:25600
  v_mfma_f32_16x16x32_bf16 v[124:127], v[76:79], v[72:75], v[124:127]
  ds_read_b64_tr_b16 v[60:61], v47 offset:24576
  ds_read_b64_tr_b16 v[62:63], v47 offset:25600
  s_waitcnt vmcnt(6)
  v_mfma_f32_16x16x32_bf16 v[112:115], v[136:139], v[128:131], v[112:115]
  buffer_load_dwordx4 v[64:67], v4, s[52:55], s15 offen offset:3072 sc1
  s_waitcnt lgkmcnt(8)
  ds_read_b64_tr_b16 v[76:77], v44 offset:28672
  ds_read_b64_tr_b16 v[78:79], v44 offset:29696
  v_mfma_f32_16x16x32_bf16 v[116:119], v[140:143], v[128:131], v[116:119]
  ds_read_b64_tr_b16 v[136:137], v45 offset:28672
  ds_read_b64_tr_b16 v[138:139], v45 offset:29696
  v_mfma_f32_16x16x32_bf16 v[120:123], v[144:147], v[128:131], v[120:123]
  ds_read_b64_tr_b16 v[140:141], v46 offset:28672
  ds_read_b64_tr_b16 v[142:143], v46 offset:29696
  v_mfma_f32_16x16x32_bf16 v[124:127], v[148:151], v[128:131], v[124:127]
  s_waitcnt lgkmcnt(8)
  ds_read_b64_tr_b16 v[144:145], v47 offset:28672
  ds_read_b64_tr_b16 v[146:147], v47 offset:29696
  s_waitcnt vmcnt(6)
  v_mfma_f32_16x16x32_bf16 v[112:115], v[152:155], v[132:135], v[112:115]
  v_mfma_f32_16x16x32_bf16 v[116:119], v[156:159], v[132:135], v[116:119]
  v_mfma_f32_16x16x32_bf16 v[120:123], v[160:163], v[132:135], v[120:123]
  v_mfma_f32_16x16x32_bf16 v[124:127], v[164:167], v[132:135], v[124:127]
  s_barrier
  ds_read_b128 v[80:83], v10 offset:0
  ds_read_b128 v[84:87], v10 offset:64
  ds_read_b128 v[88:91], v10 offset:128
  ds_read_b128 v[92:95], v10 offset:192
  s_waitcnt vmcnt(5)
  v_mfma_f32_16x16x32_bf16 v[112:115], v[168:171], v[28:31], v[112:115]
  v_mfma_f32_16x16x32_bf16 v[116:119], v[172:175], v[28:31], v[116:119]
  v_mfma_f32_16x16x32_bf16 v[120:123], v[176:179], v[28:31], v[120:123]
  v_mfma_f32_16x16x32_bf16 v[124:127], v[180:183], v[28:31], v[124:127]
  s_waitcnt vmcnt(4)
  v_mfma_f32_16x16x32_bf16 v[112:115], v[184:187], v[32:35], v[112:115]
  v_mfma_f32_16x16x32_bf16 v[116:119], v[188:191], v[32:35], v[116:119]
  v_mfma_f32_16x16x32_bf16 v[120:123], v[192:195], v[32:35], v[120:123]
  v_mfma_f32_16x16x32_bf16 v[124:127], v[196:199], v[32:35], v[124:127]
  s_waitcnt vmcnt(3)
  v_mfma_f32_16x16x32_bf16 v[112:115], v[200:203], v[48:51], v[112:115]
  v_mfma_f32_16x16x32_bf16 v[116:119], v[204:207], v[48:51], v[116:119]
  v_mfma_f32_16x16x32_bf16 v[120:123], v[208:211], v[48:51], v[120:123]
  v_mfma_f32_16x16x32_bf16 v[124:127], v[212:215], v[48:51], v[124:127]
  s_waitcnt vmcnt(2)
  v_mfma_f32_16x16x32_bf16 v[112:115], v[216:219], v[52:55], v[112:115]
  v_mfma_f32_16x16x32_bf16 v[116:119], v[220:223], v[52:55], v[116:119]
  v_mfma_f32_16x16x32_bf16 v[120:123], v[224:227], v[52:55], v[120:123]
  v_mfma_f32_16x16x32_bf16 v[124:127], v[228:231], v[52:55], v[124:127]
  s_waitcnt vmcnt(1)
  v_mfma_f32_16x16x32_bf16 v[112:115], v[232:235], v[56:59], v[112:115]
  v_mfma_f32_16x16x32_bf16 v[116:119], v[236:239], v[56:59], v[116:119]
  v_mfma_f32_16x16x32_bf16 v[120:123], v[36:39], v[56:59], v[120:123]
  s_waitcnt lgkmcnt(6)
  v_mfma_f32_16x16x32_bf16 v[124:127], v[60:63], v[56:59], v[124:127]
  s_waitcnt vmcnt(0)
  v_mfma_f32_16x16x32_bf16 v[112:115], v[76:79], v[64:67], v[112:115]
  v_mfma_f32_16x16x32_bf16 v[116:119], v[136:139], v[64:67], v[116:119]
  v_mfma_f32_16x16x32_bf16 v[120:123], v[140:143], v[64:67], v[120:123]
  s_waitcnt lgkmcnt(4)
  v_mfma_f32_16x16x32_bf16 v[124:127], v[144:147], v[64:67], v[124:127]
  s_waitcnt lgkmcnt(0)
  s_nop 2
  v_pk_fma_f32 v[112:113], v[112:113], v[80:81], v[96:97]
  v_pk_fma_f32 v[114:115], v[114:115], v[82:83], v[98:99]
  v_pk_fma_f32 v[116:117], v[116:117], v[84:85], v[100:101]
  v_pk_fma_f32 v[118:119], v[118:119], v[86:87], v[102:103]
  v_pk_fma_f32 v[120:121], v[120:121], v[88:89], v[104:105]
  v_pk_fma_f32 v[122:123], v[122:123], v[90:91], v[106:107]
  v_pk_fma_f32 v[124:125], v[124:125], v[92:93], v[108:109]
  v_pk_fma_f32 v[126:127], v[126:127], v[94:95], v[110:111]
  v_cvt_pk_bf16_f32 v28, v112, v113
  v_cvt_pk_bf16_f32 v29, v114, v115
  v_cvt_pk_bf16_f32 v30, v116, v117
  v_cvt_pk_bf16_f32 v31, v118, v119
  v_cvt_pk_bf16_f32 v32, v120, v121
  v_cvt_pk_bf16_f32 v33, v122, v123
  v_cvt_pk_bf16_f32 v34, v124, v125
  v_cvt_pk_bf16_f32 v35, v126, v127
  v_dot2c_f32_bf16 v240, s69, v28
  v_dot2c_f32_bf16 v241, v28, v28
  v_dot2c_f32_bf16 v240, s69, v29
  v_dot2c_f32_bf16 v241, v29, v29
  v_dot2c_f32_bf16 v240, s69, v30
  v_dot2c_f32_bf16 v241, v30, v30
  v_dot2c_f32_bf16 v240, s69, v31
  v_dot2c_f32_bf16 v241, v31, v31
  v_dot2c_f32_bf16 v240, s69, v32
  v_dot2c_f32_bf16 v241, v32, v32
  v_dot2c_f32_bf16 v240, s69, v33
  v_dot2c_f32_bf16 v241, v33, v33
  v_dot2c_f32_bf16 v240, s69, v34
  v_dot2c_f32_bf16 v241, v34, v34
  v_dot2c_f32_bf16 v240, s69, v35
  v_dot2c_f32_bf16 v241, v35, v35
  s_nop 2
  v_permlane16_swap_b32 v240, v241
  v_add_f32 v240, v240, v241
  v_mov_b32 v241, v240
  s_nop 1
  v_permlane32_swap_b32 v240, v241
  v_add_f32 v240, v240, v241
  v_mov_b32_e64 v241, v240
  s_nop 1
  v_permlane16_swap_b32 v240, v241
  s_mov_b64 exec, 0xffff
  s_cmp_eq_u32 s62, 1
  s_cbranch_scc0 L_far_83
  buffer_store_dwordx4 v[240:243], v4, s[52:55], s86 offen
L_stored_84:
  s_mov_b64 exec, -1
  s_barrier
  ds_read_b128 v[80:83], v10 offset:512
  ds_read_b128 v[84:87], v10 offset:576
  ds_read_b128 v[88:91], v10 offset:640
  ds_read_b128 v[92:95], v10 offset:704
  ds_read_b128 v[112:115], v10 offset:256
  ds_read_b128 v[116:119], v10 offset:320
  ds_read_b128 v[120:123], v10 offset:384
  ds_read_b128 v[124:127], v10 offset:448
  v_lshlrev_b32_e64 v96, 16, v28
  v_and_b32 v97, 0xffff0000, v28
  v_lshlrev_b32_e64 v98, 16, v29
  v_and_b32 v99, 0xffff0000, v29
  v_lshlrev_b32_e64 v100, 16, v30
  v_and_b32 v101, 0xffff0000, v30
  v_lshlrev_b32_e64 v102, 16, v31
  v_and_b32 v103, 0xffff0000, v31
  v_lshlrev_b32_e64 v104, 16, v32
  v_and_b32 v105, 0xffff0000, v32
  v_lshlrev_b32_e64 v106, 16, v33
  v_and_b32 v107, 0xffff0000, v33
  v_lshlrev_b32_e64 v108, 16, v34
  v_and_b32 v109, 0xffff0000, v34
  v_lshlrev_b32_e64 v110, 16, v35
  v_and_b32 v111, 0xffff0000, v35
  s_mov_b32 s64, s63
L_poll_85:
  buffer_load_dwordx4 v[36:39], v11, s[52:55], s85 offen sc1
  buffer_load_dwordx4 v[40:43], v11, s[52:55], s85 offen offset:1024 sc1
  s_sub_u32 s64, s64, 1
  s_cbranch_scc1 L_giveup_87
  s_waitcnt vmcnt(0)
  v_xor_b32 v38, v38, v43
  v_xor_b32 v42, v42, v39
  v_xor_b32 v39, s61, v39
  v_xor_b32 v43, s61, v43
  v_or3_b32 v38, v38, v42, v39
  v_or_b32 v38, v38, v43
  v_cmp_ne_u32 vcc, 0, v38
  s_cbranch_vccnz L_poll_85
L_pdone_86:
  v_add_f32 v240, v36, v40
  v_add_f32 v241, v37, v41
  s_nop 1
  v_permlane16_swap_b32 v240, v241
  v_add_f32 v240, v240, v241
  v_mov_b32 v241, v240
  s_nop 1
  v_permlane32_swap_b32 v240, v241
  v_add_f32 v240, v240, v241
  v_mov_b32_e64 v241, v240
  s_nop 1
  v_permlane16_swap_b32 v240, v241
  v_mul_f32 v240, 0x3b000000, v240
  v_mul_f32_e64 v12, v240, v240
  s_mov_b32 s65, 0x3b000000
  v_fma_f32 v241, v241, s65, -v12
  v_max_f32_e64 v241, 0, v241
  v_add_f32 v241, 0x3727c5ac, v241
  v_rsq_f32 v241, v241
  s_nop 0
  v_mul_f32_e64 v240, -v240, v241
  s_waitcnt lgkmcnt(0)
  s_lshl_b32 s65, s59, 11
  s_add_u32 s65, s65, s19
  s_add_u32 s85, s65, 0
  v_pk_fma_f32 v[96:97], v[96:97], v[240:241], v[240:241] op_sel:[0,1,0] op_sel_hi:[1,1,0]
  v_pk_fma_f32 v[98:99], v[98:99], v[240:241], v[240:241] op_sel:[0,1,0] op_sel_hi:[1,1,0]
  v_pk_fma_f32 v[100:101], v[100:101], v[240:241], v[240:241] op_sel:[0,1,0] op_sel_hi:[1,1,0]
  v_pk_fma_f32 v[102:103], v[102:103], v[240:241], v[240:241] op_sel:[0,1,0] op_sel_hi:[1,1,0]
  v_pk_fma_f32 v[104:105], v[104:105], v[240:241], v[240:241] op_sel:[0,1,0] op_sel_hi:[1,1,0]
  v_pk_fma_f32 v[106:107], v[106:107], v[240:241], v[240:241] op_sel:[0,1,0] op_sel_hi:[1,1,0]
  v_pk_fma_f32 v[108:109], v[108:109], v[240:241], v[240:241] op_sel:[0,1,0] op_sel_hi:[1,1,0]
  v_pk_fma_f32 v[110:111], v[110:111], v[240:241], v[240:241] op_sel:[0,1,0] op_sel_hi:[1,1,0]
  v_pk_fma_f32 v[96:97], v[96:97], v[80:81], v[112:113]
  v_pk_fma_f32 v[98:99], v[98:99], v[82:83], v[114:115]
  v_pk_fma_f32 v[100:101], v[100:101], v[84:85], v[116:117]
  v_pk_fma_f32 v[102:103], v[102:103], v[86:87], v[118:119]
  v_pk_fma_f32 v[104:105], v[104:105], v[88:89], v[120:121]
  v_pk_fma_f32 v[106:107], v[106:107], v[90:91], v[122:123]
  v_pk_fma_f32 v[108:109], v[108:109], v[92:93], v[124:125]
  v_pk_fma_f32 v[110:111], v[110:111], v[94:95], v[126:127]
  v_cvt_pk_bf16_f32 v96, v96, v97
  v_cvt_pk_bf16_f32 v97, v98, v99
  v_cvt_pk_bf16_f32 v98, v100, v101
  v_cvt_pk_bf16_f32 v99, v102, v103
  v_cvt_pk_bf16_f32 v100, v104, v105
  v_cvt_pk_bf16_f32 v101, v106, v107
  v_cvt_pk_bf16_f32 v102, v108, v109
  v_cvt_pk_bf16_f32 v103, v110, v111
  s_cmp_eq_u32 s62, 1
  s_cbranch_scc0 L_far_88
  buffer_store_dwordx4 v[96:99], v4, s[52:55], s85 offen
  buffer_store_dwordx4 v[100:103], v4, s[52:55], s85 offen offset:1024
L_stored_89:
  s_add_u32 m0, s89, 0
  s_add_u32 s67, s88, 1378048
  buffer_load_dwordx4 v16, s[24:27], s67 offen  lds
  s_add_u32 m0, s89, 1024
  s_nop 0
  buffer_load_dwordx4 v17, s[24:27], s67 offen  lds
  s_add_u32 m0, s89, 2048
  s_nop 0
  buffer_load_dwordx4 v18, s[24:27], s67 offen  lds
  s_add_u32 m0, s89, 3072
  s_nop 0
  buffer_load_dwordx4 v19, s[24:27], s67 offen  lds
  s_add_u32 m0, s89, 4096
  s_nop 0
  buffer_load_dwordx4 v20, s[24:27], s67 offen  lds
  s_add_u32 m0, s89, 5120
  s_nop 0
  buffer_load_dwordx4 v21, s[24:27], s67 offen  lds
  s_add_u32 m0, s89, 6144
  s_nop 0
  buffer_load_dwordx4 v22, s[24:27], s67 offen  lds
  v_lshrrev_b32 v6, 2, v1
  v_mul_u32_u24 v6, 224, v6
  v_and_b32_e64 v7, 3, v1
  v_lshl_add_u32 v11, v7, 3, v6
  v_add_u32 v12, 0xe000, v11
  v_add_u32 v13, 0x1c000, v11
  s_lshl_b32 s66, s56, 5
  s_add_u32 s66, s66, s101
  s_and_b32 s68, s66, 0xffffffe0
  s_add_u32 s68, s68, 1024
  s_lshl_b32 s65, s59, 2
  s_add_u32 s66, s66, s65
  v_mov_b32 v23, s61
  v_and_b32 v64, 7, v1
  v_lshlrev_b32_e64 v64, 2, v64
  s_waitcnt vmcnt(7)
  s_mov_b64 exec, 1
  s_cmp_eq_u32 s62, 1
  s_cbranch_scc0 L_far_90
  buffer_store_dword v23, off, s[52:55], s66 offset:1024
L_stored_91:
  s_mov_b64 exec, -1
  ds_read_b64_tr_b16 v[68:69], v13 offset:18432
  ds_read_b64_tr_b16 v[70:71], v13 offset:22016
  ds_read_b64_tr_b16 v[72:73], v13 offset:18464
  ds_read_b64_tr_b16 v[74:75], v13 offset:22048
  ds_read_b64_tr_b16 v[76:77], v13 offset:18496
  ds_read_b64_tr_b16 v[78:79], v13 offset:22080
  ds_read_b64_tr_b16 v[80:81], v13 offset:18528
  ds_read_b64_tr_b16 v[82:83], v13 offset:22112
  ds_read_b64_tr_b16 v[84:85], v13 offset:18560
  ds_read_b64_tr_b16 v[86:87], v13 offset:22144
  ds_read_b64_tr_b16 v[88:89], v13 offset:18592
  ds_read_b64_tr_b16 v[90:91], v13 offset:22176
  ds_read_b64_tr_b16 v[92:93], v13 offset:18624
  ds_read_b64_tr_b16 v[94:95], v13 offset:22208
  s_waitcnt lgkmcnt(8)
  ds_read_b64_tr_b16 v[96:97], v13 offset:25600
  ds_read_b64_tr_b16 v[98:99], v13 offset:29184
  ds_read_b64_tr_b16 v[100:101], v13 offset:25632
  ds_read_b64_tr_b16 v[102:103], v13 offset:29216
  ds_read_b64_tr_b16 v[168:169], v13 offset:25664
  ds_read_b64_tr_b16 v[170:171], v13 offset:29248
  s_waitcnt lgkmcnt(8)
  ds_read_b64_tr_b16 v[172:173], v13 offset:25696
  ds_read_b64_tr_b16 v[174:175], v13 offset:29280
  ds_read_b64_tr_b16 v[176:177], v13 offset:25728
  ds_read_b64_tr_b16 v[178:179], v13 offset:29312
  ds_read_b64_tr_b16 v[180:181], v13 offset:25760
  ds_read_b64_tr_b16 v[182:183], v13 offset:29344
  s_waitcnt lgkmcnt(8)
  ds_read_b64_tr_b16 v[184:185], v13 offset:25792
  ds_read_b64_tr_b16 v[186:187], v13 offset:29376
  s_add_u32 s12, s19, 0
  s_add_u32 s13, s19, 4096
  s_add_u32 s14, s19, 8192
  s_add_u32 s15, s19, 12288
  buffer_load_dword v23, v64, s[52:55], s68 offen sc1
  ds_read_b64_tr_b16 v[188:189], v13 offset:32768
  ds_read_b64_tr_b16 v[190:191], v13 offset:36352
  ds_read_b64_tr_b16 v[192:193], v13 offset:32800
  ds_read_b64_tr_b16 v[194:195], v13 offset:36384
  s_waitcnt lgkmcnt(8)
  ds_read_b64_tr_b16 v[196:197], v13 offset:32832
  ds_read_b64_tr_b16 v[198:199], v13 offset:36416
  ds_read_b64_tr_b16 v[200:201], v13 offset:32864
  ds_read_b64_tr_b16 v[202:203], v13 offset:36448
  ds_read_b64_tr_b16 v[204:205], v13 offset:32896
  ds_read_b64_tr_b16 v[206:207], v13 offset:36480
  s_waitcnt lgkmcnt(8)
  ds_read_b64_tr_b16 v[208:209], v13 offset:32928
  ds_read_b64_tr_b16 v[210:211], v13 offset:36512
  ds_read_b64_tr_b16 v[212:213], v13 offset:32960
  ds_read_b64_tr_b16 v[214:215], v13 offset:36544
  ds_read_b64_tr_b16 v[216:217], v13 offset:39936
  ds_read_b64_tr_b16 v[218:219], v13 offset:43520
  s_waitcnt lgkmcnt(8)
  ds_read_b64_tr_b16 v[220:221], v13 offset:39968
  ds_read_b64_tr_b16 v[222:223], v13 offset:43552
  ds_read_b64_tr_b16 v[224:225], v13 offset:40000
  ds_read_b64_tr_b16 v[226:227], v13 offset:43584
  ds_read_b64_tr_b16 v[228:229], v13 offset:40032
  ds_read_b64_tr_b16 v[230:231], v13 offset:43616
  s_waitcnt lgkmcnt(8)
  ds_read_b64_tr_b16 v[232:233], v13 offset:40064
  ds_read_b64_tr_b16 v[234:235], v13 offset:43648
  ds_read_b64_tr_b16 v[236:237], v13 offset:40096
  ds_read_b64_tr_b16 v[238:239], v13 offset:43680
  ds_read_b64_tr_b16 v[240:241], v13 offset:40128
  ds_read_b64_tr_b16 v[242:243], v13 offset:43712
  s_mov_b32 s64, s63
  s_waitcnt vmcnt(0)
  v_cmp_ne_u32 vcc, s61, v23
  s_cbranch_vccz L_pdone_93
L_again_92:
  buffer_load_dword v23, v64, s[52:55], s68 offen sc1
  s_waitcnt vmcnt(0)
  v_cmp_ne_u32 vcc, s61, v23
  s_cbranch_vccz L_pdone_93
  s_sub_u32 s64, s64, 1
  s_cbranch_scc0 L_again_92
  s_mov_b32 s63, 1
L_pdone_93:
  buffer_load_dwordx4 v[104:107], v4, s[52:55], s12 offen offset:0 sc1
  buffer_load_dwordx4 v[108:111], v4, s[52:55], s12 offen offset:1024 sc1
  buffer_load_dwordx4 v[112:115], v4, s[52:55], s12 offen offset:2048 sc1
  buffer_load_dwordx4 v[116:119], v4, s[52:55], s12 offen offset:3072 sc1
  v_mov_b32 v64, 0
  v_mov_b32 v65, 0
  v_mov_b32 v66, s61
  v_mov_b32_e64 v67, s61
  s_lshl_b32 s66, s56, 8
  s_add_u32 s65, s3, s66
  s_add_u32 s85, s65, 122880
  s_lshl_b32 s66, s59, 10
  s_add_u32 s86, s66, s85
  v_lshlrev_b32_e64 v23, 11, v3
  v_lshl_add_u32 v23, v2, 4, v23
  s_waitcnt vmcnt(3)
  v_mfma_f32_16x16x32_bf16 v[36:39], v[68:71], v[104:107], 0
  buffer_load_dwordx4 v[120:123], v4, s[52:55], s13 offen offset:0 sc1
  s_waitcnt lgkmcnt(8)
  ds_read_b64_tr_b16 v[244:245], v11 offset:33280
  ds_read_b64_tr_b16 v[246:247], v11 offset:36864
  v_mfma_f32_16x16x32_bf16 v[40:43], v[72:75], v[104:107], 0
  ds_read_b64_tr_b16 v[68:69], v11 offset:33312
  ds_read_b64_tr_b16 v[70:71], v11 offset:36896
  v_mfma_f32_16x16x32_bf16 v[44:47], v[76:79], v[104:107], 0
  ds_read_b64_tr_b16 v[72:73], v11 offset:33344
  ds_read_b64_tr_b16 v[74:75], v11 offset:36928
  v_mfma_f32_16x16x32_bf16 v[48:51], v[80:83], v[104:107], 0
  s_waitcnt lgkmcnt(8)
  ds_read_b64_tr_b16 v[76:77], v11 offset:33376
  ds_read_b64_tr_b16 v[78:79], v11 offset:36960
  v_mfma_f32_16x16x32_bf16 v[52:55], v[84:87], v[104:107], 0
  buffer_load_dwordx4 v[124:127], v4, s[52:55], s13 offen offset:1024 sc1
  ds_read_b64_tr_b16 v[80:81], v11 offset:33408
  ds_read_b64_tr_b16 v[82:83], v11 offset:36992
  v_mfma_f32_16x16x32_bf16 v[56:59], v[88:91], v[104:107], 0
  ds_read_b64_tr_b16 v[84:85], v11 offset:33440
  ds_read_b64_tr_b16 v[86:87], v11 offset:37024
  v_mfma_f32_16x16x32_bf16 v[60:63], v[92:95], v[104:107], 0
  s_waitcnt lgkmcnt(8)
  ds_read_b64_tr_b16 v[88:89], v11 offset:33472
  ds_read_b64_tr_b16 v[90:91], v11 offset:37056
  s_waitcnt vmcnt(4)
  v_mfma_f32_16x16x32_bf16 v[36:39], v[96:99], v[108:111], v[36:39]
  ds_read_b64_tr_b16 v[92:93], v11 offset:40448
  ds_read_b64_tr_b16 v[94:95], v11 offset:44032
  v_mfma_f32_16x16x32_bf16 v[40:43], v[100:103], v[108:111], v[40:43]
  buffer_load_dwordx4 v[128:131], v4, s[52:55], s13 offen offset:2048 sc1
  ds_read_b64_tr_b16 v[96:97], v11 offset:40480
  ds_read_b64_tr_b16 v[98:99], v11 offset:44064
  v_mfma_f32_16x16x32_bf16 v[44:47], v[168:171], v[108:111], v[44:47]
  s_waitcnt lgkmcnt(8)
  ds_read_b64_tr_b16 v[100:101], v11 offset:40512
  ds_read_b64_tr_b16 v[102:103], v11 offset:44096
  v_mfma_f32_16x16x32_bf16 v[48:51], v[172:175], v[108:111], v[48:51]
  ds_read_b64_tr_b16 v[168:169], v11 offset:40544
  ds_read_b64_tr_b16 v[170:171], v11 offset:44128
  v_mfma_f32_16x16x32_bf16 v[52:55], v[176:179], v[108:111], v[52:55]
  ds_read_b64_tr_b16 v[172:173], v11 offset:40576
  ds_read_b64_tr_b16 v[174:175], v11 offset:44160
  v_mfma_f32_16x16x32_bf16 v[56:59], v[180:183], v[108:111], v[56:59]
  buffer_load_dwordx4 v[132:135], v4, s[52:55], s13 offen offset:3072 sc1
  s_waitcnt lgkmcnt(8)
  ds_read_b64_tr_b16 v[176:177], v11 offset:40608
  ds_read_b64_tr_b16 v[178:179], v11 offset:44192
  v_mfma_f32_16x16x32_bf16 v[60:63], v[184:187], v[108:111], v[60:63]
  ds_read_b64_tr_b16 v[180:181], v11 offset:40640
  ds_read_b64_tr_b16 v[182:183], v11 offset:44224
  s_waitcnt vmcnt(5)
  v_mfma_f32_16x16x32_bf16 v[36:39], v[188:191], v[112:115], v[36:39]
  ds_read_b64_tr_b16 v[184:185], v11 offset:47616
  ds_read_b64_tr_b16 v[186:187], v11 offset:51200
  v_mfma_f32_16x16x32_bf16 v[40:43], v[192:195], v[112:115], v[40:43]
  s_waitcnt lgkmcnt(8)
  ds_read_b64_tr_b16 v[188:189], v11 offset:47648
  ds_read_b64_tr_b16 v[190:191], v11 offset:51232
  v_mfma_f32_16x16x32_bf16 v[44:47], v[196:199], v[112:115], v[44:47]
  buffer_load_dwordx4 v[136:139], v4, s[52:55], s14 offen offset:0 sc1
  ds_read_b64_tr_b16 v[192:193], v11 offset:47680
  ds_read_b64_tr_b16 v[194:195], v11 offset:51264
  v_mfma_f32_16x16x32_bf16 v[48:51], v[200:203], v[112:115], v[48:51]
  ds_read_b64_tr_b16 v[196:197], v11 offset:47712
  ds_read_b64_tr_b16 v[198:199], v11 offset:51296
  v_mfma_f32_16x16x32_bf16 v[52:55], v[204:207], v[112:115], v[52:55]
  s_waitcnt lgkmcnt(8)
  ds_read_b64_tr_b16 v[200:201], v11 offset:47744
  ds_read_b64_tr_b16 v[202:203], v11 offset:51328
  v_mfma_f32_16x16x32_bf16 v[56:59], v[208:211], v[112:115], v[56:59]
  ds_read_b64_tr_b16 v[204:205], v11 offset:47776
  ds_read_b64_tr_b16 v[206:207], v11 offset:51360
  v_mfma_f32_16x16x32_bf16 v[60:63], v[212:215], v[112:115], v[60:63]
  buffer_load_dwordx4 v[140:143], v4, s[52:55], s14 offen offset:1024 sc1
  ds_read_b64_tr_b16 v[208:209], v11 offset:47808
  ds_read_b64_tr_b16 v[210:211], v11 offset:51392
  s_waitcnt vmcnt(6)
  v_mfma_f32_16x16x32_bf16 v[36:39], v[216:219], v[116:119], v[36:39]
  s_waitcnt lgkmcnt(8)
  ds_read_b64_tr_b16 v[212:213], v11 offset:54784
  ds_read_b64_tr_b16 v[214:215], v11 offset:58368
  v_mfma_f32_16x16x32_bf16 v[40:43], v[220:223], v[116:119], v[40:43]
  ds_read_b64_tr_b16 v[216:217], v11 offset:54816
  ds_read_b64_tr_b16 v[218:219], v11 offset:58400
  v_mfma_f32_16x16x32_bf16 v[44:47], v[224:227], v[116:119], v[44:47]
  ds_read_b64_tr_b16 v[220:221], v11 offset:54848
  ds_read_b64_tr_b16 v[222:223], v11 offset:58432
  v_mfma_f32_16x16x32_bf16 v[48:51], v[228:231], v[116:119], v[48:51]
  buffer_load_dwordx4 v[144:147], v4, s[52:55], s14 offen offset:2048 sc1
  s_waitcnt lgkmcnt(8)
  ds_read_b64_tr_b16 v[224:225], v11 offset:54880
  ds_read_b64_tr_b16 v[226:227], v11 offset:58464
  v_mfma_f32_16x16x32_bf16 v[52:55], v[232:235], v[116:119], v[52:55]
  ds_read_b64_tr_b16 v[228:229], v11 offset:54912
  ds_read_b64_tr_b16 v[230:231], v11 offset:58496
  v_mfma_f32_16x16x32_bf16 v[56:59], v[236:239], v[116:119], v[56:59]
  ds_read_b64_tr_b16 v[232:233], v11 offset:54944
  ds_read_b64_tr_b16 v[234:235], v11 offset:58528
  v_mfma_f32_16x16x32_bf16 v[60:63], v[240:243], v[116:119], v[60:63]
  s_waitcnt lgkmcnt(8)
  ds_read_b64_tr_b16 v[236:237], v11 offset:54976
  ds_read_b64_tr_b16 v[238:239], v11 offset:58560
  s_waitcnt vmcnt(6)
  v_mfma_f32_16x16x32_bf16 v[36:39], v[244:247], v[120:123], v[36:39]
  buffer_load_dwordx4 v[148:151], v4, s[52:55], s14 offen offset:3072 sc1
  ds_read_b64_tr_b16 v[240:241], v12 offset:42496
  ds_read_b64_tr_b16 v[242:243], v12 offset:46080
  v_mfma_f32_16x16x32_bf16 v[40:43], v[68:71], v[120:123], v[40:43]
  ds_read_b64_tr_b16 v[244:245], v12 offset:42528
  ds_read_b64_tr_b16 v[246:247], v12 offset:46112
  v_mfma_f32_16x16x32_bf16 v[44:47], v[72:75], v[120:123], v[44:47]
  s_waitcnt lgkmcnt(8)
  ds_read_b64_tr_b16 v[68:69], v12 offset:42560
  ds_read_b64_tr_b16 v[70:71], v12 offset:46144
  v_mfma_f32_16x16x32_bf16 v[48:51], v[76:79], v[120:123], v[48:51]
  ds_read_b64_tr_b16 v[72:73], v12 offset:42592
  ds_read_b64_tr_b16 v[74:75], v12 offset:46176
  v_mfma_f32_16x16x32_bf16 v[52:55], v[80:83], v[120:123], v[52:55]
  buffer_load_dwordx4 v[152:155], v4, s[52:55], s15 offen offset:0 sc1
  ds_read_b64_tr_b16 v[76:77], v12 offset:42624
  ds_read_b64_tr_b16 v[78:79], v12 offset:46208
  v_mfma_f32_16x16x32_bf16 v[56:59], v[84:87], v[120:123], v[56:59]
  s_waitcnt lgkmcnt(8)
  ds_read_b64_tr_b16 v[80:81], v12 offset:42656
  ds_read_b64_tr_b16 v[82:83], v12 offset:46240
  v_mfma_f32_16x16x32_bf16 v[60:63], v[88:91], v[120:123], v[60:63]
  ds_read_b64_tr_b16 v[84:85], v12 offset:42688
  ds_read_b64_tr_b16 v[86:87], v12 offset:46272
  s_waitcnt vmcnt(7)
  v_mfma_f32_16x16x32_bf16 v[36:39], v[92:95], v[124:127], v[36:39]
  ds_read_b64_tr_b16 v[88:89], v12 offset:49664
  ds_read_b64_tr_b16 v[90:91], v12 offset:53248
  v_mfma_f32_16x16x32_bf16 v[40:43], v[96:99], v[124:127], v[40:43]
  buffer_load_dwordx4 v[156:159], v4, s[52:55], s15 offen offset:1024 sc1
  s_waitcnt lgkmcnt(8)
  ds_read_b64_tr_b16 v[92:93], v12 offset:49696
  ds_read_b64_tr_b16 v[94:95], v12 offset:53280
  v_mfma_f32_16x16x32_bf16 v[44:47], v[100:103], v[124:127], v[44:47]
  ds_read_b64_tr_b16 v[96:97], v12 offset:49728
  ds_read_b64_tr_b16 v[98:99], v12 offset:53312
  v_mfma_f32_16x16x32_bf16 v[48:51], v[168:171], v[124:127], v[48:51]
  ds_read_b64_tr_b16 v[100:101], v12 offset:49760
  ds_read_b64_tr_b16 v[102:103], v12 offset:53344
  v_mfma_f32_16x16x32_bf16 v[52:55], v[172:175], v[124:127], v[52:55]
  s_waitcnt lgkmcnt(8)
  ds_read_b64_tr_b16 v[168:169], v12 offset:49792
  ds_read_b64_tr_b16 v[170:171], v12 offset:53376
  v_mfma_f32_16x16x32_bf16 v[56:59], v[176:179], v[124:127], v[56:59]
  buffer_load_dwordx4 v[160:163], v4, s[52:55], s15 offen offset:2048 sc1
  ds_read_b64_tr_b16 v[172:173], v12 offset:49824
  ds_read_b64_tr_b16 v[174:175], v12 offset:53408
  v_mfma_f32_16x16x32_bf16 v[60:63], v[180:183], v[124:127], v[60:63]
  ds_read_b64_tr_b16 v[176:177], v12 offset:49856
  ds_read_b64_tr_b16 v[178:179], v12 offset:53440
  s_waitcnt vmcnt(8)
  v_mfma_f32_16x16x32_bf16 v[36:39], v[184:187], v[128:131], v[36:39]
  s_waitcnt lgkmcnt(8)
  ds_read_b64_tr_b16 v[180:181], v12 offset:56832
  ds_read_b64_tr_b16 v[182:183], v12 offset:60416
  v_mfma_f32_16x16x32_bf16 v[40:43], v[188:191], v[128:131], v[40:43]
  ds_read_b64_tr_b16 v[184:185], v12 offset:56864
  ds_read_b64_tr_b16 v[186:187], v12 offset:60448
  v_mfma_f32_16x16x32_bf16 v[44:47], v[192:195], v[128:131], v[44:47]
  buffer_load_dwordx4 v[164:167], v4, s[52:55], s15 offen offset:3072 sc1
  ds_read_b64_tr_b16 v[188:189], v12 offset:56896
  ds_read_b64_tr_b16 v[190:191], v12 offset:60480
  v_mfma_f32_16x16x32_bf16 v[48:51], v[196:199], v[128:131], v[48:51]
  s_waitcnt lgkmcnt(8)
  ds_read_b64_tr_b16 v[192:193], v12 offset:56928
  ds_read_b64_tr_b16 v[194:195], v12 offset:60512
  v_mfma_f32_16x16x32_bf16 v[52:55], v[200:203], v[128:131], v[52:55]
  ds_read_b64_tr_b16 v[196:197], v12 offset:56960
  ds_read_b64_tr_b16 v[198:199], v12 offset:60544
  v_mfma_f32_16x16x32_bf16 v[56:59], v[204:207], v[128:131], v[56:59]
  ds_read_b64_tr_b16 v[200:201], v12 offset:56992
  ds_read_b64_tr_b16 v[202:203], v12 offset:60576
  v_mfma_f32_16x16x32_bf16 v[60:63], v[208:211], v[128:131], v[60:63]
  s_barrier
  s_waitcnt lgkmcnt(8)
  ds_read_b64_tr_b16 v[204:205], v12 offset:57024
  ds_read_b64_tr_b16 v[206:207], v12 offset:60608
  s_waitcnt vmcnt(8)
  v_mfma_f32_16x16x32_bf16 v[36:39], v[212:215], v[132:135], v[36:39]
  ds_read_b64_tr_b16 v[208:209], v13 offset:6656
  ds_read_b64_tr_b16 v[210:211], v13 offset:10240
  v_mfma_f32_16x16x32_bf16 v[40:43], v[216:219], v[132:135], v[40:43]
  s_add_u32 m0, s89, 66560
  s_add_u32 s67, s88, 0
  ds_read_b64_tr_b16 v[212:213], v13 offset:6688
  ds_read_b64_tr_b16 v[214:215], v13 offset:10272
  v_mfma_f32_16x16x32_bf16 v[44:47], v[220:223], v[132:135], v[44:47]
  buffer_load_dwordx4 v16, s[24:27], s67 offen  lds
  s_waitcnt lgkmcnt(8)
  ds_read_b64_tr_b16 v[216:217], v13 offset:6720
  ds_read_b64_tr_b16 v[218:219], v13 offset:10304
  v_mfma_f32_16x16x32_bf16 v[48:51], v[224:227], v[132:135], v[48:51]
  ds_read_b64_tr_b16 v[220:221], v13 offset:6752
  ds_read_b64_tr_b16 v[222:223], v13 offset:10336
  v_mfma_f32_16x16x32_bf16 v[52:55], v[228:231], v[132:135], v[52:55]
  ds_read_b64_tr_b16 v[224:225], v13 offset:6784
  ds_read_b64_tr_b16 v[226:227], v13 offset:10368
  v_mfma_f32_16x16x32_bf16 v[56:59], v[232:235], v[132:135], v[56:59]
  s_add_u32 m0, s89, 67584
  s_waitcnt lgkmcnt(8)
  ds_read_b64_tr_b16 v[228:229], v13 offset:6816
  ds_read_b64_tr_b16 v[230:231], v13 offset:10400
  v_mfma_f32_16x16x32_bf16 v[60:63], v[236:239], v[132:135], v[60:63]
  buffer_load_dwordx4 v17, s[24:27], s67 offen  lds
  ds_read_b64_tr_b16 v[232:233], v13 offset:6848
  ds_read_b64_tr_b16 v[234:235], v13 offset:10432
  s_waitcnt vmcnt(9)
  v_mfma_f32_16x16x32_bf16 v[36:39], v[240:243], v[136:139], v[36:39]
  ds_read_b64_tr_b16 v[236:237], v11 offset:0
  ds_read_b64_tr_b16 v[238:239], v11 offset:3584
  v_mfma_f32_16x16x32_bf16 v[40:43], v[244:247], v[136:139], v[40:43]
  s_waitcnt lgkmcnt(8)
  ds_read_b64_tr_b16 v[240:241], v11 offset:32
  ds_read_b64_tr_b16 v[242:243], v11 offset:3616
  v_mfma_f32_16x16x32_bf16 v[44:47], v[68:71], v[136:139], v[44:47]
  s_add_u32 m0, s89, 68608
  ds_read_b64_tr_b16 v[244:245], v11 offset:64
  ds_read_b64_tr_b16 v[246:247], v11 offset:3648
  v_mfma_f32_16x16x32_bf16 v[48:51], v[72:75], v[136:139], v[48:51]
  buffer_load_dwordx4 v18, s[24:27], s67 offen  lds
  ds_read_b64_tr_b16 v[68:69], v11 offset:96
  ds_read_b64_tr_b16 v[70:71], v11 offset:3680
  v_mfma_f32_16x16x32_bf16 v[52:55], v[76:79], v[136:139], v[52:55]
  s_waitcnt lgkmcnt(8)
  ds_read_b64_tr_b16 v[72:73], v11 offset:128
  ds_read_b64_tr_b16 v[74:75], v11 offset:3712
  v_mfma_f32_16x16x32_bf16 v[56:59], v[80:83], v[136:139], v[56:59]
  ds_read_b64_tr_b16 v[76:77], v11 offset:160
  ds_read_b64_tr_b16 v[78:79], v11 offset:3744
  v_mfma_f32_16x16x32_bf16 v[60:63], v[84:87], v[136:139], v[60:63]
  s_add_u32 m0, s89, 69632
  ds_read_b64_tr_b16 v[80:81], v11 offset:192
  ds_read_b64_tr_b16 v[82:83], v11 offset:3776
  s_waitcnt vmcnt(9)
  v_mfma_f32_16x16x32_bf16 v[36:39], v[88:91], v[140:143], v[36:39]
  buffer_load_dwordx4 v19, s[24:27], s67 offen  lds
  s_waitcnt lgkmcnt(8)
  ds_read_b64_tr_b16 v[84:85], v11 offset:7168
  ds_read_b64_tr_b16 v[86:87], v11 offset:10752
  v_mfma_f32_16x16x32_bf16 v[40:43], v[92:95], v[140:143], v[40:43]
  ds_read_b64_tr_b16 v[88:89], v11 offset:7200
  ds_read_b64_tr_b16 v[90:91], v11 offset:10784
  v_mfma_f32_16x16x32_bf16 v[44:47], v[96:99], v[140:143], v[44:47]
  ds_read_b64_tr_b16 v[92:93], v11 offset:7232
  ds_read_b64_tr_b16 v[94:95], v11 offset:10816
  v_mfma_f32_16x16x32_bf16 v[48:51], v[100:103], v[140:143], v[48:51]
  s_add_u32 m0, s89, 70656
  s_waitcnt lgkmcnt(8)
  ds_read_b64_tr_b16 v[96:97], v11 offset:7264
  ds_read_b64_tr_b16 v[98:99], v11 offset:10848
  v_mfma_f32_16x16x32_bf16 v[52:55], v[168:171], v[140:143], v[52:55]
  buffer_load_dwordx4 v20, s[24:27], s67 offen  lds
  ds_read_b64_tr_b16 v[100:101], v11 offset:7296
  ds_read_b64_tr_b16 v[102:103], v11 offset:10880
  v_mfma_f32_16x16x32_bf16 v[56:59], v[172:175], v[140:143], v[56:59]
  ds_read_b64_tr_b16 v[168:169], v11 offset:7328
  ds_read_b64_tr_b16 v[170:171], v11 offset:10912
  v_mfma_f32_16x16x32_bf16 v[60:63], v[176:179], v[140:143], v[60:63]
  s_waitcnt lgkmcnt(8)
  ds_read_b64_tr_b16 v[172:173], v11 offset:7360
  ds_read_b64_tr_b16 v[174:175], v11 offset:10944
  s_waitcnt vmcnt(10)
  v_mfma_f32_16x16x32_bf16 v[36:39], v[180:183], v[144:147], v[36:39]
  s_add_u32 m0, s89, 71680
  ds_read_b64_tr_b16 v[176:177], v11 offset:14336
  ds_read_b64_tr_b16 v[178:179], v11 offset:17920
  v_mfma_f32_16x16x32_bf16 v[40:43], v[184:187], v[144:147], v[40:43]
  buffer_load_dwordx4 v21, s[24:27], s67 offen  lds
  ds_read_b64_tr_b16 v[180:181], v11 offset:14368
  ds_read_b64_tr_b16 v[182:183], v11 offset:17952
  v_mfma_f32_16x16x32_bf16 v[44:47], v[188:191], v[144:147], v[44:47]
  s_waitcnt lgkmcnt(8)
  ds_read_b64_tr_b16 v[184:185], v11 offset:14400
  ds_read_b64_tr_b16 v[186:187], v11 offset:17984
  v_mfma_f32_16x16x32_bf16 v[48:51], v[192:195], v[144:147], v[48:51]
  ds_read_b64_tr_b16 v[188:189], v11 offset:14432
  ds_read_b64_tr_b16 v[190:191], v11 offset:18016
  v_mfma_f32_16x16x32_bf16 v[52:55], v[196:199], v[144:147], v[52:55]
  s_add_u32 m0, s89, 72704
  ds_read_b64_tr_b16 v[192:193], v11 offset:14464
  ds_read_b64_tr_b16 v[194:195], v11 offset:18048
  v_mfma_f32_16x16x32_bf16 v[56:59], v[200:203], v[144:147], v[56:59]
  buffer_load_dwordx4 v22, s[24:27], s67 offen  lds
  s_waitcnt lgkmcnt(8)
  ds_read_b64_tr_b16 v[196:197], v11 offset:14496
  ds_read_b64_tr_b16 v[198:199], v11 offset:18080
  v_mfma_f32_16x16x32_bf16 v[60:63], v[204:207], v[144:147], v[60:63]
  ds_read_b64_tr_b16 v[200:201], v11 offset:14528
  ds_read_b64_tr_b16 v[202:203], v11 offset:18112
  s_waitcnt vmcnt(11)
  v_mfma_f32_16x16x32_bf16 v[36:39], v[208:211], v[148:151], v[36:39]
  ds_read_b64_tr_b16 v[204:205], v11 offset:21504
  ds_read_b64_tr_b16 v[206:207], v11 offset:25088
  v_mfma_f32_16x16x32_bf16 v[40:43], v[212:215], v[148:151], v[40:43]
  s_waitcnt lgkmcnt(8)
  ds_read_b64_tr_b16 v[208:209], v11 offset:21536
  ds_read_b64_tr_b16 v[210:211], v11 offset:25120
  v_mfma_f32_16x16x32_bf16 v[44:47], v[216:219], v[148:151], v[44:47]
  s_add_u32 m0, s89, 133120
  s_add_u32 s67, s88, 458752
  ds_read_b64_tr_b16 v[212:213], v11 offset:21568
  ds_read_b64_tr_b16 v[214:215], v11 offset:25152
  v_mfma_f32_16x16x32_bf16 v[48:51], v[220:223], v[148:151], v[48:51]
  buffer_load_dwordx4 v16, s[24:27], s67 offen  lds
  ds_read_b64_tr_b16 v[216:217], v11 offset:21600
  ds_read_b64_tr_b16 v[218:219], v11 offset:25184
  v_mfma_f32_16x16x32_bf16 v[52:55], v[224:227], v[148:151], v[52:55]
  s_waitcnt lgkmcnt(8)
  ds_read_b64_tr_b16 v[220:221], v11 offset:21632
  ds_read_b64_tr_b16 v[222:223], v11 offset:25216
  v_mfma_f32_16x16x32_bf16 v[56:59], v[228:231], v[148:151], v[56:59]
  ds_read_b64_tr_b16 v[224:225], v11 offset:21664
  ds_read_b64_tr_b16 v[226:227], v11 offset:25248
  v_mfma_f32_16x16x32_bf16 v[60:63], v[232:235], v[148:151], v[60:63]
  s_add_u32 m0, s89, 134144
  ds_read_b64_tr_b16 v[228:229], v11 offset:21696
  ds_read_b64_tr_b16 v[230:231], v11 offset:25280
  s_waitcnt vmcnt(11)
  v_mfma_f32_16x16x32_bf16 v[36:39], v[236:239], v[152:155], v[36:39]
  buffer_load_dwordx4 v17, s[24:27], s67 offen  lds
  v_mfma_f32_16x16x32_bf16 v[40:43], v[240:243], v[152:155], v[40:43]
  v_mfma_f32_16x16x32_bf16 v[44:47], v[244:247], v[152:155], v[44:47]
  v_mfma_f32_16x16x32_bf16 v[48:51], v[68:71], v[152:155], v[48:51]
  s_add_u32 m0, s89, 135168
  v_mfma_f32_16x16x32_bf16 v[52:55], v[72:75], v[152:155], v[52:55]
  buffer_load_dwordx4 v18, s[24:27], s67 offen  lds
  v_mfma_f32_16x16x32_bf16 v[56:59], v[76:79], v[152:155], v[56:59]
  v_mfma_f32_16x16x32_bf16 v[60:63], v[80:83], v[152:155], v[60:63]
  s_waitcnt vmcnt(12)
  v_mfma_f32_16x16x32_bf16 v[36:39], v[84:87], v[156:159], v[36:39]
  s_add_u32 m0, s89, 136192
  v_mfma_f32_16x16x32_bf16 v[40:43], v[88:91], v[156:159], v[40:43]
  buffer_load_dwordx4 v19, s[24:27], s67 offen  lds
  v_mfma_f32_16x16x32_bf16 v[44:47], v[92:95], v[156:159], v[44:47]
  v_mfma_f32_16x16x32_bf16 v[48:51], v[96:99], v[156:159], v[48:51]
  v_mfma_f32_16x16x32_bf16 v[52:55], v[100:103], v[156:159], v[52:55]
  s_add_u32 m0, s89, 137216
  v_mfma_f32_16x16x32_bf16 v[56:59], v[168:171], v[156:159], v[56:59]
  buffer_load_dwordx4 v20, s[24:27], s67 offen  lds
  v_mfma_f32_16x16x32_bf16 v[60:63], v[172:175], v[156:159], v[60:63]
  s_waitcnt vmcnt(13)
  v_mfma_f32_16x16x32_bf16 v[36:39], v[176:179], v[160:163], v[36:39]
  v_mfma_f32_16x16x32_bf16 v[40:43], v[180:183], v[160:163], v[40:43]
  s_add_u32 m0, s89, 138240
  v_mfma_f32_16x16x32_bf16 v[44:47], v[184:187], v[160:163], v[44:47]
  buffer_load_dwordx4 v21, s[24:27], s67 offen  lds
  v_mfma_f32_16x16x32_bf16 v[48:51], v[188:191], v[160:163], v[48:51]
  v_mfma_f32_16x16x32_bf16 v[52:55], v[192:195], v[160:163], v[52:55]
  v_mfma_f32_16x16x32_bf16 v[56:59], v[196:199], v[160:163], v[56:59]
  s_add_u32 m0, s89, 139264
  v_mfma_f32_16x16x32_bf16 v[60:63], v[200:203], v[160:163], v[60:63]
  buffer_load_dwordx4 v22, s[24:27], s67 offen  lds
  s_waitcnt vmcnt(14) lgkmcnt(6)
  v_mfma_f32_16x16x32_bf16 v[36:39], v[204:207], v[164:167], v[36:39]
  v_mfma_f32_16x16x32_bf16 v[40:43], v[208:211], v[164:167], v[40:43]
  v_mfma_f32_16x16x32_bf16 v[44:47], v[212:215], v[164:167], v[44:47]
  v_mfma_f32_16x16x32_bf16 v[48:51], v[216:219], v[164:167], v[48:51]
  s_waitcnt lgkmcnt(0)
  v_mfma_f32_16x16x32_bf16 v[52:55], v[220:223], v[164:167], v[52:55]
  v_mfma_f32_16x16x32_bf16 v[56:59], v[224:227], v[164:167], v[56:59]
  v_mfma_f32_16x16x32_bf16 v[60:63], v[228:231], v[164:167], v[60:63]
  v_mov_b32 v68, 0xc0135761
  v_mov_b32 v69, 0xc0135761
  s_mov_b32 s72, 0xbdd2d3e8
  s_mov_b32 s73, 0xbdd2d3e8
  v_pk_mul_f32 v[72:73], v[36:37], v[36:37]
  v_pk_mul_f32 v[74:75], v[38:39], v[38:39]
  v_pk_fma_f32 v[72:73], v[72:73], s[72:73], v[68:69]
  v_pk_fma_f32 v[74:75], v[74:75], s[72:73], v[68:69]
  v_pk_mul_f32 v[72:73], v[72:73], v[36:37]
  v_pk_mul_f32 v[74:75], v[74:75], v[38:39]
  v_exp_f32 v72, v72
  v_exp_f32 v73, v73
  v_exp_f32 v74, v74
  v_exp_f32_e64 v75, v75
  v_pk_add_f32 v[72:73], v[72:73], 1.0 op_sel_hi:[1,0]
  v_pk_add_f32 v[74:75], v[74:75], 1.0 op_sel_hi:[1,0]
  v_rcp_f32 v72, v72
  v_rcp_f32 v73, v73
  v_rcp_f32 v74, v74
  v_rcp_f32 v75, v75
  v_pk_mul_f32 v[36:37], v[36:37], v[72:73]
  v_pk_mul_f32 v[38:39], v[38:39], v[74:75]
  v_pk_mul_f32 v[72:73], v[40:41], v[40:41]
  v_pk_mul_f32 v[74:75], v[42:43], v[42:43]
  v_pk_fma_f32 v[72:73], v[72:73], s[72:73], v[68:69]
  v_pk_fma_f32 v[74:75], v[74:75], s[72:73], v[68:69]
  v_pk_mul_f32 v[72:73], v[72:73], v[40:41]
  v_pk_mul_f32 v[74:75], v[74:75], v[42:43]
  v_exp_f32 v72, v72
  v_exp_f32 v73, v73
  v_exp_f32 v74, v74
  v_exp_f32 v75, v75
  v_pk_add_f32 v[72:73], v[72:73], 1.0 op_sel_hi:[1,0]
  v_pk_add_f32 v[74:75], v[74:75], 1.0 op_sel_hi:[1,0]
  v_rcp_f32 v72, v72
  v_rcp_f32 v73, v73
  v_rcp_f32 v74, v74
  v_rcp_f32 v75, v75
  v_pk_mul_f32 v[40:41], v[40:41], v[72:73]
  v_pk_mul_f32 v[42:43], v[42:43], v[74:75]
  v_pk_mul_f32 v[72:73], v[44:45], v[44:45]
  v_pk_mul_f32 v[74:75], v[46:47], v[46:47]
  v_pk_fma_f32 v[72:73], v[72:73], s[72:73], v[68:69]
  v_pk_fma_f32 v[74:75], v[74:75], s[72:73], v[68:69]
  v_pk_mul_f32 v[72:73], v[72:73], v[44:45]
  v_pk_mul_f32 v[74:75], v[74:75], v[46:47]
  v_exp_f32 v72, v72
  v_exp_f32 v73, v73
  v_exp_f32 v74, v74
  v_exp_f32 v75, v75
  v_pk_add_f32 v[72:73], v[72:73], 1.0 op_sel_hi:[1,0]
  v_pk_add_f32 v[74:75], v[74:75], 1.0 op_sel_hi:[1,0]
  v_rcp_f32 v72, v72
  v_rcp_f32 v73, v73
  v_rcp_f32 v74, v74
  v_rcp_f32 v75, v75
  v_pk_mul_f32 v[44:45], v[44:45], v[72:73]
  v_pk_mul_f32 v[46:47], v[46:47], v[74:75]
  v_pk_mul_f32 v[72:73], v[48:49], v[48:49]
  v_pk_mul_f32 v[74:75], v[50:51], v[50:51]
  v_pk_fma_f32 v[72:73], v[72:73], s[72:73], v[68:69]
  v_pk_fma_f32 v[74:75], v[74:75], s[72:73], v[68:69]
  v_pk_mul_f32 v[72:73], v[72:73], v[48:49]
  v_pk_mul_f32 v[74:75], v[74:75], v[50:51]
  v_exp_f32 v72, v72
  v_exp_f32 v73, v73
  v_exp_f32 v74, v74
  v_exp_f32 v75, v75
  v_pk_add_f32 v[72:73], v[72:73], 1.0 op_sel_hi:[1,0]
  v_pk_add_f32 v[74:75], v[74:75], 1.0 op_sel_hi:[1,0]
  v_rcp_f32 v72, v72
  v_rcp_f32 v73, v73
  v_rcp_f32 v74, v74
  v_rcp_f32 v75, v75
  v_pk_mul_f32 v[48:49], v[48:49], v[72:73]
  v_pk_mul_f32 v[50:51], v[50:51], v[74:75]
  v_pk_mul_f32 v[72:73], v[52:53], v[52:53]
  v_pk_mul_f32 v[74:75], v[54:55], v[54:55]
  v_pk_fma_f32 v[72:73], v[72:73], s[72:73], v[68:69]
  v_pk_fma_f32 v[74:75], v[74:75], s[72:73], v[68:69]
  v_pk_mul_f32 v[72:73], v[72:73], v[52:53]
  v_pk_mul_f32 v[74:75], v[74:75], v[54:55]
  v_exp_f32 v72, v72
  v_exp_f32 v73, v73
  v_exp_f32 v74, v74
  v_exp_f32 v75, v75
  v_pk_add_f32 v[72:73], v[72:73], 1.0 op_sel_hi:[1,0]
  v_pk_add_f32 v[74:75], v[74:75], 1.0 op_sel_hi:[1,0]
  v_rcp_f32 v72, v72
  v_rcp_f32 v73, v73
  v_rcp_f32 v74, v74
  v_rcp_f32 v75, v75
  v_pk_mul_f32 v[52:53], v[52:53], v[72:73]
  v_pk_mul_f32 v[54:55], v[54:55], v[74:75]
  v_pk_mul_f32 v[72:73], v[56:57], v[56:57]
  v_pk_mul_f32 v[74:75], v[58:59], v[58:59]
  v_pk_fma_f32 v[72:73], v[72:73], s[72:73], v[68:69]
  v_pk_fma_f32 v[74:75], v[74:75], s[72:73], v[68:69]
  v_pk_mul_f32 v[72:73], v[72:73], v[56:57]
  v_pk_mul_f32 v[74:75], v[74:75], v[58:59]
  v_exp_f32 v72, v72
  v_exp_f32 v73, v73
  v_exp_f32 v74, v74
  v_exp_f32 v75, v75
  v_pk_add_f32 v[72:73], v[72:73], 1.0 op_sel_hi:[1,0]
  v_pk_add_f32 v[74:75], v[74:75], 1.0 op_sel_hi:[1,0]
  v_rcp_f32 v72, v72
  v_rcp_f32 v73, v73
  v_rcp_f32 v74, v74
  v_rcp_f32 v75, v75
  v_pk_mul_f32 v[56:57], v[56:57], v[72:73]
  v_pk_mul_f32 v[58:59], v[58:59], v[74:75]
  v_pk_mul_f32 v[72:73], v[60:61], v[60:61]
  v_pk_mul_f32 v[74:75], v[62:63], v[62:63]
  v_pk_fma_f32 v[72:73], v[72:73], s[72:73], v[68:69]
  v_pk_fma_f32 v[74:75], v[74:75], s[72:73], v[68:69]
  v_pk_mul_f32 v[72:73], v[72:73], v[60:61]
  v_pk_mul_f32 v[74:75], v[74:75], v[62:63]
  v_exp_f32 v72, v72
  v_exp_f32 v73, v73
  v_exp_f32 v74, v74
  v_exp_f32 v75, v75
  v_pk_add_f32 v[72:73], v[72:73], 1.0 op_sel_hi:[1,0]
  v_pk_add_f32 v[74:75], v[74:75], 1.0 op_sel_hi:[1,0]
  v_rcp_f32 v72, v72
  v_rcp_f32 v73, v73
  v_rcp_f32 v74, v74
  v_rcp_f32 v75, v75
  v_pk_mul_f32 v[60:61], v[60:61], v[72:73]
  v_pk_mul_f32 v[62:63], v[62:63], v[74:75]
  v_cvt_pk_bf16_f32 v36, v36, v37
  v_cvt_pk_bf16_f32 v37, v38, v39
  v_cvt_pk_bf16_f32 v38, v40, v41
  v_cvt_pk_bf16_f32 v39, v42, v43
  v_cvt_pk_bf16_f32 v40, v44, v45
  v_cvt_pk_bf16_f32 v41, v46, v47
  v_cvt_pk_bf16_f32 v42, v48, v49
  v_cvt_pk_bf16_f32 v43, v50, v51
  v_cvt_pk_bf16_f32 v44, v52, v53
  v_cvt_pk_bf16_f32 v45, v54, v55
  v_cvt_pk_bf16_f32 v46, v56, v57
  v_cvt_pk_bf16_f32 v47, v58, v59
  v_cvt_pk_bf16_f32 v48, v60, v61
  v_cvt_pk_bf16_f32 v49, v62, v63
  v_dot2c_f32_bf16 v64, s69, v36
  v_dot2c_f32_bf16 v65, v36, v36
  v_dot2c_f32_bf16 v64, s69, v37
  v_dot2c_f32_bf16 v65, v37, v37
  v_dot2c_f32_bf16 v64, s69, v38
  v_dot2c_f32_bf16 v65, v38, v38
  v_dot2c_f32_bf16 v64, s69, v39
  v_dot2c_f32_bf16 v65, v39, v39
  v_dot2c_f32_bf16 v64, s69, v40
  v_dot2c_f32_bf16 v65, v40, v40
  v_dot2c_f32_bf16 v64, s69, v41
  v_dot2c_f32_bf16 v65, v41, v41
  v_dot2c_f32_bf16 v64, s69, v42
  v_dot2c_f32_bf16 v65, v42, v42
  v_dot2c_f32_bf16 v64, s69, v43
  v_dot2c_f32_bf16 v65, v43, v43
  v_dot2c_f32_bf16 v64, s69, v44
  v_dot2c_f32_bf16 v65, v44, v44
  v_dot2c_f32_bf16 v64, s69, v45
  v_dot2c_f32_bf16 v65, v45, v45
  v_dot2c_f32_bf16 v64, s69, v46
  v_dot2c_f32_bf16 v65, v46, v46
  v_dot2c_f32_bf16 v64, s69, v47
  v_dot2c_f32_bf16 v65, v47, v47
  v_dot2c_f32_bf16 v64, s69, v48
  v_dot2c_f32_bf16 v65, v48, v48
  v_dot2c_f32_bf16 v64, s69, v49
  v_dot2c_f32_bf16 v65, v49, v49
  s_nop 2
  v_permlane16_swap_b32 v64, v65
  v_add_f32 v64, v64, v65
  v_mov_b32 v65, v64
  s_nop 1
  v_permlane32_swap_b32 v64, v65
  v_add_f32 v64, v64, v65
  v_mov_b32 v65, v64
  s_nop 1
  v_permlane16_swap_b32 v64, v65
  s_mov_b64 exec, 0xffff
  s_cmp_eq_u32 s62, 1
  s_cbranch_scc0 L_far_94
  buffer_store_dwordx4 v[64:67], v4, s[52:55], s86 offen
L_stored_95:
  s_mov_b64 exec, -1
  s_waitcnt vmcnt(8)
  s_barrier
  ds_read_b64_tr_b16 v[100:101], v12 offset:9216
  ds_read_b64_tr_b16 v[102:103], v12 offset:12800
  ds_read_b64_tr_b16 v[204:205], v12 offset:9248
  ds_read_b64_tr_b16 v[206:207], v12 offset:12832
  ds_read_b64_tr_b16 v[208:209], v12 offset:9280
  ds_read_b64_tr_b16 v[210:211], v12 offset:12864
  ds_read_b64_tr_b16 v[212:213], v12 offset:9312
  ds_read_b64_tr_b16 v[214:215], v12 offset:12896
  ds_read_b64_tr_b16 v[216:217], v12 offset:9344
  ds_read_b64_tr_b16 v[218:219], v12 offset:12928
  ds_read_b64_tr_b16 v[220:221], v12 offset:9376
  ds_read_b64_tr_b16 v[222:223], v12 offset:12960
  ds_read_b64_tr_b16 v[224:225], v12 offset:9408
  ds_read_b64_tr_b16 v[226:227], v12 offset:12992
  s_waitcnt lgkmcnt(6)
  v_mfma_f32_16x16x32_bf16 v[168:171], v[100:103], v[104:107], 0
  s_add_u32 m0, s89, 33280
  s_add_u32 s67, s88, 917504
  ds_read_b64_tr_b16 v[228:229], v12 offset:16384
  ds_read_b64_tr_b16 v[230:231], v12 offset:19968
  v_mfma_f32_16x16x32_bf16 v[172:175], v[204:207], v[104:107], 0
  buffer_load_dwordx4 v16, s[24:27], s67 offen  lds
  ds_read_b64_tr_b16 v[100:101], v12 offset:16416
  ds_read_b64_tr_b16 v[102:103], v12 offset:20000
  v_mfma_f32_16x16x32_bf16 v[176:179], v[208:211], v[104:107], 0
  ds_read_b64_tr_b16 v[204:205], v12 offset:16448
  ds_read_b64_tr_b16 v[206:207], v12 offset:20032
  v_mfma_f32_16x16x32_bf16 v[180:183], v[212:215], v[104:107], 0
  s_add_u32 m0, s89, 34304
  ds_read_b64_tr_b16 v[208:209], v12 offset:16480
  ds_read_b64_tr_b16 v[210:211], v12 offset:20064
  s_waitcnt lgkmcnt(6)
  v_mfma_f32_16x16x32_bf16 v[184:187], v[216:219], v[104:107], 0
  buffer_load_dwordx4 v17, s[24:27], s67 offen  lds
  ds_read_b64_tr_b16 v[212:213], v12 offset:16512
  ds_read_b64_tr_b16 v[214:215], v12 offset:20096
  v_mfma_f32_16x16x32_bf16 v[188:191], v[220:223], v[104:107], 0
  ds_read_b64_tr_b16 v[216:217], v12 offset:16544
  ds_read_b64_tr_b16 v[218:219], v12 offset:20128
  v_mfma_f32_16x16x32_bf16 v[192:195], v[224:227], v[104:107], 0
  s_add_u32 m0, s89, 35328
  ds_read_b64_tr_b16 v[220:221], v12 offset:16576
  ds_read_b64_tr_b16 v[222:223], v12 offset:20160
  v_mfma_f32_16x16x32_bf16 v[168:171], v[228:231], v[108:111], v[168:171]
  buffer_load_dwordx4 v18, s[24:27], s67 offen  lds
  ds_read_b64_tr_b16 v[224:225], v12 offset:23552
  ds_read_b64_tr_b16 v[226:227], v12 offset:27136
  s_waitcnt lgkmcnt(6)
  v_mfma_f32_16x16x32_bf16 v[172:175], v[100:103], v[108:111], v[172:175]
  ds_read_b64_tr_b16 v[228:229], v12 offset:23584
  ds_read_b64_tr_b16 v[230:231], v12 offset:27168
  v_mfma_f32_16x16x32_bf16 v[176:179], v[204:207], v[108:111], v[176:179]
  s_add_u32 m0, s89, 36352
  ds_read_b64_tr_b16 v[100:101], v12 offset:23616
  ds_read_b64_tr_b16 v[102:103], v12 offset:27200
  v_mfma_f32_16x16x32_bf16 v[180:183], v[208:211], v[108:111], v[180:183]
  buffer_load_dwordx4 v19, s[24:27], s67 offen  lds
  ds_read_b64_tr_b16 v[204:205], v12 offset:23648
  ds_read_b64_tr_b16 v[206:207], v12 offset:27232
  v_mfma_f32_16x16x32_bf16 v[184:187], v[212:215], v[108:111], v[184:187]
  ds_read_b64_tr_b16 v[208:209], v12 offset:23680
  ds_read_b64_tr_b16 v[210:211], v12 offset:27264
  s_waitcnt lgkmcnt(6)
  v_mfma_f32_16x16x32_bf16 v[188:191], v[216:219], v[108:111], v[188:191]
  s_add_u32 m0, s89, 37376
  ds_read_b64_tr_b16 v[212:213], v12 offset:23712
  ds_read_b64_tr_b16 v[214:215], v12 offset:27296
  v_mfma_f32_16x16x32_bf16 v[192:195], v[220:223], v[108:111], v[192:195]
  buffer_load_dwordx4 v20, s[24:27], s67 offen  lds
  ds_read_b64_tr_b16 v[216:217], v12 offset:23744
  ds_read_b64_tr_b16 v[218:219], v12 offset:27328
  v_mfma_f32_16x16x32_bf16 v[168:171], v[224:227], v[112:115], v[168:171]
  ds_read_b64_tr_b16 v[220:221], v12 offset:30720
  ds_read_b64_tr_b16 v[222:223], v12 offset:34304
  v_mfma_f32_16x16x32_bf16 v[172:175], v[228:231], v[112:115], v[172:175]
  s_add_u32 m0, s89, 38400
  ds_read_b64_tr_b16 v[224:225], v12 offset:30752
  ds_read_b64_tr_b16 v[226:227], v12 offset:34336
  s_waitcnt lgkmcnt(6)
  v_mfma_f32_16x16x32_bf16 v[176:179], v[100:103], v[112:115], v[176:179]
  buffer_load_dwordx4 v21, s[24:27], s67 offen  lds
  ds_read_b64_tr_b16 v[228:229], v12 offset:30784
  ds_read_b64_tr_b16 v[230:231], v12 offset:34368
  v_mfma_f32_16x16x32_bf16 v[180:183], v[204:207], v[112:115], v[180:183]
  ds_read_b64_tr_b16 v[100:101], v12 offset:30816
  ds_read_b64_tr_b16 v[102:103], v12 offset:34400
  v_mfma_f32_16x16x32_bf16 v[184:187], v[208:211], v[112:115], v[184:187]
  s_add_u32 m0, s89, 39424
  ds_read_b64_tr_b16 v[204:205], v12 offset:30848
  ds_read_b64_tr_b16 v[206:207], v12 offset:34432
  v_mfma_f32_16x16x32_bf16 v[188:191], v[212:215], v[112:115], v[188:191]
  buffer_load_dwordx4 v22, s[24:27], s67 offen  lds
  ds_read_b64_tr_b16 v[208:209], v12 offset:30880
  ds_read_b64_tr_b16 v[210:211], v12 offset:34464
  s_waitcnt lgkmcnt(6)
  v_mfma_f32_16x16x32_bf16 v[192:195], v[216:219], v[112:115], v[192:195]
  ds_read_b64_tr_b16 v[212:213], v12 offset:30912
  ds_read_b64_tr_b16 v[214:215], v12 offset:34496
  v_mfma_f32_16x16x32_bf16 v[168:171], v[220:223], v[116:119], v[168:171]
  v_mfma_f32_16x16x32_bf16 v[172:175], v[224:227], v[116:119], v[172:175]
  v_mfma_f32_16x16x32_bf16 v[176:179], v[228:231], v[116:119], v[176:179]
  s_waitcnt lgkmcnt(0)
  v_mfma_f32_16x16x32_bf16 v[180:183], v[100:103], v[116:119], v[180:183]
  v_mfma_f32_16x16x32_bf16 v[184:187], v[204:207], v[116:119], v[184:187]
  v_mfma_f32_16x16x32_bf16 v[188:191], v[208:211], v[116:119], v[188:191]
  v_mfma_f32_16x16x32_bf16 v[192:195], v[212:215], v[116:119], v[192:195]
  buffer_load_dwordx4 v[196:199], v23, s[52:55], s85 offen sc1
  buffer_load_dwordx4 v[200:203], v23, s[52:55], s85 offen offset:1024 sc1
  v_lshlrev_b32_e64 v68, 16, v36
  v_and_b32 v69, 0xffff0000, v36
  v_lshlrev_b32_e64 v70, 16, v37
  v_and_b32 v71, 0xffff0000, v37
  v_lshlrev_b32_e64 v72, 16, v38
  v_and_b32 v73, 0xffff0000, v38
  v_lshlrev_b32_e64 v74, 16, v39
  v_and_b32 v75, 0xffff0000, v39
  v_lshlrev_b32_e64 v76, 16, v40
  v_and_b32 v77, 0xffff0000, v40
  v_lshlrev_b32_e64 v78, 16, v41
  v_and_b32 v79, 0xffff0000, v41
  v_lshlrev_b32_e64 v80, 16, v42
  v_and_b32 v81, 0xffff0000, v42
  v_lshlrev_b32_e64 v82, 16, v43
  v_and_b32 v83, 0xffff0000, v43
  v_lshlrev_b32_e64 v84, 16, v44
  v_and_b32 v85, 0xffff0000, v44
  v_lshlrev_b32_e64 v86, 16, v45
  v_and_b32 v87, 0xffff0000, v45
  v_lshlrev_b32_e64 v88, 16, v46
  v_and_b32 v89, 0xffff0000, v46
  v_lshlrev_b32_e64 v90, 16, v47
  v_and_b32 v91, 0xffff0000, v47
  v_lshlrev_b32_e64 v92, 16, v48
  v_and_b32 v93, 0xffff0000, v48
  v_lshlrev_b32_e64 v94, 16, v49
  v_and_b32 v95, 0xffff0000, v49
  s_mul_i32 s65, s56, 3584
  s_add_u32 s65, s65, 0
  v_mul_u32_u24 v9, 224, v2
  v_lshl_add_u32 v9, v3, 3, v9
  v_add_u32 v9, s65, v9
  v_and_b32 v6, 1, v3
  v_lshlrev_b32 v6, 3, v6
  v_bfe_u32 v7, v1, 2, 2
  v_add_u32_e64 v6, v6, v7
  v_mul_u32_u24 v6, 224, v6
  v_and_b32_e64 v7, 3, v1
  v_lshl_add_u32 v6, v7, 3, v6
  v_add_u32 v7, s65, v6
  v_lshrrev_b32 v8, 5, v1
  v_lshl_add_u32 v6, v8, 5, v7
  v_and_b32 v96, 31, v1
  v_lshlrev_b32 v96, 4, v96
  v_lshl_add_u32 v96, v8, 16, v96
  s_mul_i32 s68, s59, 458752
  s_lshl_b32 s66, s60, 11
  s_add_u32 s68, s68, s66
  s_lshl_b32 s66, s56, 9
  s_add_u32 s68, s68, s66
  s_add_u32 s68, s68, 16777216
  s_mov_b32 s64, s63
  s_waitcnt vmcnt(0)
  v_xor_b32 v198, v198, v203
  v_xor_b32 v202, v202, v199
  v_xor_b32 v199, s61, v199
  v_xor_b32 v203, s61, v203
  v_or3_b32 v198, v198, v202, v199
  v_or_b32_e64 v198, v198, v203
  v_cmp_ne_u32 vcc, 0, v198
  s_cbranch_vccz L_pdone_97
L_again_96:
  buffer_load_dwordx4 v[196:199], v23, s[52:55], s85 offen sc1
  buffer_load_dwordx4 v[200:203], v23, s[52:55], s85 offen offset:1024 sc1
  s_waitcnt vmcnt(0)
  v_xor_b32 v198, v198, v203
  v_xor_b32 v202, v202, v199
  v_xor_b32 v199, s61, v199
  v_xor_b32_e64 v203, s61, v203
  v_or3_b32 v198, v198, v202, v199
  v_or_b32 v198, v198, v203
  v_cmp_ne_u32 vcc, 0, v198
  s_cbranch_vccz L_pdone_97
  s_sub_u32 s64, s64, 1
  s_cbranch_scc0 L_again_96
  s_mov_b32 s63, 1
L_pdone_97:
  v_add_f32 v64, v196, v200
  v_add_f32 v65, v197, v201
  s_nop 1
  v_permlane16_swap_b32 v64, v65
  v_add_f32 v64, v64, v65
  v_mov_b32 v65, v64
  s_nop 1
  v_permlane32_swap_b32 v64, v65
  v_add_f32 v64, v64, v65
  v_mov_b32 v65, v64
  s_nop 1
  v_permlane16_swap_b32 v64, v65
  v_mul_f32 v64, 0x3a924925, v64
  v_mul_f32_e64 v97, v64, v64
  s_mov_b32 s65, 0x3a924925
  v_fma_f32 v65, v65, s65, -v97
  v_max_f32_e64 v65, 0, v65
  v_add_f32 v65, 0x3727c5ac, v65
  v_rsq_f32 v65, v65
  s_nop 0
  v_mul_f32_e64 v64, -v64, v65
  v_pk_fma_f32 v[68:69], v[68:69], v[64:65], v[64:65] op_sel:[0,1,0] op_sel_hi:[1,1,0]
  v_pk_fma_f32 v[70:71], v[70:71], v[64:65], v[64:65] op_sel:[0,1,0] op_sel_hi:[1,1,0]
  v_cvt_pk_bf16_f32 v36, v68, v69
  v_cvt_pk_bf16_f32 v37, v70, v71
  ds_write_b64 v9, v[36:37] offset:0
  v_pk_fma_f32 v[72:73], v[72:73], v[64:65], v[64:65] op_sel:[0,1,0] op_sel_hi:[1,1,0]
  v_pk_fma_f32 v[74:75], v[74:75], v[64:65], v[64:65] op_sel:[0,1,0] op_sel_hi:[1,1,0]
  v_cvt_pk_bf16_f32 v38, v72, v73
  v_cvt_pk_bf16_f32 v39, v74, v75
  ds_write_b64 v9, v[38:39] offset:32
  ds_read_b64_tr_b16 v[68:69], v6 offset:0
  ds_read_b64_tr_b16 v[70:71], v6 offset:896
  v_pk_fma_f32 v[76:77], v[76:77], v[64:65], v[64:65] op_sel:[0,1,0] op_sel_hi:[1,1,0]
  v_pk_fma_f32 v[78:79], v[78:79], v[64:65], v[64:65] op_sel:[0,1,0] op_sel_hi:[1,1,0]
  v_cvt_pk_bf16_f32 v40, v76, v77
  v_cvt_pk_bf16_f32 v41, v78, v79
  ds_write_b64 v9, v[40:41] offset:64
  v_pk_fma_f32 v[80:81], v[80:81], v[64:65], v[64:65] op_sel:[0,1,0] op_sel_hi:[1,1,0]
  v_pk_fma_f32 v[82:83], v[82:83], v[64:65], v[64:65] op_sel:[0,1,0] op_sel_hi:[1,1,0]
  v_cvt_pk_bf16_f32 v42, v80, v81
  v_cvt_pk_bf16_f32 v43, v82, v83
  ds_write_b64 v9, v[42:43] offset:96
  ds_read_b64_tr_b16 v[72:73], v6 offset:64
  ds_read_b64_tr_b16 v[74:75], v6 offset:960
  s_waitcnt lgkmcnt(4)
  buffer_store_dwordx4 v[68:71], v96, s[52:55], s68 offen sc1
  s_add_u32 s68, s68, 131072
  v_pk_fma_f32 v[84:85], v[84:85], v[64:65], v[64:65] op_sel:[0,1,0] op_sel_hi:[1,1,0]
  v_pk_fma_f32 v[86:87], v[86:87], v[64:65], v[64:65] op_sel:[0,1,0] op_sel_hi:[1,1,0]
  v_cvt_pk_bf16_f32 v44, v84, v85
  v_cvt_pk_bf16_f32 v45, v86, v87
  ds_write_b64 v9, v[44:45] offset:128
  v_pk_fma_f32 v[88:89], v[88:89], v[64:65], v[64:65] op_sel:[0,1,0] op_sel_hi:[1,1,0]
  v_pk_fma_f32 v[90:91], v[90:91], v[64:65], v[64:65] op_sel:[0,1,0] op_sel_hi:[1,1,0]
  v_cvt_pk_bf16_f32 v46, v88, v89
  v_cvt_pk_bf16_f32 v47, v90, v91
  ds_write_b64 v9, v[46:47] offset:160
  ds_read_b64_tr_b16 v[76:77], v6 offset:128
  ds_read_b64_tr_b16 v[78:79], v6 offset:1024
  s_waitcnt lgkmcnt(4)
  buffer_store_dwordx4 v[72:75], v96, s[52:55], s68 offen sc1
  s_add_u32 s68, s68, 131072
  v_pk_fma_f32 v[92:93], v[92:93], v[64:65], v[64:65] op_sel:[0,1,0] op_sel_hi:[1,1,0]
  v_pk_fma_f32 v[94:95], v[94:95], v[64:65], v[64:65] op_sel:[0,1,0] op_sel_hi:[1,1,0]
  v_cvt_pk_bf16_f32 v48, v92, v93
  v_cvt_pk_bf16_f32 v49, v94, v95
  ds_write_b64 v9, v[48:49] offset:192
  ds_read_b64_tr_b16 v[80:81], v7 offset:192
  ds_read_b64_tr_b16 v[82:83], v7 offset:1088
  s_waitcnt lgkmcnt(3)
  buffer_store_dwordx4 v[76:79], v96, s[52:55], s68 offen sc1
  s_add_u32 s68, s68, 131072
  s_waitcnt lgkmcnt(0)
  s_mov_b32 exec_lo, 0xffffffff
  s_mov_b32 exec_hi, 0x0
  buffer_store_dwordx4 v[80:83], v96, s[52:55], s68 offen sc1
  s_mov_b64 exec, -1
  s_barrier
  s_lshl_b32 s94, s56, 12
  s_lshl_b32 s91, s94, 3
  s_add_u32 s91, s91, s87
  v_add_u32 v6, 7168, v5
  v_add_u32 v7, 14336, v5
  v_add_u32 v8, 21504, v5
  ds_read_b64_tr_b16 v[92:93], v13 offset:18432
  ds_read_b64_tr_b16 v[94:95], v13 offset:22016
  ds_read_b64_tr_b16 v[96:97], v13 offset:18464
  ds_read_b64_tr_b16 v[98:99], v13 offset:22048
  ds_read_b64_tr_b16 v[100:101], v13 offset:18496
  ds_read_b64_tr_b16 v[102:103], v13 offset:22080
  ds_read_b64_tr_b16 v[196:197], v13 offset:18528
  ds_read_b64_tr_b16 v[198:199], v13 offset:22112
  ds_read_b64_tr_b16 v[200:201], v13 offset:18560
  ds_read_b64_tr_b16 v[202:203], v13 offset:22144
  ds_read_b64_tr_b16 v[204:205], v13 offset:18592
  ds_read_b64_tr_b16 v[206:207], v13 offset:22176
  ds_read_b64_tr_b16 v[208:209], v13 offset:18624
  ds_read_b64_tr_b16 v[210:211], v13 offset:22208
  s_waitcnt lgkmcnt(6)
  v_mfma_f32_16x16x32_bf16 v[168:171], v[92:95], v[120:123], v[168:171]
  s_add_u32 m0, s89, 99840
  s_add_u32 s67, s88, 1376256
  ds_read_b64_tr_b16 v[212:213], v13 offset:25600
  ds_read_b64_tr_b16 v[214:215], v13 offset:29184
  v_mfma_f32_16x16x32_bf16 v[172:175], v[96:99], v[120:123], v[172:175]
  buffer_load_dwordx4 v16, s[24:27], s67 offen  lds
  ds_read_b64_tr_b16 v[92:93], v13 offset:25632
  ds_read_b64_tr_b16 v[94:95], v13 offset:29216
  v_mfma_f32_16x16x32_bf16 v[176:179], v[100:103], v[120:123], v[176:179]
  s_add_u32 m0, s89, 100864
  ds_read_b64_tr_b16 v[96:97], v13 offset:25664
  ds_read_b64_tr_b16 v[98:99], v13 offset:29248
  v_mfma_f32_16x16x32_bf16 v[180:183], v[196:199], v[120:123], v[180:183]
  buffer_load_dwordx4 v17, s[24:27], s67 offen  lds
  ds_read_b64_tr_b16 v[100:101], v13 offset:25696
  ds_read_b64_tr_b16 v[102:103], v13 offset:29280
  s_waitcnt lgkmcnt(6)
  v_mfma_f32_16x16x32_bf16 v[184:187], v[200:203], v[120:123], v[184:187]
  s_add_u32 m0, s89, 101888
  ds_read_b64_tr_b16 v[196:197], v13 offset:25728
  ds_read_b64_tr_b16 v[198:199], v13 offset:29312
  v_mfma_f32_16x16x32_bf16 v[188:191], v[204:207], v[120:123], v[188:191]
  buffer_load_dwordx4 v18, s[24:27], s67 offen  lds
  ds_read_b64_tr_b16 v[200:201], v13 offset:25760
  ds_read_b64_tr_b16 v[202:203], v13 offset:29344
  v_mfma_f32_16x16x32_bf16 v[192:195], v[208:211], v[120:123], v[192:195]
  s_add_u32 m0, s89, 102912
  ds_read_b64_tr_b16 v[204:205], v13 offset:25792
  ds_read_b64_tr_b16 v[206:207], v13 offset:29376
  v_mfma_f32_16x16x32_bf16 v[168:171], v[212:215], v[124:127], v[168:171]
  buffer_load_dwordx4 v19, s[24:27], s67 offen  lds
  ds_read_b64_tr_b16 v[208:209], v13 offset:32768
  ds_read_b64_tr_b16 v[210:211], v13 offset:36352
  s_waitcnt lgkmcnt(6)
  v_mfma_f32_16x16x32_bf16 v[172:175], v[92:95], v[124:127], v[172:175]
  s_add_u32 m0, s89, 103936
  ds_read_b64_tr_b16 v[212:213], v13 offset:32800
  ds_read_b64_tr_b16 v[214:215], v13 offset:36384
  v_mfma_f32_16x16x32_bf16 v[176:179], v[96:99], v[124:127], v[176:179]
  buffer_load_dwordx4 v20, s[24:27], s67 offen  lds
  ds_read_b64_tr_b16 v[92:93], v13 offset:32832
  ds_read_b64_tr_b16 v[94:95], v13 offset:36416
  v_mfma_f32_16x16x32_bf16 v[180:183], v[100:103], v[124:127], v[180:183]
  s_add_u32 m0, s89, 104960
  ds_read_b64_tr_b16 v[96:97], v13 offset:32864
  ds_read_b64_tr_b16 v[98:99], v13 offset:36448
  v_mfma_f32_16x16x32_bf16 v[184:187], v[196:199], v[124:127], v[184:187]
  buffer_load_dwordx4 v21, s[24:27], s67 offen  lds
  ds_read_b64_tr_b16 v[100:101], v13 offset:32896
  ds_read_b64_tr_b16 v[102:103], v13 offset:36480
  s_waitcnt lgkmcnt(6)
  v_mfma_f32_16x16x32_bf16 v[188:191], v[200:203], v[124:127], v[188:191]
  s_add_u32 m0, s89, 105984
  ds_read_b64_tr_b16 v[196:197], v13 offset:32928
  ds_read_b64_tr_b16 v[198:199], v13 offset:36512
  v_mfma_f32_16x16x32_bf16 v[192:195], v[204:207], v[124:127], v[192:195]
  buffer_load_dwordx4 v22, s[24:27], s67 offen  lds
  ds_read_b64_tr_b16 v[200:201], v13 offset:32960
  ds_read_b64_tr_b16 v[202:203], v13 offset:36544
  v_mfma_f32_16x16x32_bf16 v[168:171], v[208:211], v[128:131], v[168:171]
  s_add_u32 s65, s60, 0
  s_and_b32 s66, s65, 2
  ds_read_b64_tr_b16 v[204:205], v13 offset:39936
  ds_read_b64_tr_b16 v[206:207], v13 offset:43520
  v_mfma_f32_16x16x32_bf16 v[172:175], v[212:215], v[128:131], v[172:175]
  s_and_b32 s65, s65, 3
  s_add_u32 s65, s65, s66
  ds_read_b64_tr_b16 v[208:209], v13 offset:39968
  ds_read_b64_tr_b16 v[210:211], v13 offset:43552
  s_waitcnt lgkmcnt(6)
  v_mfma_f32_16x16x32_bf16 v[176:179], v[92:95], v[128:131], v[176:179]
  s_lshl_b32 s65, s65, 14
  s_add_u32 m0, s94, s65
  ds_read_b64_tr_b16 v[212:213], v13 offset:40000
  ds_read_b64_tr_b16 v[214:215], v13 offset:43584
  v_mfma_f32_16x16x32_bf16 v[180:183], v[96:99], v[128:131], v[180:183]
  s_lshl_b32 s65, s65, 3
  s_add_u32 s65, s65, s91
  ds_read_b64_tr_b16 v[92:93], v13 offset:40032
  ds_read_b64_tr_b16 v[94:95], v13 offset:43616
  v_mfma_f32_16x16x32_bf16 v[184:187], v[100:103], v[128:131], v[184:187]
  buffer_load_dwordx4 v5, s[36:39], s65 offen  lds
  ds_read_b64_tr_b16 v[96:97], v13 offset:40064
  ds_read_b64_tr_b16 v[98:99], v13 offset:43648
  v_mfma_f32_16x16x32_bf16 v[188:191], v[196:199], v[128:131], v[188:191]
  s_lshl_b32 s85, s59, 5
  s_add_u32 s86, s85, s60
  ds_read_b64_tr_b16 v[100:101], v13 offset:40096
  ds_read_b64_tr_b16 v[102:103], v13 offset:43680
  s_waitcnt lgkmcnt(6)
  v_mfma_f32_16x16x32_bf16 v[192:195], v[200:203], v[128:131], v[192:195]
  buffer_load_dwordx4 v6, s[36:39], s65 offen offset:1024  lds
  ds_read_b64_tr_b16 v[196:197], v13 offset:40128
  ds_read_b64_tr_b16 v[198:199], v13 offset:43712
  v_mfma_f32_16x16x32_bf16 v[168:171], v[204:207], v[132:135], v[168:171]
  s_lshl_b32 s86, s86, 4
  s_add_u32 s86, s86, s56
  ds_read_b64_tr_b16 v[200:201], v11 offset:33280
  ds_read_b64_tr_b16 v[202:203], v11 offset:36864
  v_mfma_f32_16x16x32_bf16 v[172:175], v[208:211], v[132:135], v[172:175]
  buffer_load_dwordx4 v7, s[36:39], s65 offen offset:2048  lds
  ds_read_b64_tr_b16 v[204:205], v11 offset:33312
  ds_read_b64_tr_b16 v[206:207], v11 offset:36896
  v_mfma_f32_16x16x32_bf16 v[176:179], v[212:215], v[132:135], v[176:179]
  s_lshl_b32 s86, s86, 3
  s_add_u32 s86, s86, 786432
  ds_read_b64_tr_b16 v[208:209], v11 offset:33344
  ds_read_b64_tr_b16 v[210:211], v11 offset:36928
  s_waitcnt lgkmcnt(6)
  v_mfma_f32_16x16x32_bf16 v[180:183], v[92:95], v[132:135], v[180:183]
  buffer_load_dwordx4 v8, s[36:39], s65 offen offset:3072  lds
  ds_read_b64_tr_b16 v[212:213], v11 offset:33376
  ds_read_b64_tr_b16 v[214:215], v11 offset:36960
  v_mfma_f32_16x16x32_bf16 v[184:187], v[96:99], v[132:135], v[184:187]
  v_mov_b32 v36, s61
  v_mov_b32_e64 v23, 0
  ds_read_b64_tr_b16 v[92:93], v11 offset:33408
  ds_read_b64_tr_b16 v[94:95], v11 offset:36992
  v_mfma_f32_16x16x32_bf16 v[188:191], v[100:103], v[132:135], v[188:191]
  s_add_u32 s65, s60, 1
  s_and_b32 s66, s65, 2
  ds_read_b64_tr_b16 v[96:97], v11 offset:33440
  ds_read_b64_tr_b16 v[98:99], v11 offset:37024
  v_mfma_f32_16x16x32_bf16 v[192:195], v[196:199], v[132:135], v[192:195]
  s_and_b32 s65, s65, 3
  s_add_u32 s65, s65, s66
  ds_read_b64_tr_b16 v[100:101], v11 offset:33472
  ds_read_b64_tr_b16 v[102:103], v11 offset:37056
  s_waitcnt lgkmcnt(6)
  v_mfma_f32_16x16x32_bf16 v[168:171], v[200:203], v[136:139], v[168:171]
  s_lshl_b32 s65, s65, 14
  s_add_u32 m0, s94, s65
  ds_read_b64_tr_b16 v[196:197], v11 offset:40448
  ds_read_b64_tr_b16 v[198:199], v11 offset:44032
  v_mfma_f32_16x16x32_bf16 v[172:175], v[204:207], v[136:139], v[172:175]
  s_lshl_b32 s65, s65, 3
  s_add_u32 s65, s65, s91
  ds_read_b64_tr_b16 v[200:201], v11 offset:40480
  ds_read_b64_tr_b16 v[202:203], v11 offset:44064
  v_mfma_f32_16x16x32_bf16 v[176:179], v[208:211], v[136:139], v[176:179]
  buffer_load_dwordx4 v5, s[36:39], s65 offen  lds
  ds_read_b64_tr_b16 v[204:205], v11 offset:40512
  ds_read_b64_tr_b16 v[206:207], v11 offset:44096
  v_mfma_f32_16x16x32_bf16 v[180:183], v[212:215], v[136:139], v[180:183]
  s_add_u32 s85, s85, s56
  s_lshl_b32 s85, s85, 7
  ds_read_b64_tr_b16 v[208:209], v11 offset:40544
  ds_read_b64_tr_b16 v[210:211], v11 offset:44128
  s_waitcnt lgkmcnt(6)
  v_mfma_f32_16x16x32_bf16 v[184:187], v[92:95], v[136:139], v[184:187]
  buffer_load_dwordx4 v6, s[36:39], s65 offen offset:1024  lds
  ds_read_b64_tr_b16 v[212:213], v11 offset:40576
  ds_read_b64_tr_b16 v[214:215], v11 offset:44160
  v_mfma_f32_16x16x32_bf16 v[188:191], v[96:99], v[136:139], v[188:191]
  s_add_u32 s85, s85, 786432
  v_mov_b32_e64 v37, v4
  ds_read_b64_tr_b16 v[92:93], v11 offset:40608
  ds_read_b64_tr_b16 v[94:95], v11 offset:44192
  v_mfma_f32_16x16x32_bf16 v[192:195], v[100:103], v[136:139], v[192:195]
  buffer_load_dwordx4 v7, s[36:39], s65 offen offset:2048  lds
  s_waitcnt vmcnt(7)
  s_barrier
  s_cmp_eq_u32 s56, 0
  s_cbranch_scc0 L_arm_99
  s_mov_b64 exec, 1
  buffer_store_dword v36, v23, s[52:55], s86 offen sc1
  s_mov_b64 exec, -1
L_arm_99:
L_join_98:
  v_lshrrev_b32 v23, 3, v1
  v_lshlrev_b32 v23, 9, v23
  ds_read_b64_tr_b16 v[96:97], v11 offset:40640
  ds_read_b64_tr_b16 v[98:99], v11 offset:44224
  v_mfma_f32_16x16x32_bf16 v[168:171], v[196:199], v[140:143], v[168:171]
  s_mul_i32 s67, s59, 458752
  s_lshl_b32 s68, s56, 11
  ds_read_b64_tr_b16 v[100:101], v11 offset:47616
  ds_read_b64_tr_b16 v[102:103], v11 offset:51200
  s_waitcnt lgkmcnt(6)
  v_mfma_f32_16x16x32_bf16 v[172:175], v[200:203], v[140:143], v[172:175]
  buffer_load_dwordx4 v8, s[36:39], s65 offen offset:3072  lds
  ds_read_b64_tr_b16 v[196:197], v11 offset:47648
  ds_read_b64_tr_b16 v[198:199], v11 offset:51232
  v_mfma_f32_16x16x32_bf16 v[176:179], v[204:207], v[140:143], v[176:179]
  s_add_u32 s67, s67, s68
  s_add_u32 s67, s67, 16777216
  ds_read_b64_tr_b16 v[200:201], v11 offset:47680
  ds_read_b64_tr_b16 v[202:203], v11 offset:51264
  v_mfma_f32_16x16x32_bf16 v[180:183], v[208:211], v[140:143], v[180:183]
  s_add_u32 s65, s60, 2
  s_and_b32 s66, s65, 2
  ds_read_b64_tr_b16 v[204:205], v11 offset:47712
  ds_read_b64_tr_b16 v[206:207], v11 offset:51296
  v_mfma_f32_16x16x32_bf16 v[184:187], v[212:215], v[140:143], v[184:187]
  s_and_b32 s65, s65, 3
  s_add_u32 s65, s65, s66
  ds_read_b64_tr_b16 v[208:209], v11 offset:47744
  ds_read_b64_tr_b16 v[210:211], v11 offset:51328
  s_waitcnt lgkmcnt(6)
  v_mfma_f32_16x16x32_bf16 v[188:191], v[92:95], v[140:143], v[188:191]
  s_lshl_b32 s65, s65, 14
  s_add_u32 m0, s94, s65
  ds_read_b64_tr_b16 v[212:213], v11 offset:47776
  ds_read_b64_tr_b16 v[214:215], v11 offset:51360
  v_mfma_f32_16x16x32_bf16 v[192:195], v[96:99], v[140:143], v[192:195]
  s_lshl_b32 s65, s65, 3
  s_add_u32 s65, s65, s91
  ds_read_b64_tr_b16 v[92:93], v11 offset:47808
  ds_read_b64_tr_b16 v[94:95], v11 offset:51392
  v_mfma_f32_16x16x32_bf16 v[168:171], v[100:103], v[144:147], v[168:171]
  buffer_load_dwordx4 v5, s[36:39], s65 offen  lds
  ds_read_b64_tr_b16 v[96:97], v11 offset:54784
  ds_read_b64_tr_b16 v[98:99], v11 offset:58368
  v_mfma_f32_16x16x32_bf16 v[172:175], v[196:199], v[144:147], v[172:175]
  s_lshl_b32 s76, s76, 4
  s_add_u32 s76, s76, s67
  ds_read_b64_tr_b16 v[100:101], v11 offset:54816
  ds_read_b64_tr_b16 v[102:103], v11 offset:58400
  s_waitcnt lgkmcnt(6)
  v_mfma_f32_16x16x32_bf16 v[176:179], v[200:203], v[144:147], v[176:179]
  buffer_load_dwordx4 v6, s[36:39], s65 offen offset:1024  lds
  ds_read_b64_tr_b16 v[196:197], v11 offset:54848
  ds_read_b64_tr_b16 v[198:199], v11 offset:58432
  v_mfma_f32_16x16x32_bf16 v[180:183], v[204:207], v[144:147], v[180:183]
  s_lshl_b32 s77, s77, 4
  s_add_u32 s77, s77, s67
  ds_read_b64_tr_b16 v[200:201], v11 offset:54880
  ds_read_b64_tr_b16 v[202:203], v11 offset:58464
  v_mfma_f32_16x16x32_bf16 v[184:187], v[208:211], v[144:147], v[184:187]
  buffer_load_dwordx4 v7, s[36:39], s65 offen offset:2048  lds
  ds_read_b64_tr_b16 v[204:205], v11 offset:54912
  ds_read_b64_tr_b16 v[206:207], v11 offset:58496
  v_mfma_f32_16x16x32_bf16 v[188:191], v[212:215], v[144:147], v[188:191]
  s_lshl_b32 s78, s78, 4
  s_add_u32 s78, s78, s67
  ds_read_b64_tr_b16 v[208:209], v11 offset:54944
  ds_read_b64_tr_b16 v[210:211], v11 offset:58528
  s_waitcnt lgkmcnt(6)
  v_mfma_f32_16x16x32_bf16 v[192:195], v[92:95], v[144:147], v[192:195]
  buffer_load_dwordx4 v8, s[36:39], s65 offen offset:3072  lds
  ds_read_b64_tr_b16 v[212:213], v11 offset:54976
  ds_read_b64_tr_b16 v[214:215], v11 offset:58560
  v_mfma_f32_16x16x32_bf16 v[168:171], v[96:99], v[148:151], v[168:171]
  s_lshl_b32 s79, s79, 4
  s_add_u32 s79, s79, s67
  ds_read_b64_tr_b16 v[92:93], v12 offset:42496
  ds_read_b64_tr_b16 v[94:95], v12 offset:46080
  v_mfma_f32_16x16x32_bf16 v[172:175], v[100:103], v[148:151], v[172:175]
  s_add_u32 s65, s60, 3
  s_and_b32 s66, s65, 2
  ds_read_b64_tr_b16 v[96:97], v12 offset:42528
  ds_read_b64_tr_b16 v[98:99], v12 offset:46112
  v_mfma_f32_16x16x32_bf16 v[176:179], v[196:199], v[148:151], v[176:179]
  s_and_b32 s65, s65, 3
  s_add_u32 s65, s65, s66
  ds_read_b64_tr_b16 v[100:101], v12 offset:42560
  ds_read_b64_tr_b16 v[102:103], v12 offset:46144
  s_waitcnt lgkmcnt(6)
  v_mfma_f32_16x16x32_bf16 v[180:183], v[200:203], v[148:151], v[180:183]
  s_lshl_b32 s65, s65, 14
  s_add_u32 m0, s94, s65
  ds_read_b64_tr_b16 v[196:197], v12 offset:42592
  ds_read_b64_tr_b16 v[198:199], v12 offset:46176
  v_mfma_f32_16x16x32_bf16 v[184:187], v[204:207], v[148:151], v[184:187]
  s_lshl_b32 s65, s65, 3
  s_add_u32 s65, s65, s91
  ds_read_b64_tr_b16 v[200:201], v12 offset:42624
  ds_read_b64_tr_b16 v[202:203], v12 offset:46208
  v_mfma_f32_16x16x32_bf16 v[188:191], v[208:211], v[148:151], v[188:191]
  buffer_load_dwordx4 v5, s[36:39], s65 offen  lds
  ds_read_b64_tr_b16 v[204:205], v12 offset:42656
  ds_read_b64_tr_b16 v[206:207], v12 offset:46240
  v_mfma_f32_16x16x32_bf16 v[192:195], v[212:215], v[148:151], v[192:195]
  s_lshl_b32 s80, s80, 4
  s_add_u32 s80, s80, s67
  ds_read_b64_tr_b16 v[208:209], v12 offset:42688
  ds_read_b64_tr_b16 v[210:211], v12 offset:46272
  s_waitcnt lgkmcnt(6)
  v_mfma_f32_16x16x32_bf16 v[168:171], v[92:95], v[152:155], v[168:171]
  buffer_load_dwordx4 v6, s[36:39], s65 offen offset:1024  lds
  ds_read_b64_tr_b16 v[212:213], v12 offset:49664
  ds_read_b64_tr_b16 v[214:215], v12 offset:53248
  v_mfma_f32_16x16x32_bf16 v[172:175], v[96:99], v[152:155], v[172:175]
  s_lshl_b32 s81, s81, 4
  s_add_u32 s81, s81, s67
  ds_read_b64_tr_b16 v[92:93], v12 offset:49696
  ds_read_b64_tr_b16 v[94:95], v12 offset:53280
  v_mfma_f32_16x16x32_bf16 v[176:179], v[100:103], v[152:155], v[176:179]
  buffer_load_dwordx4 v7, s[36:39], s65 offen offset:2048  lds
  ds_read_b64_tr_b16 v[96:97], v12 offset:49728
  ds_read_b64_tr_b16 v[98:99], v12 offset:53312
  v_mfma_f32_16x16x32_bf16 v[180:183], v[196:199], v[152:155], v[180:183]
  s_lshl_b32 s82, s82, 4
  s_add_u32 s82, s82, s67
  ds_read_b64_tr_b16 v[100:101], v12 offset:49760
  ds_read_b64_tr_b16 v[102:103], v12 offset:53344
  s_waitcnt lgkmcnt(6)
  v_mfma_f32_16x16x32_bf16 v[184:187], v[200:203], v[152:155], v[184:187]
  buffer_load_dwordx4 v8, s[36:39], s65 offen offset:3072  lds
  ds_read_b64_tr_b16 v[196:197], v12 offset:49792
  ds_read_b64_tr_b16 v[198:199], v12 offset:53376
  v_mfma_f32_16x16x32_bf16 v[188:191], v[204:207], v[152:155], v[188:191]
  s_lshl_b32 s83, s83, 4
  s_add_u32 s83, s83, s67
  ds_read_b64_tr_b16 v[200:201], v12 offset:49824
  ds_read_b64_tr_b16 v[202:203], v12 offset:53408
  v_mfma_f32_16x16x32_bf16 v[192:195], v[208:211], v[152:155], v[192:195]
  ds_read_b64_tr_b16 v[204:205], v12 offset:49856
  ds_read_b64_tr_b16 v[206:207], v12 offset:53440
  v_mfma_f32_16x16x32_bf16 v[168:171], v[212:215], v[156:159], v[168:171]
  ds_read_b64_tr_b16 v[208:209], v12 offset:56832
  ds_read_b64_tr_b16 v[210:211], v12 offset:60416
  s_waitcnt lgkmcnt(6)
  v_mfma_f32_16x16x32_bf16 v[172:175], v[92:95], v[156:159], v[172:175]
  buffer_load_dword v41, v23, s[52:55], s85 offen sc1
  ds_read_b64_tr_b16 v[212:213], v12 offset:56864
  ds_read_b64_tr_b16 v[214:215], v12 offset:60448
  v_mfma_f32_16x16x32_bf16 v[176:179], v[96:99], v[156:159], v[176:179]
  ds_read_b64_tr_b16 v[92:93], v12 offset:56896
  ds_read_b64_tr_b16 v[94:95], v12 offset:60480
  v_mfma_f32_16x16x32_bf16 v[180:183], v[100:103], v[156:159], v[180:183]
  ds_read_b64_tr_b16 v[96:97], v12 offset:56928
  ds_read_b64_tr_b16 v[98:99], v12 offset:60512
  v_mfma_f32_16x16x32_bf16 v[184:187], v[196:199], v[156:159], v[184:187]
  ds_read_b64_tr_b16 v[100:101], v12 offset:56960
  ds_read_b64_tr_b16 v[102:103], v12 offset:60544
  s_waitcnt lgkmcnt(6)
  v_mfma_f32_16x16x32_bf16 v[188:191], v[200:203], v[156:159], v[188:191]
  ds_read_b64_tr_b16 v[196:197], v12 offset:56992
  ds_read_b64_tr_b16 v[198:199], v12 offset:60576
  v_mfma_f32_16x16x32_bf16 v[192:195], v[204:207], v[156:159], v[192:195]
  ds_read_b64_tr_b16 v[200:201], v12 offset:57024
  ds_read_b64_tr_b16 v[202:203], v12 offset:60608
  v_mfma_f32_16x16x32_bf16 v[168:171], v[208:211], v[160:163], v[168:171]
  ds_read_b64_tr_b16 v[204:205], v13 offset:6656
  ds_read_b64_tr_b16 v[206:207], v13 offset:10240
  v_mfma_f32_16x16x32_bf16 v[172:175], v[212:215], v[160:163], v[172:175]
  ds_read_b64_tr_b16 v[208:209], v13 offset:6688
  ds_read_b64_tr_b16 v[210:211], v13 offset:10272
  s_waitcnt lgkmcnt(6)
  v_mfma_f32_16x16x32_bf16 v[176:179], v[92:95], v[160:163], v[176:179]
  ds_read_b64_tr_b16 v[212:213], v13 offset:6720
  ds_read_b64_tr_b16 v[214:215], v13 offset:10304
  v_mfma_f32_16x16x32_bf16 v[180:183], v[96:99], v[160:163], v[180:183]
  ds_read_b64_tr_b16 v[92:93], v13 offset:6752
  ds_read_b64_tr_b16 v[94:95], v13 offset:10336
  v_mfma_f32_16x16x32_bf16 v[184:187], v[100:103], v[160:163], v[184:187]
  ds_read_b64_tr_b16 v[96:97], v13 offset:6784
  ds_read_b64_tr_b16 v[98:99], v13 offset:10368
  v_mfma_f32_16x16x32_bf16 v[188:191], v[196:199], v[160:163], v[188:191]
  s_waitcnt vmcnt(0)
  v_cmp_ne_u32 vcc, s61, v41
  s_cbranch_vccnz L_rare_100
L_back_101:
  ds_read_b64_tr_b16 v[100:101], v13 offset:6816
  ds_read_b64_tr_b16 v[102:103], v13 offset:10400
  s_waitcnt lgkmcnt(6)
  v_mfma_f32_16x16x32_bf16 v[192:195], v[200:203], v[160:163], v[192:195]
  buffer_load_dwordx4 v[44:47], v37, s[52:55], s76 offen offset:0 sc1
  ds_read_b64_tr_b16 v[196:197], v13 offset:6848
  ds_read_b64_tr_b16 v[198:199], v13 offset:10432
  v_mfma_f32_16x16x32_bf16 v[168:171], v[204:207], v[164:167], v[168:171]
  buffer_load_dwordx4 v[48:51], v37, s[52:55], s76 offen offset:1024 sc1
  v_mfma_f32_16x16x32_bf16 v[172:175], v[208:211], v[164:167], v[172:175]
  buffer_load_dwordx4 v[52:55], v37, s[52:55], s77 offen offset:0 sc1
  v_mfma_f32_16x16x32_bf16 v[176:179], v[212:215], v[164:167], v[176:179]
  buffer_load_dwordx4 v[56:59], v37, s[52:55], s77 offen offset:1024 sc1
  s_waitcnt lgkmcnt(0)
  v_mfma_f32_16x16x32_bf16 v[180:183], v[92:95], v[164:167], v[180:183]
  buffer_load_dwordx4 v[60:63], v37, s[52:55], s78 offen offset:0 sc1
  v_mfma_f32_16x16x32_bf16 v[184:187], v[96:99], v[164:167], v[184:187]
  buffer_load_dwordx4 v[64:67], v37, s[52:55], s78 offen offset:1024 sc1
  v_mfma_f32_16x16x32_bf16 v[188:191], v[100:103], v[164:167], v[188:191]
  buffer_load_dwordx4 v[68:71], v37, s[52:55], s79 offen offset:0 sc1
  v_mfma_f32_16x16x32_bf16 v[192:195], v[196:199], v[164:167], v[192:195]
  buffer_load_dwordx4 v[72:75], v37, s[52:55], s79 offen offset:1024 sc1
  s_barrier
  v_add_u32 v40, 0x10000, v4
  v_mov_b32 v12, 0xc0135761
  v_mov_b32 v13, 0xc0135761
  s_mov_b32 s72, 0xbdd2d3e8
  s_mov_b32 s73, 0xbdd2d3e8
  buffer_load_dwordx4 v[76:79], v37, s[52:55], s80 offen offset:0 sc1
  buffer_load_dwordx4 v[80:83], v37, s[52:55], s80 offen offset:1024 sc1
  s_add_u32 s65, s56, 1
  s_and_b32 s65, s65, 3
  s_mul_i32 s65, s65, 3072
  s_add_u32 s65, s65, 114688
  v_add_u32_e64 v20, s65, v4
  s_add_u32 s65, s56, 2
  s_and_b32 s65, s65, 3
  s_mul_i32 s65, s65, 3072
  s_add_u32 s65, s65, 115712
  v_add_u32_e64 v21, s65, v4
  s_add_u32 s65, s56, 3
  s_and_b32 s65, s65, 3
  s_mul_i32 s65, s65, 3072
  s_add_u32 s65, s65, 116736
  v_add_u32_e64 v22, s65, v4
  s_mul_i32 s65, s56, 3072
  s_add_u32 s65, s65, 114688
  v_add_u32 v11, s65, v4
  v_lshlrev_b32 v15, 16, v15
  s_mul_i32 s86, s56, 28672
  s_add_u32 s86, s86, s3
  s_lshr_b32 s65, s59, 1
  s_mul_i32 s65, s65, 7168
  s_add_u32 s65, s65, s86
  s_and_b32 s66, s59, 1
  s_mul_i32 s67, s66, 3072
  s_add_u32 s85, s65, s67
  s_lshl_b32 s66, s66, 3
  s_add_u32 s65, s65, s66
  s_add_u32 s84, s65, 6144
  s_and_b32 s90, s60, 3
  s_lshl_b32 s90, s90, 2
  s_add_u32 s90, s90, s56
  s_lshl_b32 s90, s90, 7
  s_add_u32 s90, s90, s100
  s_add_u32 s90, s90, 23552
  s_lshl_b32 s93, s59, 2
  s_add_u32 s93, s93, s90
  v_and_b32 v23, 7, v1
  v_lshlrev_b32_e64 v23, 2, v23
  s_add_u32 s12, s86, 0
  s_add_u32 s13, s86, 4096
  s_add_u32 s14, s86, 8192
  s_add_u32 s15, s86, 12288
  s_add_u32 s16, s86, 16384
  s_add_u32 s17, s86, 20480
  s_add_u32 s18, s86, 24576
  s_waitcnt vmcnt(9)
  v_mfma_f32_16x16x32_bf16 v[92:95], v[44:47], a[0:3], 0
  buffer_load_dwordx4 v[84:87], v37, s[52:55], s81 offen offset:0 sc1
  v_mfma_f32_16x16x32_bf16 v[120:123], v[44:47], a[64:67], 0
  v_mul_f32 v16, v168, v168
  v_mul_f32_e64 v17, v169, v169
  v_mfma_f32_16x16x32_bf16 v[124:127], v[44:47], a[128:131], 0
  v_mul_f32 v18, v170, v170
  v_mul_f32 v19, v171, v171
  v_mfma_f32_16x16x32_bf16 v[128:131], v[44:47], a[192:195], 0
  v_fma_f32 v16, v16, s72, v12
  v_fma_f32 v17, v17, s72, v12
  s_waitcnt vmcnt(9)
  v_mfma_f32_16x16x32_bf16 v[92:95], v[48:51], a[4:7], v[92:95]
  buffer_load_dwordx4 v[88:91], v37, s[52:55], s81 offen offset:1024 sc1
  v_mfma_f32_16x16x32_bf16 v[120:123], v[48:51], a[68:71], v[120:123]
  v_fma_f32 v18, v18, s72, v12
  v_fma_f32 v19, v19, s72, v12
  v_mfma_f32_16x16x32_bf16 v[124:127], v[48:51], a[132:135], v[124:127]
  v_mul_f32 v16, v16, v168
  v_mul_f32_e64 v17, v17, v169
  v_mfma_f32_16x16x32_bf16 v[128:131], v[48:51], a[196:199], v[128:131]
  v_mul_f32 v18, v18, v170
  v_mul_f32_e64 v19, v19, v171
  s_waitcnt vmcnt(9)
  v_mfma_f32_16x16x32_bf16 v[92:95], v[52:55], a[8:11], v[92:95]
  buffer_load_dwordx4 v[44:47], v37, s[52:55], s82 offen offset:0 sc1
  v_mfma_f32_16x16x32_bf16 v[120:123], v[52:55], a[72:75], v[120:123]
  v_exp_f32_e64 v16, v16
  v_mfma_f32_16x16x32_bf16 v[124:127], v[52:55], a[136:139], v[124:127]
  v_exp_f32_e64 v17, v17
  v_mfma_f32_16x16x32_bf16 v[128:131], v[52:55], a[200:203], v[128:131]
  v_exp_f32 v18, v18
  s_waitcnt vmcnt(9)
  v_mfma_f32_16x16x32_bf16 v[92:95], v[56:59], a[12:15], v[92:95]
  buffer_load_dwordx4 v[48:51], v37, s[52:55], s82 offen offset:1024 sc1
  v_mfma_f32_16x16x32_bf16 v[120:123], v[56:59], a[76:79], v[120:123]
  v_exp_f32_e64 v19, v19
  v_mfma_f32_16x16x32_bf16 v[124:127], v[56:59], a[140:143], v[124:127]
  v_add_f32 v16, 1.0, v16
  v_add_f32 v17, 1.0, v17
  v_mfma_f32_16x16x32_bf16 v[128:131], v[56:59], a[204:207], v[128:131]
  v_add_f32 v18, 1.0, v18
  v_add_f32_e64 v19, 1.0, v19
  s_waitcnt vmcnt(9)
  v_mfma_f32_16x16x32_bf16 v[92:95], v[60:63], a[16:19], v[92:95]
  buffer_load_dwordx4 v[52:55], v37, s[52:55], s83 offen offset:0 sc1
  v_mfma_f32_16x16x32_bf16 v[120:123], v[60:63], a[80:83], v[120:123]
  v_rcp_f32_e64 v16, v16
  v_mfma_f32_16x16x32_bf16 v[124:127], v[60:63], a[144:147], v[124:127]
  v_rcp_f32_e64 v17, v17
  v_mfma_f32_16x16x32_bf16 v[128:131], v[60:63], a[208:211], v[128:131]
  v_rcp_f32 v18, v18
  s_waitcnt vmcnt(9)
  v_mfma_f32_16x16x32_bf16 v[92:95], v[64:67], a[20:23], v[92:95]
  buffer_load_dwordx4 v[56:59], v37, s[52:55], s83 offen offset:1024 sc1
  v_mfma_f32_16x16x32_bf16 v[120:123], v[64:67], a[84:87], v[120:123]
  v_rcp_f32_e64 v19, v19
  v_mfma_f32_16x16x32_bf16 v[124:127], v[64:67], a[148:151], v[124:127]
  v_mul_f32 v168, v168, v16
  v_mul_f32 v169, v169, v17
  v_mfma_f32_16x16x32_bf16 v[128:131], v[64:67], a[212:215], v[128:131]
  v_mul_f32 v170, v170, v18
  v_mul_f32_e64 v171, v171, v19
  s_waitcnt vmcnt(9)
  v_mfma_f32_16x16x32_bf16 v[92:95], v[68:71], a[24:27], v[92:95]
  buffer_load_dwordx4 v[60:63], v40, s[52:55], s76 offen offset:0 sc1
  v_mfma_f32_16x16x32_bf16 v[120:123], v[68:71], a[88:91], v[120:123]
  v_mul_f32 v16, v172, v172
  v_mul_f32 v17, v173, v173
  v_mfma_f32_16x16x32_bf16 v[124:127], v[68:71], a[152:155], v[124:127]
  v_mul_f32 v18, v174, v174
  v_mul_f32 v19, v175, v175
  v_mfma_f32_16x16x32_bf16 v[128:131], v[68:71], a[216:219], v[128:131]
  v_fma_f32 v16, v16, s72, v12
  v_fma_f32 v17, v17, s72, v12
  s_waitcnt vmcnt(9)
  v_mfma_f32_16x16x32_bf16 v[92:95], v[72:75], a[28:31], v[92:95]
  buffer_load_dwordx4 v[64:67], v40, s[52:55], s76 offen offset:1024 sc1
  v_mfma_f32_16x16x32_bf16 v[120:123], v[72:75], a[92:95], v[120:123]
  v_fma_f32 v18, v18, s72, v12
  v_fma_f32 v19, v19, s72, v12
  v_mfma_f32_16x16x32_bf16 v[124:127], v[72:75], a[156:159], v[124:127]
  v_mul_f32 v16, v16, v172
  v_mul_f32_e64 v17, v17, v173
  v_mfma_f32_16x16x32_bf16 v[128:131], v[72:75], a[220:223], v[128:131]
  v_mul_f32 v18, v18, v174
  v_mul_f32_e64 v19, v19, v175
  s_waitcnt vmcnt(9)
  v_mfma_f32_16x16x32_bf16 v[92:95], v[76:79], a[32:35], v[92:95]
  buffer_load_dwordx4 v[68:71], v40, s[52:55], s77 offen offset:0 sc1
  v_mfma_f32_16x16x32_bf16 v[120:123], v[76:79], a[96:99], v[120:123]
  v_exp_f32_e64 v16, v16
  v_mfma_f32_16x16x32_bf16 v[124:127], v[76:79], a[160:163], v[124:127]
  v_exp_f32_e64 v17, v17
  v_mfma_f32_16x16x32_bf16 v[128:131], v[76:79], a[224:227], v[128:131]
  v_exp_f32 v18, v18
  s_waitcnt vmcnt(9)
  v_mfma_f32_16x16x32_bf16 v[92:95], v[80:83], a[36:39], v[92:95]
  buffer_load_dwordx4 v[72:75], v40, s[52:55], s77 offen offset:1024 sc1
  v_mfma_f32_16x16x32_bf16 v[120:123], v[80:83], a[100:103], v[120:123]
  v_exp_f32_e64 v19, v19
  v_mfma_f32_16x16x32_bf16 v[124:127], v[80:83], a[164:167], v[124:127]
  v_add_f32 v16, 1.0, v16
  v_add_f32 v17, 1.0, v17
  v_mfma_f32_16x16x32_bf16 v[128:131], v[80:83], a[228:231], v[128:131]
  v_add_f32 v18, 1.0, v18
  v_add_f32_e64 v19, 1.0, v19
  s_waitcnt vmcnt(9)
  v_mfma_f32_16x16x32_bf16 v[92:95], v[84:87], a[40:43], v[92:95]
  buffer_load_dwordx4 v[76:79], v40, s[52:55], s78 offen offset:0 sc1
  v_mfma_f32_16x16x32_bf16 v[120:123], v[84:87], a[104:107], v[120:123]
  v_rcp_f32_e64 v16, v16
  v_mfma_f32_16x16x32_bf16 v[124:127], v[84:87], a[168:171], v[124:127]
  v_rcp_f32_e64 v17, v17
  v_mfma_f32_16x16x32_bf16 v[128:131], v[84:87], a[232:235], v[128:131]
  v_rcp_f32 v18, v18
  s_waitcnt vmcnt(9)
  v_mfma_f32_16x16x32_bf16 v[92:95], v[88:91], a[44:47], v[92:95]
  buffer_load_dwordx4 v[80:83], v40, s[52:55], s78 offen offset:1024 sc1
  v_mfma_f32_16x16x32_bf16 v[120:123], v[88:91], a[108:111], v[120:123]
  v_rcp_f32_e64 v19, v19
  v_mfma_f32_16x16x32_bf16 v[124:127], v[88:91], a[172:175], v[124:127]
  v_mul_f32 v172, v172, v16
  v_mul_f32 v173, v173, v17
  v_mfma_f32_16x16x32_bf16 v[128:131], v[88:91], a[236:239], v[128:131]
  v_mul_f32 v174, v174, v18
  v_mul_f32_e64 v175, v175, v19
  s_waitcnt vmcnt(9)
  v_mfma_f32_16x16x32_bf16 v[92:95], v[44:47], a[48:51], v[92:95]
  buffer_load_dwordx4 v[84:87], v40, s[52:55], s79 offen offset:0 sc1
  v_mfma_f32_16x16x32_bf16 v[120:123], v[44:47], a[112:115], v[120:123]
  v_mul_f32 v16, v176, v176
  v_mul_f32 v17, v177, v177
  v_mfma_f32_16x16x32_bf16 v[124:127], v[44:47], a[176:179], v[124:127]
  v_mul_f32 v18, v178, v178
  v_mul_f32 v19, v179, v179
  v_mfma_f32_16x16x32_bf16 v[128:131], v[44:47], a[240:243], v[128:131]
  v_fma_f32 v16, v16, s72, v12
  v_fma_f32 v17, v17, s72, v12
  s_waitcnt vmcnt(9)
  v_mfma_f32_16x16x32_bf16 v[92:95], v[48:51], a[52:55], v[92:95]
  buffer_load_dwordx4 v[88:91], v40, s[52:55], s79 offen offset:1024 sc1
  v_mfma_f32_16x16x32_bf16 v[120:123], v[48:51], a[116:119], v[120:123]
  v_fma_f32 v18, v18, s72, v12
  v_fma_f32 v19, v19, s72, v12
  v_mfma_f32_16x16x32_bf16 v[124:127], v[48:51], a[180:183], v[124:127]
  v_mul_f32 v16, v16, v176
  v_mul_f32_e64 v17, v17, v177
  v_mfma_f32_16x16x32_bf16 v[128:131], v[48:51], a[244:247], v[128:131]
  v_mul_f32 v18, v18, v178
  v_mul_f32_e64 v19, v19, v179
  s_waitcnt vmcnt(9)
  v_mfma_f32_16x16x32_bf16 v[92:95], v[52:55], a[56:59], v[92:95]
  buffer_load_dwordx4 v[44:47], v40, s[52:55], s80 offen offset:0 sc1
  v_mfma_f32_16x16x32_bf16 v[120:123], v[52:55], a[120:123], v[120:123]
  v_exp_f32_e64 v16, v16
  v_mfma_f32_16x16x32_bf16 v[124:127], v[52:55], a[184:187], v[124:127]
  v_exp_f32_e64 v17, v17
  v_mfma_f32_16x16x32_bf16 v[128:131], v[52:55], a[248:251], v[128:131]
  v_exp_f32 v18, v18
  s_waitcnt vmcnt(9)
  v_mfma_f32_16x16x32_bf16 v[92:95], v[56:59], a[60:63], v[92:95]
  buffer_load_dwordx4 v[48:51], v40, s[52:55], s80 offen offset:1024 sc1
  v_mfma_f32_16x16x32_bf16 v[120:123], v[56:59], a[124:127], v[120:123]
  v_exp_f32_e64 v19, v19
  v_mfma_f32_16x16x32_bf16 v[124:127], v[56:59], a[188:191], v[124:127]
  v_add_f32 v16, 1.0, v16
  v_add_f32 v17, 1.0, v17
  v_mfma_f32_16x16x32_bf16 v[128:131], v[56:59], a[252:255], v[128:131]
  v_add_f32 v18, 1.0, v18
  v_add_f32_e64 v19, 1.0, v19
  s_waitcnt vmcnt(9)
  v_mfma_f32_16x16x32_bf16 v[96:99], v[60:63], a[0:3], 0
  buffer_load_dwordx4 v[52:55], v40, s[52:55], s81 offen offset:0 sc1
  v_mfma_f32_16x16x32_bf16 v[132:135], v[60:63], a[64:67], 0
  v_rcp_f32_e64 v16, v16
  v_mfma_f32_16x16x32_bf16 v[136:139], v[60:63], a[128:131], 0
  v_rcp_f32_e64 v17, v17
  v_mfma_f32_16x16x32_bf16 v[140:143], v[60:63], a[192:195], 0
  v_rcp_f32 v18, v18
  s_waitcnt vmcnt(9)
  v_mfma_f32_16x16x32_bf16 v[96:99], v[64:67], a[4:7], v[96:99]
  buffer_load_dwordx4 v[56:59], v40, s[52:55], s81 offen offset:1024 sc1
  v_mfma_f32_16x16x32_bf16 v[132:135], v[64:67], a[68:71], v[132:135]
  ds_write_b128 v20, v[120:123] offset:0
  ds_write_b128 v21, v[124:127] offset:0
  ds_write_b128 v22, v[128:131] offset:0
  v_mfma_f32_16x16x32_bf16 v[136:139], v[64:67], a[132:135], v[136:139]
  v_rcp_f32_e64 v19, v19
  v_mfma_f32_16x16x32_bf16 v[140:143], v[64:67], a[196:199], v[140:143]
  v_mul_f32 v176, v176, v16
  v_mul_f32_e64 v177, v177, v17
  s_waitcnt vmcnt(9)
  v_mfma_f32_16x16x32_bf16 v[96:99], v[68:71], a[8:11], v[96:99]
  buffer_load_dwordx4 v[60:63], v40, s[52:55], s82 offen offset:0 sc1
  v_mfma_f32_16x16x32_bf16 v[132:135], v[68:71], a[72:75], v[132:135]
  v_mul_f32 v178, v178, v18
  v_mul_f32 v179, v179, v19
  v_mfma_f32_16x16x32_bf16 v[136:139], v[68:71], a[136:139], v[136:139]
  v_mul_f32 v16, v180, v180
  v_mul_f32 v17, v181, v181
  v_mfma_f32_16x16x32_bf16 v[140:143], v[68:71], a[200:203], v[140:143]
  v_mul_f32 v18, v182, v182
  v_mul_f32_e64 v19, v183, v183
  s_waitcnt vmcnt(9)
  v_mfma_f32_16x16x32_bf16 v[96:99], v[72:75], a[12:15], v[96:99]
  buffer_load_dwordx4 v[64:67], v40, s[52:55], s82 offen offset:1024 sc1
  v_mfma_f32_16x16x32_bf16 v[132:135], v[72:75], a[76:79], v[132:135]
  v_fma_f32 v16, v16, s72, v12
  v_fma_f32 v17, v17, s72, v12
  v_mfma_f32_16x16x32_bf16 v[136:139], v[72:75], a[140:143], v[136:139]
  v_fma_f32 v18, v18, s72, v12
  v_fma_f32 v19, v19, s72, v12
  v_mfma_f32_16x16x32_bf16 v[140:143], v[72:75], a[204:207], v[140:143]
  v_mul_f32 v16, v16, v180
  v_mul_f32_e64 v17, v17, v181
  s_waitcnt vmcnt(9)
  v_mfma_f32_16x16x32_bf16 v[96:99], v[76:79], a[16:19], v[96:99]
  buffer_load_dwordx4 v[68:71], v40, s[52:55], s83 offen offset:0 sc1
  v_mfma_f32_16x16x32_bf16 v[132:135], v[76:79], a[80:83], v[132:135]
  s_waitcnt lgkmcnt(0)
  s_barrier
  ds_read_b128 v[144:147], v11 offset:0
  ds_read_b128 v[148:151], v11 offset:1024
  ds_read_b128 v[152:155], v11 offset:2048
  v_mfma_f32_16x16x32_bf16 v[136:139], v[76:79], a[144:147], v[136:139]
  v_mul_f32 v18, v18, v182
  v_mul_f32 v19, v19, v183
  v_mfma_f32_16x16x32_bf16 v[140:143], v[76:79], a[208:211], v[140:143]
  v_exp_f32 v16, v16
  s_waitcnt vmcnt(9)
  v_mfma_f32_16x16x32_bf16 v[96:99], v[80:83], a[20:23], v[96:99]
  buffer_load_dwordx4 v[72:75], v40, s[52:55], s83 offen offset:1024 sc1
  v_mfma_f32_16x16x32_bf16 v[132:135], v[80:83], a[84:87], v[132:135]
  v_exp_f32_e64 v17, v17
  v_mfma_f32_16x16x32_bf16 v[136:139], v[80:83], a[148:151], v[136:139]
  v_exp_f32_e64 v18, v18
  v_mfma_f32_16x16x32_bf16 v[140:143], v[80:83], a[212:215], v[140:143]
  v_exp_f32 v19, v19
  s_waitcnt vmcnt(9)
  v_mfma_f32_16x16x32_bf16 v[96:99], v[84:87], a[24:27], v[96:99]
  v_add_u32 v37, 0x20000, v37
  buffer_load_dwordx4 v[76:79], v37, s[52:55], s76 offen offset:0 sc1
  v_mfma_f32_16x16x32_bf16 v[132:135], v[84:87], a[88:91], v[132:135]
  v_add_f32 v16, 1.0, v16
  v_add_f32 v17, 1.0, v17
  v_mfma_f32_16x16x32_bf16 v[136:139], v[84:87], a[152:155], v[136:139]
  v_add_f32 v18, 1.0, v18
  v_add_f32 v19, 1.0, v19
  v_mfma_f32_16x16x32_bf16 v[140:143], v[84:87], a[216:219], v[140:143]
  v_rcp_f32 v16, v16
  s_waitcnt vmcnt(9)
  v_mfma_f32_16x16x32_bf16 v[96:99], v[88:91], a[28:31], v[96:99]
  buffer_load_dwordx4 v[80:83], v37, s[52:55], s76 offen offset:1024 sc1
  v_mfma_f32_16x16x32_bf16 v[132:135], v[88:91], a[92:95], v[132:135]
  s_waitcnt lgkmcnt(0)
  v_mfma_f32_16x16x32_bf16 v[136:139], v[88:91], a[156:159], v[136:139]
  v_add_f32 v92, v92, v144
  v_add_f32_e64 v93, v93, v145
  v_mfma_f32_16x16x32_bf16 v[140:143], v[88:91], a[220:223], v[140:143]
  v_add_f32 v94, v94, v146
  v_add_f32_e64 v95, v95, v147
  s_waitcnt vmcnt(9)
  v_mfma_f32_16x16x32_bf16 v[96:99], v[44:47], a[32:35], v[96:99]
  buffer_load_dwordx4 v[84:87], v37, s[52:55], s77 offen offset:0 sc1
  v_mfma_f32_16x16x32_bf16 v[132:135], v[44:47], a[96:99], v[132:135]
  v_add_f32 v92, v92, v148
  v_add_f32 v93, v93, v149
  v_mfma_f32_16x16x32_bf16 v[136:139], v[44:47], a[160:163], v[136:139]
  v_add_f32 v94, v94, v150
  v_add_f32 v95, v95, v151
  v_mfma_f32_16x16x32_bf16 v[140:143], v[44:47], a[224:227], v[140:143]
  v_add_f32 v92, v92, v152
  v_add_f32_e64 v93, v93, v153
  s_waitcnt vmcnt(9)
  v_mfma_f32_16x16x32_bf16 v[96:99], v[48:51], a[36:39], v[96:99]
  buffer_load_dwordx4 v[88:91], v37, s[52:55], s77 offen offset:1024 sc1
  v_mfma_f32_16x16x32_bf16 v[132:135], v[48:51], a[100:103], v[132:135]
  v_add_f32 v94, v94, v154
  v_add_f32 v95, v95, v155
  v_mfma_f32_16x16x32_bf16 v[136:139], v[48:51], a[164:167], v[136:139]
  v_rcp_f32_e64 v17, v17
  v_mfma_f32_16x16x32_bf16 v[140:143], v[48:51], a[228:231], v[140:143]
  v_rcp_f32 v18, v18
  s_waitcnt vmcnt(9)
  v_mfma_f32_16x16x32_bf16 v[96:99], v[52:55], a[40:43], v[96:99]
  buffer_load_dwordx4 v[44:47], v37, s[52:55], s78 offen offset:0 sc1
  v_mfma_f32_16x16x32_bf16 v[132:135], v[52:55], a[104:107], v[132:135]
  v_rcp_f32_e64 v19, v19
  v_mfma_f32_16x16x32_bf16 v[136:139], v[52:55], a[168:171], v[136:139]
  v_mul_f32 v180, v180, v16
  v_mul_f32 v181, v181, v17
  v_mfma_f32_16x16x32_bf16 v[140:143], v[52:55], a[232:235], v[140:143]
  v_mul_f32 v182, v182, v18
  v_mul_f32_e64 v183, v183, v19
  s_waitcnt vmcnt(9)
  v_mfma_f32_16x16x32_bf16 v[96:99], v[56:59], a[44:47], v[96:99]
  buffer_load_dwordx4 v[48:51], v37, s[52:55], s78 offen offset:1024 sc1
  v_mfma_f32_16x16x32_bf16 v[132:135], v[56:59], a[108:111], v[132:135]
  v_mul_f32 v16, v184, v184
  v_mul_f32 v17, v185, v185
  v_mfma_f32_16x16x32_bf16 v[136:139], v[56:59], a[172:175], v[136:139]
  v_mul_f32 v18, v186, v186
  v_mul_f32 v19, v187, v187
  v_mfma_f32_16x16x32_bf16 v[140:143], v[56:59], a[236:239], v[140:143]
  v_fma_f32 v16, v16, s72, v12
  v_fma_f32 v17, v17, s72, v12
  s_waitcnt vmcnt(9)
  v_mfma_f32_16x16x32_bf16 v[96:99], v[60:63], a[48:51], v[96:99]
  buffer_load_dwordx4 v[52:55], v37, s[52:55], s79 offen offset:0 sc1
  v_mfma_f32_16x16x32_bf16 v[132:135], v[60:63], a[112:115], v[132:135]
  v_fma_f32 v18, v18, s72, v12
  v_fma_f32 v19, v19, s72, v12
  v_mfma_f32_16x16x32_bf16 v[136:139], v[60:63], a[176:179], v[136:139]
  v_mul_f32 v16, v16, v184
  v_mul_f32_e64 v17, v17, v185
  v_mfma_f32_16x16x32_bf16 v[140:143], v[60:63], a[240:243], v[140:143]
  v_mul_f32 v18, v18, v186
  v_mul_f32_e64 v19, v19, v187
  s_waitcnt vmcnt(9)
  v_mfma_f32_16x16x32_bf16 v[96:99], v[64:67], a[52:55], v[96:99]
  buffer_load_dwordx4 v[56:59], v37, s[52:55], s79 offen offset:1024 sc1
  v_mfma_f32_16x16x32_bf16 v[132:135], v[64:67], a[116:119], v[132:135]
  v_exp_f32_e64 v16, v16
  v_mfma_f32_16x16x32_bf16 v[136:139], v[64:67], a[180:183], v[136:139]
  v_exp_f32_e64 v17, v17
  v_mfma_f32_16x16x32_bf16 v[140:143], v[64:67], a[244:247], v[140:143]
  v_exp_f32 v18, v18
  s_waitcnt vmcnt(9)
  v_mfma_f32_16x16x32_bf16 v[96:99], v[68:71], a[56:59], v[96:99]
  buffer_load_dwordx4 v[60:63], v37, s[52:55], s80 offen offset:0 sc1
  v_mfma_f32_16x16x32_bf16 v[132:135], v[68:71], a[120:123], v[132:135]
  v_exp_f32_e64 v19, v19
  v_mfma_f32_16x16x32_bf16 v[136:139], v[68:71], a[184:187], v[136:139]
  v_add_f32 v16, 1.0, v16
  v_add_f32 v17, 1.0, v17
  v_mfma_f32_16x16x32_bf16 v[140:143], v[68:71], a[248:251], v[140:143]
  v_add_f32 v18, 1.0, v18
  v_add_f32_e64 v19, 1.0, v19
  s_waitcnt vmcnt(9)
  v_mfma_f32_16x16x32_bf16 v[96:99], v[72:75], a[60:63], v[96:99]
  buffer_load_dwordx4 v[64:67], v37, s[52:55], s80 offen offset:1024 sc1
  v_mfma_f32_16x16x32_bf16 v[132:135], v[72:75], a[124:127], v[132:135]
  v_rcp_f32_e64 v16, v16
  v_mfma_f32_16x16x32_bf16 v[136:139], v[72:75], a[188:191], v[136:139]
  v_rcp_f32_e64 v17, v17
  v_mfma_f32_16x16x32_bf16 v[140:143], v[72:75], a[252:255], v[140:143]
  v_rcp_f32 v18, v18
  s_waitcnt vmcnt(9)
  v_mfma_f32_16x16x32_bf16 v[100:103], v[76:79], a[0:3], 0
  buffer_load_dwordx4 v[68:71], v37, s[52:55], s81 offen offset:0 sc1
  v_mfma_f32_16x16x32_bf16 v[120:123], v[76:79], a[64:67], 0
  v_rcp_f32_e64 v19, v19
  v_mfma_f32_16x16x32_bf16 v[124:127], v[76:79], a[128:131], 0
  v_mul_f32 v184, v184, v16
  v_mul_f32 v185, v185, v17
  v_mfma_f32_16x16x32_bf16 v[128:131], v[76:79], a[192:195], 0
  v_mul_f32 v186, v186, v18
  v_mul_f32_e64 v187, v187, v19
  s_waitcnt vmcnt(9)
  v_mfma_f32_16x16x32_bf16 v[100:103], v[80:83], a[4:7], v[100:103]
  buffer_load_dwordx4 v[72:75], v37, s[52:55], s81 offen offset:1024 sc1
  v_mfma_f32_16x16x32_bf16 v[120:123], v[80:83], a[68:71], v[120:123]
  ds_write_b128 v20, v[132:135] offset:12288
  ds_write_b128 v21, v[136:139] offset:12288
  ds_write_b128 v22, v[140:143] offset:12288
  v_mfma_f32_16x16x32_bf16 v[124:127], v[80:83], a[132:135], v[124:127]
  v_mul_f32 v16, v188, v188
  v_mul_f32 v17, v189, v189
  v_mfma_f32_16x16x32_bf16 v[128:131], v[80:83], a[196:199], v[128:131]
  v_mul_f32 v18, v190, v190
  v_mul_f32_e64 v19, v191, v191
  s_waitcnt vmcnt(9)
  v_mfma_f32_16x16x32_bf16 v[100:103], v[84:87], a[8:11], v[100:103]
  buffer_load_dwordx4 v[76:79], v37, s[52:55], s82 offen offset:0 sc1
  v_mfma_f32_16x16x32_bf16 v[120:123], v[84:87], a[72:75], v[120:123]
  v_fma_f32 v16, v16, s72, v12
  v_fma_f32 v17, v17, s72, v12
  v_mfma_f32_16x16x32_bf16 v[124:127], v[84:87], a[136:139], v[124:127]
  v_fma_f32 v18, v18, s72, v12
  v_fma_f32 v19, v19, s72, v12
  v_mfma_f32_16x16x32_bf16 v[128:131], v[84:87], a[200:203], v[128:131]
  v_mul_f32 v16, v16, v188
  v_mul_f32_e64 v17, v17, v189
  s_waitcnt vmcnt(9)
  v_mfma_f32_16x16x32_bf16 v[100:103], v[88:91], a[12:15], v[100:103]
  buffer_load_dwordx4 v[80:83], v37, s[52:55], s82 offen offset:1024 sc1
  v_mfma_f32_16x16x32_bf16 v[120:123], v[88:91], a[76:79], v[120:123]
  v_mul_f32 v18, v18, v190
  v_mul_f32 v19, v19, v191
  v_mfma_f32_16x16x32_bf16 v[124:127], v[88:91], a[140:143], v[124:127]
  v_exp_f32_e64 v16, v16
  v_mfma_f32_16x16x32_bf16 v[128:131], v[88:91], a[204:207], v[128:131]
  v_exp_f32 v17, v17
  s_waitcnt vmcnt(9)
  v_mfma_f32_16x16x32_bf16 v[100:103], v[44:47], a[16:19], v[100:103]
  buffer_load_dwordx4 v[84:87], v37, s[52:55], s83 offen offset:0 sc1
  v_mfma_f32_16x16x32_bf16 v[120:123], v[44:47], a[80:83], v[120:123]
  s_waitcnt lgkmcnt(0)
  s_barrier
  ds_read_b128 v[144:147], v11 offset:12288
  ds_read_b128 v[148:151], v11 offset:13312
  ds_read_b128 v[152:155], v11 offset:14336
  v_mfma_f32_16x16x32_bf16 v[124:127], v[44:47], a[144:147], v[124:127]
  v_exp_f32_e64 v18, v18
  v_mfma_f32_16x16x32_bf16 v[128:131], v[44:47], a[208:211], v[128:131]
  v_exp_f32 v19, v19
  s_waitcnt vmcnt(9)
  v_mfma_f32_16x16x32_bf16 v[100:103], v[48:51], a[20:23], v[100:103]
  buffer_load_dwordx4 v[88:91], v37, s[52:55], s83 offen offset:1024 sc1
  v_mfma_f32_16x16x32_bf16 v[120:123], v[48:51], a[84:87], v[120:123]
  v_add_f32 v16, 1.0, v16
  v_add_f32 v17, 1.0, v17
  v_mfma_f32_16x16x32_bf16 v[124:127], v[48:51], a[148:151], v[124:127]
  v_add_f32 v18, 1.0, v18
  v_add_f32 v19, 1.0, v19
  v_mfma_f32_16x16x32_bf16 v[128:131], v[48:51], a[212:215], v[128:131]
  v_rcp_f32 v16, v16
  s_waitcnt vmcnt(9)
  v_mfma_f32_16x16x32_bf16 v[100:103], v[52:55], a[24:27], v[100:103]
  v_add_u32 v40, 0x20000, v40
  buffer_load_dwordx4 v[44:47], v40, s[52:55], s76 offen offset:0 sc1
  v_mfma_f32_16x16x32_bf16 v[120:123], v[52:55], a[88:91], v[120:123]
  v_rcp_f32_e64 v17, v17
  v_mfma_f32_16x16x32_bf16 v[124:127], v[52:55], a[152:155], v[124:127]
  v_rcp_f32_e64 v18, v18
  v_mfma_f32_16x16x32_bf16 v[128:131], v[52:55], a[216:219], v[128:131]
  v_rcp_f32 v19, v19
  s_waitcnt vmcnt(9)
  v_mfma_f32_16x16x32_bf16 v[100:103], v[56:59], a[28:31], v[100:103]
  buffer_load_dwordx4 v[48:51], v40, s[52:55], s76 offen offset:1024 sc1
  v_mfma_f32_16x16x32_bf16 v[120:123], v[56:59], a[92:95], v[120:123]
  s_waitcnt lgkmcnt(0)
  v_mfma_f32_16x16x32_bf16 v[124:127], v[56:59], a[156:159], v[124:127]
  v_add_f32 v96, v96, v144
  v_add_f32_e64 v97, v97, v145
  v_mfma_f32_16x16x32_bf16 v[128:131], v[56:59], a[220:223], v[128:131]
  v_add_f32 v98, v98, v146
  v_add_f32_e64 v99, v99, v147
  s_waitcnt vmcnt(9)
  v_mfma_f32_16x16x32_bf16 v[100:103], v[60:63], a[32:35], v[100:103]
  buffer_load_dwordx4 v[52:55], v40, s[52:55], s77 offen offset:0 sc1
  v_mfma_f32_16x16x32_bf16 v[120:123], v[60:63], a[96:99], v[120:123]
  v_add_f32 v96, v96, v148
  v_add_f32 v97, v97, v149
  v_mfma_f32_16x16x32_bf16 v[124:127], v[60:63], a[160:163], v[124:127]
  v_add_f32 v98, v98, v150
  v_add_f32 v99, v99, v151
  v_mfma_f32_16x16x32_bf16 v[128:131], v[60:63], a[224:227], v[128:131]
  v_add_f32 v96, v96, v152
  v_add_f32_e64 v97, v97, v153
  s_waitcnt vmcnt(9)
  v_mfma_f32_16x16x32_bf16 v[100:103], v[64:67], a[36:39], v[100:103]
  buffer_load_dwordx4 v[56:59], v40, s[52:55], s77 offen offset:1024 sc1
  v_mfma_f32_16x16x32_bf16 v[120:123], v[64:67], a[100:103], v[120:123]
  v_add_f32 v98, v98, v154
  v_add_f32 v99, v99, v155
  v_mfma_f32_16x16x32_bf16 v[124:127], v[64:67], a[164:167], v[124:127]
  v_mul_f32 v188, v188, v16
  v_mul_f32 v189, v189, v17
  v_mfma_f32_16x16x32_bf16 v[128:131], v[64:67], a[228:231], v[128:131]
  v_mul_f32 v190, v190, v18
  v_mul_f32_e64 v191, v191, v19
  s_waitcnt vmcnt(9)
  v_mfma_f32_16x16x32_bf16 v[100:103], v[68:71], a[40:43], v[100:103]
  buffer_load_dwordx4 v[60:63], v40, s[52:55], s78 offen offset:0 sc1
  v_mfma_f32_16x16x32_bf16 v[120:123], v[68:71], a[104:107], v[120:123]
  v_mul_f32 v16, v192, v192
  v_mul_f32 v17, v193, v193
  v_mfma_f32_16x16x32_bf16 v[124:127], v[68:71], a[168:171], v[124:127]
  v_mul_f32 v18, v194, v194
  v_mul_f32 v19, v195, v195
  v_mfma_f32_16x16x32_bf16 v[128:131], v[68:71], a[232:235], v[128:131]
  v_fma_f32 v16, v16, s72, v12
  v_fma_f32 v17, v17, s72, v12
  s_waitcnt vmcnt(9)
  v_mfma_f32_16x16x32_bf16 v[100:103], v[72:75], a[44:47], v[100:103]
  buffer_load_dwordx4 v[64:67], v40, s[52:55], s78 offen offset:1024 sc1
  v_mfma_f32_16x16x32_bf16 v[120:123], v[72:75], a[108:111], v[120:123]
  v_fma_f32 v18, v18, s72, v12
  v_fma_f32 v19, v19, s72, v12
  v_mfma_f32_16x16x32_bf16 v[124:127], v[72:75], a[172:175], v[124:127]
  v_mul_f32 v16, v16, v192
  v_mul_f32_e64 v17, v17, v193
  v_mfma_f32_16x16x32_bf16 v[128:131], v[72:75], a[236:239], v[128:131]
  v_mul_f32 v18, v18, v194
  v_mul_f32_e64 v19, v19, v195
  s_waitcnt vmcnt(9)
  v_mfma_f32_16x16x32_bf16 v[100:103], v[76:79], a[48:51], v[100:103]
  buffer_load_dwordx4 v[68:71], v40, s[52:55], s79 offen offset:0 sc1
  v_mfma_f32_16x16x32_bf16 v[120:123], v[76:79], a[112:115], v[120:123]
  v_exp_f32_e64 v16, v16
  v_mfma_f32_16x16x32_bf16 v[124:127], v[76:79], a[176:179], v[124:127]
  v_exp_f32_e64 v17, v17
  v_mfma_f32_16x16x32_bf16 v[128:131], v[76:79], a[240:243], v[128:131]
  v_exp_f32 v18, v18
  s_waitcnt vmcnt(9)
  v_mfma_f32_16x16x32_bf16 v[100:103], v[80:83], a[52:55], v[100:103]
  buffer_load_dwordx4 v[72:75], v40, s[52:55], s79 offen offset:1024 sc1
  v_mfma_f32_16x16x32_bf16 v[120:123], v[80:83], a[116:119], v[120:123]
  v_exp_f32_e64 v19, v19
  v_mfma_f32_16x16x32_bf16 v[124:127], v[80:83], a[180:183], v[124:127]
  v_add_f32 v16, 1.0, v16
  v_add_f32 v17, 1.0, v17
  v_mfma_f32_16x16x32_bf16 v[128:131], v[80:83], a[244:247], v[128:131]
  v_add_f32 v18, 1.0, v18
  v_add_f32_e64 v19, 1.0, v19
  s_waitcnt vmcnt(9)
  v_mfma_f32_16x16x32_bf16 v[100:103], v[84:87], a[56:59], v[100:103]
  buffer_load_dwordx4 v[76:79], v40, s[52:55], s80 offen offset:0 sc1
  v_mfma_f32_16x16x32_bf16 v[120:123], v[84:87], a[120:123], v[120:123]
  v_rcp_f32_e64 v16, v16
  v_mfma_f32_16x16x32_bf16 v[124:127], v[84:87], a[184:187], v[124:127]
  v_rcp_f32_e64 v17, v17
  v_mfma_f32_16x16x32_bf16 v[128:131], v[84:87], a[248:251], v[128:131]
  v_rcp_f32 v18, v18
  s_waitcnt vmcnt(9)
  v_mfma_f32_16x16x32_bf16 v[100:103], v[88:91], a[60:63], v[100:103]
  buffer_load_dwordx4 v[80:83], v40, s[52:55], s80 offen offset:1024 sc1
  v_mfma_f32_16x16x32_bf16 v[120:123], v[88:91], a[124:127], v[120:123]
  v_rcp_f32_e64 v19, v19
  v_mfma_f32_16x16x32_bf16 v[124:127], v[88:91], a[188:191], v[124:127]
  v_mul_f32 v192, v192, v16
  v_mul_f32 v193, v193, v17
  v_mfma_f32_16x16x32_bf16 v[128:131], v[88:91], a[252:255], v[128:131]
  v_mul_f32 v194, v194, v18
  v_mul_f32_e64 v195, v195, v19
  s_waitcnt vmcnt(9)
  v_mfma_f32_16x16x32_bf16 v[104:107], v[44:47], a[0:3], 0
  buffer_load_dwordx4 v[84:87], v40, s[52:55], s81 offen offset:0 sc1
  v_mfma_f32_16x16x32_bf16 v[132:135], v[44:47], a[64:67], 0
  v_mfma_f32_16x16x32_bf16 v[136:139], v[44:47], a[128:131], 0
  v_mfma_f32_16x16x32_bf16 v[140:143], v[44:47], a[192:195], 0
  s_waitcnt vmcnt(9)
  v_mfma_f32_16x16x32_bf16 v[104:107], v[48:51], a[4:7], v[104:107]
  buffer_load_dwordx4 v[88:91], v40, s[52:55], s81 offen offset:1024 sc1
  v_mfma_f32_16x16x32_bf16 v[132:135], v[48:51], a[68:71], v[132:135]
  ds_write_b128 v20, v[120:123] offset:0
  ds_write_b128 v21, v[124:127] offset:0
  ds_write_b128 v22, v[128:131] offset:0
  v_mfma_f32_16x16x32_bf16 v[136:139], v[48:51], a[132:135], v[136:139]
  v_mfma_f32_16x16x32_bf16 v[140:143], v[48:51], a[196:199], v[140:143]
  s_waitcnt vmcnt(9)
  v_mfma_f32_16x16x32_bf16 v[104:107], v[52:55], a[8:11], v[104:107]
  buffer_load_dwordx4 v[44:47], v40, s[52:55], s82 offen offset:0 sc1
  v_mfma_f32_16x16x32_bf16 v[132:135], v[52:55], a[72:75], v[132:135]
  v_mfma_f32_16x16x32_bf16 v[136:139], v[52:55], a[136:139], v[136:139]
  v_mfma_f32_16x16x32_bf16 v[140:143], v[52:55], a[200:203], v[140:143]
  s_waitcnt vmcnt(9)
  v_mfma_f32_16x16x32_bf16 v[104:107], v[56:59], a[12:15], v[104:107]
  buffer_load_dwordx4 v[48:51], v40, s[52:55], s82 offen offset:1024 sc1
  v_mfma_f32_16x16x32_bf16 v[132:135], v[56:59], a[76:79], v[132:135]
  v_mfma_f32_16x16x32_bf16 v[136:139], v[56:59], a[140:143], v[136:139]
  v_mfma_f32_16x16x32_bf16 v[140:143], v[56:59], a[204:207], v[140:143]
  s_waitcnt vmcnt(9)
  v_mfma_f32_16x16x32_bf16 v[104:107], v[60:63], a[16:19], v[104:107]
  buffer_load_dwordx4 v[52:55], v40, s[52:55], s83 offen offset:0 sc1
  v_mfma_f32_16x16x32_bf16 v[132:135], v[60:63], a[80:83], v[132:135]
  s_waitcnt lgkmcnt(0)
  s_barrier
  ds_read_b128 v[144:147], v11 offset:0
  ds_read_b128 v[148:151], v11 offset:1024
  ds_read_b128 v[152:155], v11 offset:2048
  v_mfma_f32_16x16x32_bf16 v[136:139], v[60:63], a[144:147], v[136:139]
  v_mfma_f32_16x16x32_bf16 v[140:143], v[60:63], a[208:211], v[140:143]
  s_waitcnt vmcnt(9)
  v_mfma_f32_16x16x32_bf16 v[104:107], v[64:67], a[20:23], v[104:107]
  buffer_load_dwordx4 v[56:59], v40, s[52:55], s83 offen offset:1024 sc1
  v_mfma_f32_16x16x32_bf16 v[132:135], v[64:67], a[84:87], v[132:135]
  v_mfma_f32_16x16x32_bf16 v[136:139], v[64:67], a[148:151], v[136:139]
  v_mfma_f32_16x16x32_bf16 v[140:143], v[64:67], a[212:215], v[140:143]
  s_waitcnt vmcnt(9)
  v_mfma_f32_16x16x32_bf16 v[104:107], v[68:71], a[24:27], v[104:107]
  v_add_u32 v37, 0x20000, v37
  buffer_load_dwordx4 v[60:63], v37, s[52:55], s76 offen offset:0 sc1
  v_mfma_f32_16x16x32_bf16 v[132:135], v[68:71], a[88:91], v[132:135]
  v_mfma_f32_16x16x32_bf16 v[136:139], v[68:71], a[152:155], v[136:139]
  v_mfma_f32_16x16x32_bf16 v[140:143], v[68:71], a[216:219], v[140:143]
  s_waitcnt vmcnt(9)
  v_mfma_f32_16x16x32_bf16 v[104:107], v[72:75], a[28:31], v[104:107]
  buffer_load_dwordx4 v[64:67], v37, s[52:55], s76 offen offset:1024 sc1
  v_mfma_f32_16x16x32_bf16 v[132:135], v[72:75], a[92:95], v[132:135]
  s_waitcnt lgkmcnt(0)
  v_mfma_f32_16x16x32_bf16 v[136:139], v[72:75], a[156:159], v[136:139]
  v_add_f32 v100, v100, v144
  v_add_f32 v101, v101, v145
  v_mfma_f32_16x16x32_bf16 v[140:143], v[72:75], a[220:223], v[140:143]
  v_add_f32 v102, v102, v146
  v_add_f32_e64 v103, v103, v147
  s_waitcnt vmcnt(9)
  v_mfma_f32_16x16x32_bf16 v[104:107], v[76:79], a[32:35], v[104:107]
  buffer_load_dwordx4 v[68:71], v37, s[52:55], s77 offen offset:0 sc1
  v_mfma_f32_16x16x32_bf16 v[132:135], v[76:79], a[96:99], v[132:135]
  v_add_f32 v100, v100, v148
  v_add_f32 v101, v101, v149
  v_mfma_f32_16x16x32_bf16 v[136:139], v[76:79], a[160:163], v[136:139]
  v_add_f32 v102, v102, v150
  v_add_f32 v103, v103, v151
  v_mfma_f32_16x16x32_bf16 v[140:143], v[76:79], a[224:227], v[140:143]
  v_add_f32 v100, v100, v152
  v_add_f32_e64 v101, v101, v153
  s_waitcnt vmcnt(9)
  v_mfma_f32_16x16x32_bf16 v[104:107], v[80:83], a[36:39], v[104:107]
  buffer_load_dwordx4 v[72:75], v37, s[52:55], s77 offen offset:1024 sc1
  v_mfma_f32_16x16x32_bf16 v[132:135], v[80:83], a[100:103], v[132:135]
  v_add_f32 v102, v102, v154
  v_add_f32 v103, v103, v155
  v_mfma_f32_16x16x32_bf16 v[136:139], v[80:83], a[164:167], v[136:139]
  v_add_f32 v92, v92, v15
  v_add_f32 v93, v93, v15
  v_mfma_f32_16x16x32_bf16 v[140:143], v[80:83], a[228:231], v[140:143]
  v_add_f32 v94, v94, v15
  v_add_f32_e64 v95, v95, v15
  s_waitcnt vmcnt(9)
  v_mfma_f32_16x16x32_bf16 v[104:107], v[84:87], a[40:43], v[104:107]
  buffer_load_dwordx4 v[76:79], v37, s[52:55], s78 offen offset:0 sc1
  v_mfma_f32_16x16x32_bf16 v[132:135], v[84:87], a[104:107], v[132:135]
  v_mul_f32 v92, v92, v168
  v_mul_f32 v93, v93, v169
  v_mfma_f32_16x16x32_bf16 v[136:139], v[84:87], a[168:171], v[136:139]
  v_mul_f32 v94, v94, v170
  v_mul_f32 v95, v95, v171
  v_mfma_f32_16x16x32_bf16 v[140:143], v[84:87], a[232:235], v[140:143]
  v_cvt_pk_bf16_f32 v168, v92, v93
  v_cvt_pk_bf16_f32 v169, v94, v95
  s_waitcnt vmcnt(9)
  v_mfma_f32_16x16x32_bf16 v[104:107], v[88:91], a[44:47], v[104:107]
  buffer_load_dwordx4 v[80:83], v37, s[52:55], s78 offen offset:1024 sc1
  v_mfma_f32_16x16x32_bf16 v[132:135], v[88:91], a[108:111], v[132:135]
  v_add_f32 v96, v96, v15
  v_add_f32_e64 v97, v97, v15
  v_mfma_f32_16x16x32_bf16 v[136:139], v[88:91], a[172:175], v[136:139]
  v_add_f32 v98, v98, v15
  v_add_f32 v99, v99, v15
  v_mfma_f32_16x16x32_bf16 v[140:143], v[88:91], a[236:239], v[140:143]
  v_mul_f32 v96, v96, v172
  v_mul_f32_e64 v97, v97, v173
  s_waitcnt vmcnt(9)
  v_mfma_f32_16x16x32_bf16 v[104:107], v[44:47], a[48:51], v[104:107]
  buffer_load_dwordx4 v[84:87], v37, s[52:55], s79 offen offset:0 sc1
  v_mfma_f32_16x16x32_bf16 v[132:135], v[44:47], a[112:115], v[132:135]
  v_mul_f32 v98, v98, v174
  v_mul_f32 v99, v99, v175
  v_mfma_f32_16x16x32_bf16 v[136:139], v[44:47], a[176:179], v[136:139]
  v_cvt_pk_bf16_f32 v170, v96, v97
  v_cvt_pk_bf16_f32 v171, v98, v99
  v_mfma_f32_16x16x32_bf16 v[140:143], v[44:47], a[240:243], v[140:143]
  v_add_f32 v100, v100, v15
  v_add_f32_e64 v101, v101, v15
  s_waitcnt vmcnt(9)
  v_mfma_f32_16x16x32_bf16 v[104:107], v[48:51], a[52:55], v[104:107]
  buffer_load_dwordx4 v[88:91], v37, s[52:55], s79 offen offset:1024 sc1
  v_mfma_f32_16x16x32_bf16 v[132:135], v[48:51], a[116:119], v[132:135]
  v_add_f32 v102, v102, v15
  v_add_f32 v103, v103, v15
  v_mfma_f32_16x16x32_bf16 v[136:139], v[48:51], a[180:183], v[136:139]
  v_mul_f32 v100, v100, v176
  v_mul_f32 v101, v101, v177
  v_mfma_f32_16x16x32_bf16 v[140:143], v[48:51], a[244:247], v[140:143]
  v_mul_f32 v102, v102, v178
  v_mul_f32_e64 v103, v103, v179
  s_waitcnt vmcnt(9)
  v_mfma_f32_16x16x32_bf16 v[104:107], v[52:55], a[56:59], v[104:107]
  buffer_load_dwordx4 v[44:47], v37, s[52:55], s80 offen offset:0 sc1
  v_mfma_f32_16x16x32_bf16 v[132:135], v[52:55], a[120:123], v[132:135]
  v_cvt_pk_bf16_f32 v172, v100, v101
  v_cvt_pk_bf16_f32 v173, v102, v103
  v_mfma_f32_16x16x32_bf16 v[136:139], v[52:55], a[184:187], v[136:139]
  v_mfma_f32_16x16x32_bf16 v[140:143], v[52:55], a[248:251], v[140:143]
  s_waitcnt vmcnt(9)
  v_mfma_f32_16x16x32_bf16 v[104:107], v[56:59], a[60:63], v[104:107]
  buffer_load_dwordx4 v[48:51], v37, s[52:55], s80 offen offset:1024 sc1
  v_mfma_f32_16x16x32_bf16 v[132:135], v[56:59], a[124:127], v[132:135]
  v_mfma_f32_16x16x32_bf16 v[136:139], v[56:59], a[188:191], v[136:139]
  v_mfma_f32_16x16x32_bf16 v[140:143], v[56:59], a[252:255], v[140:143]
  s_waitcnt vmcnt(9)
  v_mfma_f32_16x16x32_bf16 v[108:111], v[60:63], a[0:3], 0
  buffer_load_dwordx4 v[52:55], v37, s[52:55], s81 offen offset:0 sc1
  v_mfma_f32_16x16x32_bf16 v[120:123], v[60:63], a[64:67], 0
  v_mfma_f32_16x16x32_bf16 v[124:127], v[60:63], a[128:131], 0
  v_mfma_f32_16x16x32_bf16 v[128:131], v[60:63], a[192:195], 0
  s_waitcnt vmcnt(9)
  v_mfma_f32_16x16x32_bf16 v[108:111], v[64:67], a[4:7], v[108:111]
  buffer_load_dwordx4 v[56:59], v37, s[52:55], s81 offen offset:1024 sc1
  v_mfma_f32_16x16x32_bf16 v[120:123], v[64:67], a[68:71], v[120:123]
  ds_write_b128 v20, v[132:135] offset:12288
  ds_write_b128 v21, v[136:139] offset:12288
  ds_write_b128 v22, v[140:143] offset:12288
  v_mfma_f32_16x16x32_bf16 v[124:127], v[64:67], a[132:135], v[124:127]
  v_mfma_f32_16x16x32_bf16 v[128:131], v[64:67], a[196:199], v[128:131]
  s_waitcnt vmcnt(9)
  v_mfma_f32_16x16x32_bf16 v[108:111], v[68:71], a[8:11], v[108:111]
  buffer_load_dwordx4 v[60:63], v37, s[52:55], s82 offen offset:0 sc1
  v_mfma_f32_16x16x32_bf16 v[120:123], v[68:71], a[72:75], v[120:123]
  v_mfma_f32_16x16x32_bf16 v[124:127], v[68:71], a[136:139], v[124:127]
  v_mfma_f32_16x16x32_bf16 v[128:131], v[68:71], a[200:203], v[128:131]
  s_waitcnt vmcnt(9)
  v_mfma_f32_16x16x32_bf16 v[108:111], v[72:75], a[12:15], v[108:111]
  buffer_load_dwordx4 v[64:67], v37, s[52:55], s82 offen offset:1024 sc1
  v_mfma_f32_16x16x32_bf16 v[120:123], v[72:75], a[76:79], v[120:123]
  v_mfma_f32_16x16x32_bf16 v[124:127], v[72:75], a[140:143], v[124:127]
  v_mfma_f32_16x16x32_bf16 v[128:131], v[72:75], a[204:207], v[128:131]
  s_waitcnt vmcnt(9)
  v_mfma_f32_16x16x32_bf16 v[108:111], v[76:79], a[16:19], v[108:111]
  buffer_load_dwordx4 v[68:71], v37, s[52:55], s83 offen offset:0 sc1
  v_mfma_f32_16x16x32_bf16 v[120:123], v[76:79], a[80:83], v[120:123]
  s_waitcnt lgkmcnt(0)
  s_barrier
  ds_read_b128 v[144:147], v11 offset:12288
  ds_read_b128 v[148:151], v11 offset:13312
  ds_read_b128 v[152:155], v11 offset:14336
  v_mfma_f32_16x16x32_bf16 v[124:127], v[76:79], a[144:147], v[124:127]
  v_mfma_f32_16x16x32_bf16 v[128:131], v[76:79], a[208:211], v[128:131]
  s_waitcnt vmcnt(9)
  v_mfma_f32_16x16x32_bf16 v[108:111], v[80:83], a[20:23], v[108:111]
  buffer_load_dwordx4 v[72:75], v37, s[52:55], s83 offen offset:1024 sc1
  v_mfma_f32_16x16x32_bf16 v[120:123], v[80:83], a[84:87], v[120:123]
  v_mfma_f32_16x16x32_bf16 v[124:127], v[80:83], a[148:151], v[124:127]
  v_mfma_f32_16x16x32_bf16 v[128:131], v[80:83], a[212:215], v[128:131]
  s_waitcnt vmcnt(9)
  v_mfma_f32_16x16x32_bf16 v[108:111], v[84:87], a[24:27], v[108:111]
  v_add_u32 v40, 0x20000, v40
  buffer_load_dwordx4 v[76:79], v40, s[52:55], s76 offen offset:0 sc1
  v_mfma_f32_16x16x32_bf16 v[120:123], v[84:87], a[88:91], v[120:123]
  v_mfma_f32_16x16x32_bf16 v[124:127], v[84:87], a[152:155], v[124:127]
  v_mfma_f32_16x16x32_bf16 v[128:131], v[84:87], a[216:219], v[128:131]
  s_waitcnt vmcnt(9)
  v_mfma_f32_16x16x32_bf16 v[108:111], v[88:91], a[28:31], v[108:111]
  buffer_load_dwordx4 v[80:83], v40, s[52:55], s76 offen offset:1024 sc1
  v_mfma_f32_16x16x32_bf16 v[120:123], v[88:91], a[92:95], v[120:123]
  s_waitcnt lgkmcnt(0)
  v_mfma_f32_16x16x32_bf16 v[124:127], v[88:91], a[156:159], v[124:127]
  v_add_f32 v104, v104, v144
  v_add_f32 v105, v105, v145
  v_mfma_f32_16x16x32_bf16 v[128:131], v[88:91], a[220:223], v[128:131]
  v_add_f32 v106, v106, v146
  v_add_f32_e64 v107, v107, v147
  s_waitcnt vmcnt(9)
  v_mfma_f32_16x16x32_bf16 v[108:111], v[44:47], a[32:35], v[108:111]
  buffer_load_dwordx4 v[84:87], v40, s[52:55], s77 offen offset:0 sc1
  v_mfma_f32_16x16x32_bf16 v[120:123], v[44:47], a[96:99], v[120:123]
  v_add_f32 v104, v104, v148
  v_add_f32 v105, v105, v149
  v_mfma_f32_16x16x32_bf16 v[124:127], v[44:47], a[160:163], v[124:127]
  v_add_f32 v106, v106, v150
  v_add_f32 v107, v107, v151
  v_mfma_f32_16x16x32_bf16 v[128:131], v[44:47], a[224:227], v[128:131]
  v_add_f32 v104, v104, v152
  v_add_f32_e64 v105, v105, v153
  s_waitcnt vmcnt(9)
  v_mfma_f32_16x16x32_bf16 v[108:111], v[48:51], a[36:39], v[108:111]
  buffer_load_dwordx4 v[88:91], v40, s[52:55], s77 offen offset:1024 sc1
  v_mfma_f32_16x16x32_bf16 v[120:123], v[48:51], a[100:103], v[120:123]
  v_add_f32 v106, v106, v154
  v_add_f32 v107, v107, v155
  v_mfma_f32_16x16x32_bf16 v[124:127], v[48:51], a[164:167], v[124:127]
  v_add_f32 v104, v104, v15
  v_add_f32 v105, v105, v15
  v_mfma_f32_16x16x32_bf16 v[128:131], v[48:51], a[228:231], v[128:131]
  v_add_f32 v106, v106, v15
  v_add_f32_e64 v107, v107, v15
  s_waitcnt vmcnt(9)
  v_mfma_f32_16x16x32_bf16 v[108:111], v[52:55], a[40:43], v[108:111]
  buffer_load_dwordx4 v[44:47], v40, s[52:55], s78 offen offset:0 sc1
  v_mfma_f32_16x16x32_bf16 v[120:123], v[52:55], a[104:107], v[120:123]
  v_mul_f32 v104, v104, v180
  v_mul_f32 v105, v105, v181
  v_mfma_f32_16x16x32_bf16 v[124:127], v[52:55], a[168:171], v[124:127]
  v_mul_f32 v106, v106, v182
  v_mul_f32 v107, v107, v183
  v_mfma_f32_16x16x32_bf16 v[128:131], v[52:55], a[232:235], v[128:131]
  v_cvt_pk_bf16_f32 v174, v104, v105
  v_cvt_pk_bf16_f32 v175, v106, v107
  s_waitcnt vmcnt(9)
  v_mfma_f32_16x16x32_bf16 v[108:111], v[56:59], a[44:47], v[108:111]
  buffer_load_dwordx4 v[48:51], v40, s[52:55], s78 offen offset:1024 sc1
  v_mfma_f32_16x16x32_bf16 v[120:123], v[56:59], a[108:111], v[120:123]
  v_mfma_f32_16x16x32_bf16 v[124:127], v[56:59], a[172:175], v[124:127]
  v_mfma_f32_16x16x32_bf16 v[128:131], v[56:59], a[236:239], v[128:131]
  s_waitcnt vmcnt(9)
  v_mfma_f32_16x16x32_bf16 v[108:111], v[60:63], a[48:51], v[108:111]
  buffer_load_dwordx4 v[52:55], v40, s[52:55], s79 offen offset:0 sc1
  v_mfma_f32_16x16x32_bf16 v[120:123], v[60:63], a[112:115], v[120:123]
  v_mfma_f32_16x16x32_bf16 v[124:127], v[60:63], a[176:179], v[124:127]
  s_cmp_eq_u32 s62, 1
  s_cbranch_scc0 L_far_105
  buffer_store_dwordx4 v[168:171], v4, s[52:55], s85 offen offset:0
  buffer_store_dwordx4 v[172:175], v4, s[52:55], s85 offen offset:1024
L_stored_106:
  v_mfma_f32_16x16x32_bf16 v[128:131], v[60:63], a[240:243], v[128:131]
  s_waitcnt vmcnt(11)
  v_mfma_f32_16x16x32_bf16 v[108:111], v[64:67], a[52:55], v[108:111]
  buffer_load_dwordx4 v[56:59], v40, s[52:55], s79 offen offset:1024 sc1
  v_mfma_f32_16x16x32_bf16 v[120:123], v[64:67], a[116:119], v[120:123]
  v_mfma_f32_16x16x32_bf16 v[124:127], v[64:67], a[180:183], v[124:127]
  v_mfma_f32_16x16x32_bf16 v[128:131], v[64:67], a[244:247], v[128:131]
  s_waitcnt vmcnt(11)
  v_mfma_f32_16x16x32_bf16 v[108:111], v[68:71], a[56:59], v[108:111]
  buffer_load_dwordx4 v[60:63], v40, s[52:55], s80 offen offset:0 sc1
  v_mfma_f32_16x16x32_bf16 v[120:123], v[68:71], a[120:123], v[120:123]
  v_mfma_f32_16x16x32_bf16 v[124:127], v[68:71], a[184:187], v[124:127]
  v_mfma_f32_16x16x32_bf16 v[128:131], v[68:71], a[248:251], v[128:131]
  s_waitcnt vmcnt(11)
  v_mfma_f32_16x16x32_bf16 v[108:111], v[72:75], a[60:63], v[108:111]
  buffer_load_dwordx4 v[64:67], v40, s[52:55], s80 offen offset:1024 sc1
  v_mfma_f32_16x16x32_bf16 v[120:123], v[72:75], a[124:127], v[120:123]
  v_mfma_f32_16x16x32_bf16 v[124:127], v[72:75], a[188:191], v[124:127]
  v_mfma_f32_16x16x32_bf16 v[128:131], v[72:75], a[252:255], v[128:131]
  s_waitcnt vmcnt(11)
  v_mfma_f32_16x16x32_bf16 v[112:115], v[76:79], a[0:3], 0
  buffer_load_dwordx4 v[68:71], v40, s[52:55], s81 offen offset:0 sc1
  v_mfma_f32_16x16x32_bf16 v[132:135], v[76:79], a[64:67], 0
  v_mfma_f32_16x16x32_bf16 v[136:139], v[76:79], a[128:131], 0
  v_mfma_f32_16x16x32_bf16 v[140:143], v[76:79], a[192:195], 0
  s_waitcnt vmcnt(11)
  v_mfma_f32_16x16x32_bf16 v[112:115], v[80:83], a[4:7], v[112:115]
  buffer_load_dwordx4 v[72:75], v40, s[52:55], s81 offen offset:1024 sc1
  v_mfma_f32_16x16x32_bf16 v[132:135], v[80:83], a[68:71], v[132:135]
  ds_write_b128 v20, v[120:123] offset:0
  ds_write_b128 v21, v[124:127] offset:0
  ds_write_b128 v22, v[128:131] offset:0
  v_mfma_f32_16x16x32_bf16 v[136:139], v[80:83], a[132:135], v[136:139]
  v_mfma_f32_16x16x32_bf16 v[140:143], v[80:83], a[196:199], v[140:143]
  s_waitcnt vmcnt(11)
  v_mfma_f32_16x16x32_bf16 v[112:115], v[84:87], a[8:11], v[112:115]
  buffer_load_dwordx4 v[76:79], v40, s[52:55], s82 offen offset:0 sc1
  v_mfma_f32_16x16x32_bf16 v[132:135], v[84:87], a[72:75], v[132:135]
  v_mfma_f32_16x16x32_bf16 v[136:139], v[84:87], a[136:139], v[136:139]
  v_mfma_f32_16x16x32_bf16 v[140:143], v[84:87], a[200:203], v[140:143]
  s_waitcnt vmcnt(11)
  v_mfma_f32_16x16x32_bf16 v[112:115], v[88:91], a[12:15], v[112:115]
  buffer_load_dwordx4 v[80:83], v40, s[52:55], s82 offen offset:1024 sc1
  v_mfma_f32_16x16x32_bf16 v[132:135], v[88:91], a[76:79], v[132:135]
  v_mfma_f32_16x16x32_bf16 v[136:139], v[88:91], a[140:143], v[136:139]
  s_waitcnt vmcnt(7)
  v_mov_b32 v36, s61
  s_mov_b64 exec, 1
  s_cmp_eq_u32 s62, 1
  s_cbranch_scc0 L_far_107
  buffer_store_dword v36, off, s[52:55], s93 offset:0
L_stored_108:
  s_mov_b64 exec, -1
  v_mfma_f32_16x16x32_bf16 v[140:143], v[88:91], a[204:207], v[140:143]
  v_mfma_f32_16x16x32_bf16 v[112:115], v[44:47], a[16:19], v[112:115]
  buffer_load_dwordx4 v[84:87], v40, s[52:55], s83 offen offset:0 sc1
  v_mfma_f32_16x16x32_bf16 v[132:135], v[44:47], a[80:83], v[132:135]
  s_waitcnt lgkmcnt(0)
  s_barrier
  ds_read_b128 v[144:147], v11 offset:0
  ds_read_b128 v[148:151], v11 offset:1024
  ds_read_b128 v[152:155], v11 offset:2048
  v_mfma_f32_16x16x32_bf16 v[136:139], v[44:47], a[144:147], v[136:139]
  v_mfma_f32_16x16x32_bf16 v[140:143], v[44:47], a[208:211], v[140:143]
  v_mfma_f32_16x16x32_bf16 v[112:115], v[48:51], a[20:23], v[112:115]
  buffer_load_dwordx4 v[88:91], v40, s[52:55], s83 offen offset:1024 sc1
  v_mfma_f32_16x16x32_bf16 v[132:135], v[48:51], a[84:87], v[132:135]
  v_mfma_f32_16x16x32_bf16 v[136:139], v[48:51], a[148:151], v[136:139]
  v_mfma_f32_16x16x32_bf16 v[140:143], v[48:51], a[212:215], v[140:143]
  v_mfma_f32_16x16x32_bf16 v[112:115], v[52:55], a[24:27], v[112:115]
  v_add_u32 v37, 0x20000, v37
  buffer_load_dwordx4 v[44:47], v37, s[52:55], s76 offen offset:0 sc1
  v_mfma_f32_16x16x32_bf16 v[132:135], v[52:55], a[88:91], v[132:135]
  v_mfma_f32_16x16x32_bf16 v[136:139], v[52:55], a[152:155], v[136:139]
  v_mfma_f32_16x16x32_bf16 v[140:143], v[52:55], a[216:219], v[140:143]
  s_waitcnt vmcnt(10)
  v_mfma_f32_16x16x32_bf16 v[112:115], v[56:59], a[28:31], v[112:115]
  buffer_load_dwordx4 v[48:51], v37, s[52:55], s76 offen offset:1024 sc1
  v_mfma_f32_16x16x32_bf16 v[132:135], v[56:59], a[92:95], v[132:135]
  s_waitcnt lgkmcnt(0)
  v_mfma_f32_16x16x32_bf16 v[136:139], v[56:59], a[156:159], v[136:139]
  v_add_f32 v108, v108, v144
  v_add_f32_e64 v109, v109, v145
  v_mfma_f32_16x16x32_bf16 v[140:143], v[56:59], a[220:223], v[140:143]
  v_add_f32 v110, v110, v146
  v_add_f32_e64 v111, v111, v147
  s_waitcnt vmcnt(10)
  v_mfma_f32_16x16x32_bf16 v[112:115], v[60:63], a[32:35], v[112:115]
  buffer_load_dwordx4 v[52:55], v37, s[52:55], s77 offen offset:0 sc1
  v_mfma_f32_16x16x32_bf16 v[132:135], v[60:63], a[96:99], v[132:135]
  v_add_f32 v108, v108, v148
  v_add_f32 v109, v109, v149
  v_mfma_f32_16x16x32_bf16 v[136:139], v[60:63], a[160:163], v[136:139]
  v_add_f32 v110, v110, v150
  v_add_f32 v111, v111, v151
  v_mfma_f32_16x16x32_bf16 v[140:143], v[60:63], a[224:227], v[140:143]
  v_add_f32 v108, v108, v152
  v_add_f32_e64 v109, v109, v153
  s_waitcnt vmcnt(10)
  v_mfma_f32_16x16x32_bf16 v[112:115], v[64:67], a[36:39], v[112:115]
  buffer_load_dwordx4 v[56:59], v37, s[52:55], s77 offen offset:1024 sc1
  v_mfma_f32_16x16x32_bf16 v[132:135], v[64:67], a[100:103], v[132:135]
  v_add_f32 v110, v110, v154
  v_add_f32 v111, v111, v155
  v_mfma_f32_16x16x32_bf16 v[136:139], v[64:67], a[164:167], v[136:139]
  v_add_f32 v108, v108, v15
  v_add_f32 v109, v109, v15
  v_mfma_f32_16x16x32_bf16 v[140:143], v[64:67], a[228:231], v[140:143]
  v_add_f32 v110, v110, v15
  v_add_f32_e64 v111, v111, v15
  s_waitcnt vmcnt(10)
  v_mfma_f32_16x16x32_bf16 v[112:115], v[68:71], a[40:43], v[112:115]
  buffer_load_dwordx4 v[60:63], v37, s[52:55], s78 offen offset:0 sc1
  v_mfma_f32_16x16x32_bf16 v[132:135], v[68:71], a[104:107], v[132:135]
  v_mul_f32 v108, v108, v184
  v_mul_f32 v109, v109, v185
  v_mfma_f32_16x16x32_bf16 v[136:139], v[68:71], a[168:171], v[136:139]
  v_mul_f32 v110, v110, v186
  v_mul_f32 v111, v111, v187
  v_mfma_f32_16x16x32_bf16 v[140:143], v[68:71], a[232:235], v[140:143]
  v_cvt_pk_bf16_f32 v176, v108, v109
  v_cvt_pk_bf16_f32 v177, v110, v111
  s_waitcnt vmcnt(10)
  v_mfma_f32_16x16x32_bf16 v[112:115], v[72:75], a[44:47], v[112:115]
  buffer_load_dwordx4 v[64:67], v37, s[52:55], s78 offen offset:1024 sc1
  v_mfma_f32_16x16x32_bf16 v[132:135], v[72:75], a[108:111], v[132:135]
  v_mfma_f32_16x16x32_bf16 v[136:139], v[72:75], a[172:175], v[136:139]
  v_mfma_f32_16x16x32_bf16 v[140:143], v[72:75], a[236:239], v[140:143]
  s_waitcnt vmcnt(10)
  v_mfma_f32_16x16x32_bf16 v[112:115], v[76:79], a[48:51], v[112:115]
  buffer_load_dwordx4 v[68:71], v37, s[52:55], s79 offen offset:0 sc1
  v_mfma_f32_16x16x32_bf16 v[132:135], v[76:79], a[112:115], v[132:135]
  v_mfma_f32_16x16x32_bf16 v[136:139], v[76:79], a[176:179], v[136:139]
  v_mfma_f32_16x16x32_bf16 v[140:143], v[76:79], a[240:243], v[140:143]
  s_waitcnt vmcnt(10)
  v_mfma_f32_16x16x32_bf16 v[112:115], v[80:83], a[52:55], v[112:115]
  buffer_load_dwordx4 v[72:75], v37, s[52:55], s79 offen offset:1024 sc1
  v_mfma_f32_16x16x32_bf16 v[132:135], v[80:83], a[116:119], v[132:135]
  v_mfma_f32_16x16x32_bf16 v[136:139], v[80:83], a[180:183], v[136:139]
  buffer_load_dword v36, v23, s[52:55], s90 offen offset:0 sc1
  v_mfma_f32_16x16x32_bf16 v[140:143], v[80:83], a[244:247], v[140:143]
  s_waitcnt vmcnt(10)
  v_mfma_f32_16x16x32_bf16 v[112:115], v[84:87], a[56:59], v[112:115]
  buffer_load_dwordx4 v[76:79], v37, s[52:55], s80 offen offset:0 sc1
  v_mfma_f32_16x16x32_bf16 v[132:135], v[84:87], a[120:123], v[132:135]
  v_mfma_f32_16x16x32_bf16 v[136:139], v[84:87], a[184:187], v[136:139]
  v_mfma_f32_16x16x32_bf16 v[140:143], v[84:87], a[248:251], v[140:143]
  s_waitcnt vmcnt(10)
  v_mfma_f32_16x16x32_bf16 v[112:115], v[88:91], a[60:63], v[112:115]
  buffer_load_dwordx4 v[80:83], v37, s[52:55], s80 offen offset:1024 sc1
  v_mfma_f32_16x16x32_bf16 v[132:135], v[88:91], a[124:127], v[132:135]
  v_mfma_f32_16x16x32_bf16 v[136:139], v[88:91], a[188:191], v[136:139]
  v_mfma_f32_16x16x32_bf16 v[140:143], v[88:91], a[252:255], v[140:143]
  s_waitcnt vmcnt(10)
  v_mfma_f32_16x16x32_bf16 v[116:119], v[44:47], a[0:3], 0
  buffer_load_dwordx4 v[84:87], v37, s[52:55], s81 offen offset:0 sc1
  v_mfma_f32_16x16x32_bf16 v[120:123], v[44:47], a[64:67], 0
  v_mfma_f32_16x16x32_bf16 v[124:127], v[44:47], a[128:131], 0
  v_mfma_f32_16x16x32_bf16 v[128:131], v[44:47], a[192:195], 0
  s_waitcnt vmcnt(10)
  v_mfma_f32_16x16x32_bf16 v[116:119], v[48:51], a[4:7], v[116:119]
  buffer_load_dwordx4 v[88:91], v37, s[52:55], s81 offen offset:1024 sc1
  v_mfma_f32_16x16x32_bf16 v[120:123], v[48:51], a[68:71], v[120:123]
  ds_write_b128 v20, v[132:135] offset:12288
  ds_write_b128 v21, v[136:139] offset:12288
  ds_write_b128 v22, v[140:143] offset:12288
  v_mfma_f32_16x16x32_bf16 v[124:127], v[48:51], a[132:135], v[124:127]
  v_mfma_f32_16x16x32_bf16 v[128:131], v[48:51], a[196:199], v[128:131]
  s_waitcnt vmcnt(10)
  v_mfma_f32_16x16x32_bf16 v[116:119], v[52:55], a[8:11], v[116:119]
  buffer_load_dwordx4 v[44:47], v37, s[52:55], s82 offen offset:0 sc1
  v_mfma_f32_16x16x32_bf16 v[120:123], v[52:55], a[72:75], v[120:123]
  v_mfma_f32_16x16x32_bf16 v[124:127], v[52:55], a[136:139], v[124:127]
  v_mfma_f32_16x16x32_bf16 v[128:131], v[52:55], a[200:203], v[128:131]
  s_waitcnt vmcnt(10)
  v_mfma_f32_16x16x32_bf16 v[116:119], v[56:59], a[12:15], v[116:119]
  buffer_load_dwordx4 v[48:51], v37, s[52:55], s82 offen offset:1024 sc1
  v_mfma_f32_16x16x32_bf16 v[120:123], v[56:59], a[76:79], v[120:123]
  v_mfma_f32_16x16x32_bf16 v[124:127], v[56:59], a[140:143], v[124:127]
  v_mfma_f32_16x16x32_bf16 v[128:131], v[56:59], a[204:207], v[128:131]
  s_waitcnt vmcnt(10)
  v_mfma_f32_16x16x32_bf16 v[116:119], v[60:63], a[16:19], v[116:119]
  buffer_load_dwordx4 v[52:55], v37, s[52:55], s83 offen offset:0 sc1
  v_mfma_f32_16x16x32_bf16 v[120:123], v[60:63], a[80:83], v[120:123]
  s_waitcnt lgkmcnt(0)
  s_barrier
  ds_read_b128 v[144:147], v11 offset:12288
  ds_read_b128 v[148:151], v11 offset:13312
  ds_read_b128 v[152:155], v11 offset:14336
  v_mfma_f32_16x16x32_bf16 v[124:127], v[60:63], a[144:147], v[124:127]
  v_mfma_f32_16x16x32_bf16 v[128:131], v[60:63], a[208:211], v[128:131]
  s_waitcnt vmcnt(10)
  v_mfma_f32_16x16x32_bf16 v[116:119], v[64:67], a[20:23], v[116:119]
  buffer_load_dwordx4 v[56:59], v37, s[52:55], s83 offen offset:1024 sc1
  v_mfma_f32_16x16x32_bf16 v[120:123], v[64:67], a[84:87], v[120:123]
  v_mfma_f32_16x16x32_bf16 v[124:127], v[64:67], a[148:151], v[124:127]
  v_mfma_f32_16x16x32_bf16 v[128:131], v[64:67], a[212:215], v[128:131]
  s_waitcnt vmcnt(8)
  v_cmp_ne_u32 vcc, s61, v36
  s_cbranch_vccnz L_rare_109
L_back_110:
  v_mfma_f32_16x16x32_bf16 v[116:119], v[68:71], a[24:27], v[116:119]
  buffer_load_dwordx4 v[156:159], v4, s[52:55], s12 offen offset:0 sc1
  v_mfma_f32_16x16x32_bf16 v[120:123], v[68:71], a[88:91], v[120:123]
  v_mfma_f32_16x16x32_bf16 v[124:127], v[68:71], a[152:155], v[124:127]
  buffer_load_dwordx4 v[160:163], v4, s[52:55], s12 offen offset:1024 sc1
  v_mfma_f32_16x16x32_bf16 v[128:131], v[68:71], a[216:219], v[128:131]
  v_mfma_f32_16x16x32_bf16 v[116:119], v[72:75], a[28:31], v[116:119]
  buffer_load_dwordx4 v[164:167], v4, s[52:55], s12 offen offset:3072 sc1
  v_mfma_f32_16x16x32_bf16 v[120:123], v[72:75], a[92:95], v[120:123]
  s_waitcnt lgkmcnt(0)
  v_mfma_f32_16x16x32_bf16 v[124:127], v[72:75], a[156:159], v[124:127]
  buffer_load_dwordx4 v[196:199], v4, s[52:55], s13 offen offset:0 sc1
  v_mfma_f32_16x16x32_bf16 v[128:131], v[72:75], a[220:223], v[128:131]
  v_add_f32 v112, v112, v144
  v_add_f32 v113, v113, v145
  s_waitcnt vmcnt(11)
  v_mfma_f32_16x16x32_bf16 v[116:119], v[76:79], a[32:35], v[116:119]
  buffer_load_dwordx4 v[200:203], v4, s[52:55], s13 offen offset:3072 sc1
  v_mfma_f32_16x16x32_bf16 v[120:123], v[76:79], a[96:99], v[120:123]
  v_add_f32 v114, v114, v146
  v_add_f32 v115, v115, v147
  v_mfma_f32_16x16x32_bf16 v[124:127], v[76:79], a[160:163], v[124:127]
  buffer_load_dwordx4 v[204:207], v4, s[52:55], s16 offen offset:1024 sc1
  v_mfma_f32_16x16x32_bf16 v[128:131], v[76:79], a[224:227], v[128:131]
  v_add_f32 v112, v112, v148
  v_add_f32_e64 v113, v113, v149
  s_waitcnt vmcnt(12)
  v_mfma_f32_16x16x32_bf16 v[116:119], v[80:83], a[36:39], v[116:119]
  buffer_load_dwordx4 v[208:211], v4, s[52:55], s16 offen offset:2048 sc1
  v_mfma_f32_16x16x32_bf16 v[120:123], v[80:83], a[100:103], v[120:123]
  v_add_f32 v114, v114, v150
  v_add_f32 v115, v115, v151
  v_mfma_f32_16x16x32_bf16 v[124:127], v[80:83], a[164:167], v[124:127]
  buffer_load_dwordx4 v[212:215], v4, s[52:55], s17 offen offset:1024 sc1
  v_mfma_f32_16x16x32_bf16 v[128:131], v[80:83], a[228:231], v[128:131]
  v_add_f32 v112, v112, v152
  v_add_f32_e64 v113, v113, v153
  s_waitcnt vmcnt(13)
  v_mfma_f32_16x16x32_bf16 v[116:119], v[84:87], a[40:43], v[116:119]
  buffer_load_dwordx4 v[216:219], v4, s[52:55], s17 offen offset:2048 sc1
  v_mfma_f32_16x16x32_bf16 v[120:123], v[84:87], a[104:107], v[120:123]
  v_add_f32 v114, v114, v154
  v_add_f32 v115, v115, v155
  v_mfma_f32_16x16x32_bf16 v[124:127], v[84:87], a[168:171], v[124:127]
  s_add_u32 m0, s94, 32768
  s_add_u32 s65, s91, 262144
  v_mfma_f32_16x16x32_bf16 v[128:131], v[84:87], a[232:235], v[128:131]
  v_add_f32 v112, v112, v15
  v_add_f32_e64 v113, v113, v15
  s_waitcnt vmcnt(13)
  v_mfma_f32_16x16x32_bf16 v[116:119], v[88:91], a[44:47], v[116:119]
  buffer_load_dwordx4 v5, s[36:39], s65 offen  lds
  v_mfma_f32_16x16x32_bf16 v[120:123], v[88:91], a[108:111], v[120:123]
  v_add_f32 v114, v114, v15
  v_add_f32 v115, v115, v15
  v_mfma_f32_16x16x32_bf16 v[124:127], v[88:91], a[172:175], v[124:127]
  buffer_load_dwordx4 v6, s[36:39], s65 offen offset:1024  lds
  v_mfma_f32_16x16x32_bf16 v[128:131], v[88:91], a[236:239], v[128:131]
  v_mul_f32 v112, v112, v188
  v_mul_f32_e64 v113, v113, v189
  s_waitcnt vmcnt(14)
  v_mfma_f32_16x16x32_bf16 v[116:119], v[44:47], a[48:51], v[116:119]
  buffer_load_dwordx4 v7, s[36:39], s65 offen offset:2048  lds
  v_mfma_f32_16x16x32_bf16 v[120:123], v[44:47], a[112:115], v[120:123]
  v_mul_f32 v114, v114, v190
  v_mul_f32 v115, v115, v191
  v_mfma_f32_16x16x32_bf16 v[124:127], v[44:47], a[176:179], v[124:127]
  buffer_load_dwordx4 v8, s[36:39], s65 offen offset:3072  lds
  v_mfma_f32_16x16x32_bf16 v[128:131], v[44:47], a[240:243], v[128:131]
  v_cvt_pk_bf16_f32 v178, v112, v113
  v_cvt_pk_bf16_f32 v179, v114, v115
  s_waitcnt vmcnt(15)
  v_mfma_f32_16x16x32_bf16 v[116:119], v[48:51], a[52:55], v[116:119]
  s_add_u32 m0, s94, 49152
  s_add_u32 s65, s91, 393216
  v_mfma_f32_16x16x32_bf16 v[120:123], v[48:51], a[116:119], v[120:123]
  v_mfma_f32_16x16x32_bf16 v[124:127], v[48:51], a[180:183], v[124:127]
  buffer_load_dwordx4 v5, s[36:39], s65 offen  lds
  v_mfma_f32_16x16x32_bf16 v[128:131], v[48:51], a[244:247], v[128:131]
  s_waitcnt vmcnt(15)
  v_mfma_f32_16x16x32_bf16 v[116:119], v[52:55], a[56:59], v[116:119]
  buffer_load_dwordx4 v6, s[36:39], s65 offen offset:1024  lds
  v_mfma_f32_16x16x32_bf16 v[120:123], v[52:55], a[120:123], v[120:123]
  v_mfma_f32_16x16x32_bf16 v[124:127], v[52:55], a[184:187], v[124:127]
  buffer_load_dwordx4 v7, s[36:39], s65 offen offset:2048  lds
  v_mfma_f32_16x16x32_bf16 v[128:131], v[52:55], a[248:251], v[128:131]
  s_waitcnt vmcnt(16)
  v_mfma_f32_16x16x32_bf16 v[116:119], v[56:59], a[60:63], v[116:119]
  buffer_load_dwordx4 v8, s[36:39], s65 offen offset:3072  lds
  v_mfma_f32_16x16x32_bf16 v[120:123], v[56:59], a[124:127], v[120:123]
  v_mfma_f32_16x16x32_bf16 v[124:127], v[56:59], a[188:191], v[124:127]
  s_add_u32 m0, s94, 98304
  s_add_u32 s65, s91, 786432
  v_mfma_f32_16x16x32_bf16 v[128:131], v[56:59], a[252:255], v[128:131]
  v_add_u32 v16, 0xe000, v24
  v_add_u32 v17, 0xe000, v25
  v_add_u32 v18, 0xe000, v26
  v_add_u32 v19, 0xe000, v27
  ds_write_b128 v20, v[120:123] offset:0
  ds_write_b128 v21, v[124:127] offset:0
  s_nop 1
  ds_write_b128 v22, v[128:131] offset:0
  s_waitcnt lgkmcnt(0)
  s_barrier
  ds_read_b128 v[144:147], v11 offset:0
  ds_read_b128 v[148:151], v11 offset:1024
  ds_read_b128 v[152:155], v11 offset:2048
  s_cmp_eq_u32 s62, 1
  s_cbranch_scc0 L_far_114
  buffer_store_dwordx4 v[176:179], v4, s[52:55], s85 offen offset:2048
L_stored_115:
  ds_read_b64_tr_b16 v[44:45], v24 offset:0
  ds_read_b64_tr_b16 v[46:47], v24 offset:2048
  ds_read_b64_tr_b16 v[48:49], v25 offset:0
  ds_read_b64_tr_b16 v[50:51], v25 offset:2048
  ds_read_b64_tr_b16 v[52:53], v26 offset:0
  ds_read_b64_tr_b16 v[54:55], v26 offset:2048
  ds_read_b64_tr_b16 v[56:57], v27 offset:0
  ds_read_b64_tr_b16 v[58:59], v27 offset:2048
  ds_read_b64_tr_b16 v[60:61], v24 offset:4096
  ds_read_b64_tr_b16 v[62:63], v24 offset:6144
  s_waitcnt lgkmcnt(10)
  v_pk_add_f32 v[144:145], v[144:145], v[148:149]
  v_pk_add_f32 v[116:117], v[116:117], v[152:153]
  v_pk_add_f32 v[146:147], v[146:147], v[150:151]
  v_pk_add_f32 v[118:119], v[118:119], v[154:155]
  v_pk_add_f32 v[116:117], v[116:117], v[144:145]
  v_pk_add_f32 v[118:119], v[118:119], v[146:147]
  v_add_f32 v116, v116, v15
  v_add_f32 v117, v117, v15
  v_add_f32 v118, v118, v15
  v_add_f32 v119, v119, v15
  v_mul_f32 v116, v116, v192
  v_mul_f32 v117, v117, v193
  v_mul_f32 v118, v118, v194
  v_mul_f32_e64 v119, v119, v195
  v_cvt_pk_bf16_f32 v180, v116, v117
  v_cvt_pk_bf16_f32 v181, v118, v119
  s_cmp_eq_u32 s62, 1
  s_cbranch_scc0 L_far_116
  buffer_store_dwordx2 v[180:181], v4, s[52:55], s84 offen
L_stored_117:
  buffer_load_dwordx4 v5, s[36:39], s65 offen  lds
  buffer_load_dwordx4 v6, s[36:39], s65 offen offset:1024  lds
  buffer_load_dwordx4 v7, s[36:39], s65 offen offset:2048  lds
  buffer_load_dwordx4 v8, s[36:39], s65 offen offset:3072  lds
  ds_read_b64_tr_b16 v[64:65], v25 offset:4096
  ds_read_b64_tr_b16 v[66:67], v25 offset:6144
  ds_read_b64_tr_b16 v[40:41], v26 offset:4096
  ds_read_b64_tr_b16 v[42:43], v26 offset:6144
  s_waitcnt vmcnt(22) lgkmcnt(6)
  v_mfma_f32_16x16x32_bf16 v[120:123], v[44:47], v[156:159], 0
  ds_read_b64_tr_b16 v[68:69], v27 offset:4096
  ds_read_b64_tr_b16 v[70:71], v27 offset:6144
  ds_read_b64_tr_b16 v[72:73], v24 offset:14336
  ds_read_b64_tr_b16 v[74:75], v24 offset:16384
  v_mfma_f32_16x16x32_bf16 v[124:127], v[48:51], v[156:159], 0
  ds_read_b64_tr_b16 v[76:77], v25 offset:14336
  ds_read_b64_tr_b16 v[78:79], v25 offset:16384
  ds_read_b64_tr_b16 v[80:81], v26 offset:14336
  ds_read_b64_tr_b16 v[82:83], v26 offset:16384
  v_mfma_f32_16x16x32_bf16 v[128:131], v[52:55], v[156:159], 0
  s_waitcnt lgkmcnt(8)
  ds_read_b64_tr_b16 v[84:85], v27 offset:14336
  ds_read_b64_tr_b16 v[86:87], v27 offset:16384
  ds_read_b64_tr_b16 v[88:89], v24 offset:18432
  ds_read_b64_tr_b16 v[90:91], v24 offset:20480
  v_mfma_f32_16x16x32_bf16 v[132:135], v[56:59], v[156:159], 0
  ds_read_b64_tr_b16 v[92:93], v25 offset:18432
  ds_read_b64_tr_b16 v[94:95], v25 offset:20480
  s_waitcnt lgkmcnt(8)
  ds_read_b64_tr_b16 v[96:97], v26 offset:18432
  ds_read_b64_tr_b16 v[98:99], v26 offset:20480
  s_waitcnt vmcnt(21)
  v_mfma_f32_16x16x32_bf16 v[120:123], v[60:63], v[160:163], v[120:123]
  buffer_load_dwordx4 v[220:223], v4, s[52:55], s14 offen offset:0 sc1
  ds_read_b64_tr_b16 v[100:101], v27 offset:18432
  ds_read_b64_tr_b16 v[102:103], v27 offset:20480
  ds_read_b64_tr_b16 v[104:105], v24 offset:28672
  ds_read_b64_tr_b16 v[106:107], v24 offset:30720
  v_mfma_f32_16x16x32_bf16 v[124:127], v[64:67], v[160:163], v[124:127]
  s_waitcnt lgkmcnt(8)
  ds_read_b64_tr_b16 v[108:109], v25 offset:28672
  ds_read_b64_tr_b16 v[110:111], v25 offset:30720
  ds_read_b64_tr_b16 v[112:113], v26 offset:28672
  ds_read_b64_tr_b16 v[114:115], v26 offset:30720
  v_mfma_f32_16x16x32_bf16 v[128:131], v[40:43], v[160:163], v[128:131]
  ds_read_b64_tr_b16 v[116:117], v27 offset:28672
  ds_read_b64_tr_b16 v[118:119], v27 offset:30720
  s_waitcnt lgkmcnt(8)
  ds_read_b64_tr_b16 v[136:137], v16 offset:14336
  ds_read_b64_tr_b16 v[138:139], v16 offset:16384
  v_mfma_f32_16x16x32_bf16 v[132:135], v[68:71], v[160:163], v[132:135]
  ds_read_b64_tr_b16 v[44:45], v17 offset:14336
  ds_read_b64_tr_b16 v[46:47], v17 offset:16384
  ds_read_b64_tr_b16 v[48:49], v18 offset:14336
  ds_read_b64_tr_b16 v[50:51], v18 offset:16384
  s_waitcnt vmcnt(21)
  v_mfma_f32_16x16x32_bf16 v[120:123], v[72:75], v[164:167], v[120:123]
  buffer_load_dwordx4 v[156:159], v4, s[52:55], s14 offen offset:2048 sc1
  s_waitcnt lgkmcnt(8)
  ds_read_b64_tr_b16 v[52:53], v19 offset:14336
  ds_read_b64_tr_b16 v[54:55], v19 offset:16384
  ds_read_b64_tr_b16 v[56:57], v16 offset:18432
  ds_read_b64_tr_b16 v[58:59], v16 offset:20480
  v_mfma_f32_16x16x32_bf16 v[124:127], v[76:79], v[164:167], v[124:127]
  ds_read_b64_tr_b16 v[60:61], v17 offset:18432
  ds_read_b64_tr_b16 v[62:63], v17 offset:20480
  s_waitcnt lgkmcnt(8)
  ds_read_b64_tr_b16 v[64:65], v18 offset:18432
  ds_read_b64_tr_b16 v[66:67], v18 offset:20480
  v_mfma_f32_16x16x32_bf16 v[128:131], v[80:83], v[164:167], v[128:131]
  ds_read_b64_tr_b16 v[40:41], v19 offset:18432
  ds_read_b64_tr_b16 v[42:43], v19 offset:20480
  ds_read_b64_tr_b16 v[68:69], v16 offset:28672
  ds_read_b64_tr_b16 v[70:71], v16 offset:30720
  v_mfma_f32_16x16x32_bf16 v[132:135], v[84:87], v[164:167], v[132:135]
  s_waitcnt lgkmcnt(8)
  ds_read_b64_tr_b16 v[72:73], v17 offset:28672
  ds_read_b64_tr_b16 v[74:75], v17 offset:30720
  ds_read_b64_tr_b16 v[76:77], v18 offset:28672
  ds_read_b64_tr_b16 v[78:79], v18 offset:30720
  s_waitcnt vmcnt(21)
  v_mfma_f32_16x16x32_bf16 v[120:123], v[88:91], v[196:199], v[120:123]
  buffer_load_dwordx4 v[160:163], v4, s[52:55], s14 offen offset:3072 sc1
  ds_read_b64_tr_b16 v[80:81], v19 offset:28672
  ds_read_b64_tr_b16 v[82:83], v19 offset:30720
  s_waitcnt lgkmcnt(8)
  ds_read_b64_tr_b16 v[84:85], v16 offset:32768
  ds_read_b64_tr_b16 v[86:87], v16 offset:34816
  v_mfma_f32_16x16x32_bf16 v[124:127], v[92:95], v[196:199], v[124:127]
  ds_read_b64_tr_b16 v[88:89], v17 offset:32768
  ds_read_b64_tr_b16 v[90:91], v17 offset:34816
  v_mfma_f32_16x16x32_bf16 v[128:131], v[96:99], v[196:199], v[128:131]
  ds_read_b64_tr_b16 v[92:93], v18 offset:32768
  ds_read_b64_tr_b16 v[94:95], v18 offset:34816
  v_mfma_f32_16x16x32_bf16 v[132:135], v[100:103], v[196:199], v[132:135]
  s_waitcnt lgkmcnt(8)
  ds_read_b64_tr_b16 v[96:97], v19 offset:32768
  ds_read_b64_tr_b16 v[98:99], v19 offset:34816
  s_waitcnt vmcnt(21)
  v_mfma_f32_16x16x32_bf16 v[120:123], v[104:107], v[200:203], v[120:123]
  buffer_load_dwordx4 v[164:167], v4, s[52:55], s15 offen offset:2048 sc1
  v_mfma_f32_16x16x32_bf16 v[124:127], v[108:111], v[200:203], v[124:127]
  v_mfma_f32_16x16x32_bf16 v[128:131], v[112:115], v[200:203], v[128:131]
  v_mfma_f32_16x16x32_bf16 v[132:135], v[116:119], v[200:203], v[132:135]
  s_waitcnt vmcnt(8)
  v_mov_b32_e64 v36, s61
  s_mov_b64 exec, 1
  s_cmp_eq_u32 s62, 1
  s_cbranch_scc0 L_far_118
  buffer_store_dword v36, off, s[52:55], s93 offset:64
L_stored_119:
  s_mov_b64 exec, -1
  s_waitcnt vmcnt(5)
  s_barrier
  ds_read_b64_tr_b16 v[100:101], v24 offset:32768
  ds_read_b64_tr_b16 v[102:103], v24 offset:34816
  ds_read_b64_tr_b16 v[104:105], v25 offset:32768
  ds_read_b64_tr_b16 v[106:107], v25 offset:34816
  v_mfma_f32_16x16x32_bf16 v[120:123], v[136:139], v[204:207], v[120:123]
  buffer_load_dwordx4 v[196:199], v4, s[52:55], s15 offen offset:3072 sc1
  s_waitcnt lgkmcnt(8)
  ds_read_b64_tr_b16 v[108:109], v26 offset:32768
  ds_read_b64_tr_b16 v[110:111], v26 offset:34816
  ds_read_b64_tr_b16 v[112:113], v27 offset:32768
  ds_read_b64_tr_b16 v[114:115], v27 offset:34816
  v_mfma_f32_16x16x32_bf16 v[124:127], v[44:47], v[204:207], v[124:127]
  ds_read_b64_tr_b16 v[116:117], v24 offset:43008
  ds_read_b64_tr_b16 v[118:119], v24 offset:45056
  s_waitcnt lgkmcnt(8)
  ds_read_b64_tr_b16 v[136:137], v25 offset:43008
  ds_read_b64_tr_b16 v[138:139], v25 offset:45056
  v_mfma_f32_16x16x32_bf16 v[128:131], v[48:51], v[204:207], v[128:131]
  ds_read_b64_tr_b16 v[44:45], v26 offset:43008
  ds_read_b64_tr_b16 v[46:47], v26 offset:45056
  v_mfma_f32_16x16x32_bf16 v[132:135], v[52:55], v[204:207], v[132:135]
  ds_read_b64_tr_b16 v[48:49], v27 offset:43008
  ds_read_b64_tr_b16 v[50:51], v27 offset:45056
  v_mfma_f32_16x16x32_bf16 v[120:123], v[56:59], v[208:211], v[120:123]
  buffer_load_dwordx4 v[200:203], v4, s[52:55], s18 offen offset:0 sc1
  s_waitcnt lgkmcnt(8)
  ds_read_b64_tr_b16 v[52:53], v24 offset:47104
  ds_read_b64_tr_b16 v[54:55], v24 offset:49152
  v_mfma_f32_16x16x32_bf16 v[124:127], v[60:63], v[208:211], v[124:127]
  ds_read_b64_tr_b16 v[56:57], v25 offset:47104
  ds_read_b64_tr_b16 v[58:59], v25 offset:49152
  v_mfma_f32_16x16x32_bf16 v[128:131], v[64:67], v[208:211], v[128:131]
  ds_read_b64_tr_b16 v[60:61], v26 offset:47104
  ds_read_b64_tr_b16 v[62:63], v26 offset:49152
  v_mfma_f32_16x16x32_bf16 v[132:135], v[40:43], v[208:211], v[132:135]
  s_waitcnt lgkmcnt(8)
  ds_read_b64_tr_b16 v[64:65], v27 offset:47104
  ds_read_b64_tr_b16 v[66:67], v27 offset:49152
  v_mfma_f32_16x16x32_bf16 v[120:123], v[68:71], v[212:215], v[120:123]
  buffer_load_dwordx4 v[204:207], v4, s[52:55], s18 offen offset:1024 sc1
  ds_read_b64_tr_b16 v[40:41], v16 offset:0
  ds_read_b64_tr_b16 v[42:43], v16 offset:2048
  v_mfma_f32_16x16x32_bf16 v[124:127], v[72:75], v[212:215], v[124:127]
  ds_read_b64_tr_b16 v[68:69], v17 offset:0
  ds_read_b64_tr_b16 v[70:71], v17 offset:2048
  v_mfma_f32_16x16x32_bf16 v[128:131], v[76:79], v[212:215], v[128:131]
  s_waitcnt lgkmcnt(8)
  ds_read_b64_tr_b16 v[72:73], v18 offset:0
  ds_read_b64_tr_b16 v[74:75], v18 offset:2048
  v_mfma_f32_16x16x32_bf16 v[132:135], v[80:83], v[212:215], v[132:135]
  ds_read_b64_tr_b16 v[76:77], v19 offset:0
  ds_read_b64_tr_b16 v[78:79], v19 offset:2048
  v_mfma_f32_16x16x32_bf16 v[120:123], v[84:87], v[216:219], v[120:123]
  ds_read_b64_tr_b16 v[80:81], v16 offset:4096
  ds_read_b64_tr_b16 v[82:83], v16 offset:6144
  v_mfma_f32_16x16x32_bf16 v[124:127], v[88:91], v[216:219], v[124:127]
  s_waitcnt lgkmcnt(8)
  ds_read_b64_tr_b16 v[84:85], v17 offset:4096
  ds_read_b64_tr_b16 v[86:87], v17 offset:6144
  v_mfma_f32_16x16x32_bf16 v[128:131], v[92:95], v[216:219], v[128:131]
  ds_read_b64_tr_b16 v[88:89], v18 offset:4096
  ds_read_b64_tr_b16 v[90:91], v18 offset:6144
  v_mfma_f32_16x16x32_bf16 v[132:135], v[96:99], v[216:219], v[132:135]
  ds_read_b64_tr_b16 v[92:93], v19 offset:4096
  ds_read_b64_tr_b16 v[94:95], v19 offset:6144
  s_waitcnt vmcnt(7)
  v_mfma_f32_16x16x32_bf16 v[120:123], v[100:103], v[220:223], v[120:123]
  s_waitcnt lgkmcnt(8)
  ds_read_b64_tr_b16 v[96:97], v16 offset:43008
  ds_read_b64_tr_b16 v[98:99], v16 offset:45056
  v_mfma_f32_16x16x32_bf16 v[124:127], v[104:107], v[220:223], v[124:127]
  ds_read_b64_tr_b16 v[100:101], v17 offset:43008
  ds_read_b64_tr_b16 v[102:103], v17 offset:45056
  v_mfma_f32_16x16x32_bf16 v[128:131], v[108:111], v[220:223], v[128:131]
  ds_read_b64_tr_b16 v[104:105], v18 offset:43008
  ds_read_b64_tr_b16 v[106:107], v18 offset:45056
  v_mfma_f32_16x16x32_bf16 v[132:135], v[112:115], v[220:223], v[132:135]
  s_waitcnt lgkmcnt(8)
  ds_read_b64_tr_b16 v[108:109], v19 offset:43008
  ds_read_b64_tr_b16 v[110:111], v19 offset:45056
  s_waitcnt vmcnt(6)
  v_mfma_f32_16x16x32_bf16 v[120:123], v[116:119], v[156:159], v[120:123]
  ds_read_b64_tr_b16 v[112:113], v16 offset:47104
  ds_read_b64_tr_b16 v[114:115], v16 offset:49152
  v_mfma_f32_16x16x32_bf16 v[124:127], v[136:139], v[156:159], v[124:127]
  ds_read_b64_tr_b16 v[116:117], v17 offset:47104
  ds_read_b64_tr_b16 v[118:119], v17 offset:49152
  v_mfma_f32_16x16x32_bf16 v[128:131], v[44:47], v[156:159], v[128:131]
  buffer_load_dword v36, v23, s[52:55], s90 offen offset:64 sc1
  s_waitcnt lgkmcnt(8)
  ds_read_b64_tr_b16 v[136:137], v18 offset:47104
  ds_read_b64_tr_b16 v[138:139], v18 offset:49152
  v_mfma_f32_16x16x32_bf16 v[132:135], v[48:51], v[156:159], v[132:135]
  ds_read_b64_tr_b16 v[44:45], v19 offset:47104
  ds_read_b64_tr_b16 v[46:47], v19 offset:49152
  s_waitcnt vmcnt(6)
  v_mfma_f32_16x16x32_bf16 v[120:123], v[52:55], v[160:163], v[120:123]
  ds_read_b64_tr_b16 v[48:49], v24 offset:8192
  ds_read_b64_tr_b16 v[50:51], v24 offset:10240
  v_mfma_f32_16x16x32_bf16 v[124:127], v[56:59], v[160:163], v[124:127]
  s_waitcnt lgkmcnt(8)
  ds_read_b64_tr_b16 v[52:53], v25 offset:8192
  ds_read_b64_tr_b16 v[54:55], v25 offset:10240
  v_mfma_f32_16x16x32_bf16 v[128:131], v[60:63], v[160:163], v[128:131]
  ds_read_b64_tr_b16 v[56:57], v26 offset:8192
  ds_read_b64_tr_b16 v[58:59], v26 offset:10240
  v_mfma_f32_16x16x32_bf16 v[132:135], v[64:67], v[160:163], v[132:135]
  ds_read_b64_tr_b16 v[60:61], v27 offset:8192
  ds_read_b64_tr_b16 v[62:63], v27 offset:10240
  s_waitcnt vmcnt(5)
  v_mfma_f32_16x16x32_bf16 v[120:123], v[40:43], v[164:167], v[120:123]
  s_waitcnt lgkmcnt(8)
  ds_read_b64_tr_b16 v[64:65], v24 offset:22528
  ds_read_b64_tr_b16 v[66:67], v24 offset:24576
  v_mfma_f32_16x16x32_bf16 v[124:127], v[68:71], v[164:167], v[124:127]
  ds_read_b64_tr_b16 v[40:41], v25 offset:22528
  ds_read_b64_tr_b16 v[42:43], v25 offset:24576
  v_mfma_f32_16x16x32_bf16 v[128:131], v[72:75], v[164:167], v[128:131]
  ds_read_b64_tr_b16 v[68:69], v26 offset:22528
  ds_read_b64_tr_b16 v[70:71], v26 offset:24576
  v_mfma_f32_16x16x32_bf16 v[132:135], v[76:79], v[164:167], v[132:135]
  s_waitcnt vmcnt(0)
  v_cmp_ne_u32 vcc, s61, v36
  s_cbranch_vccnz L_rare_120
L_back_121:
  buffer_load_dwordx4 v[208:211], v4, s[52:55], s12 offen offset:2048 sc1
  buffer_load_dwordx4 v[212:215], v4, s[52:55], s13 offen offset:1024 sc1
  buffer_load_dwordx4 v[216:219], v4, s[52:55], s13 offen offset:2048 sc1
  buffer_load_dwordx4 v[220:223], v4, s[52:55], s14 offen offset:1024 sc1
  s_waitcnt lgkmcnt(8)
  ds_read_b64_tr_b16 v[72:73], v27 offset:22528
  ds_read_b64_tr_b16 v[74:75], v27 offset:24576
  v_mfma_f32_16x16x32_bf16 v[120:123], v[80:83], v[196:199], v[120:123]
  ds_read_b64_tr_b16 v[76:77], v24 offset:12288
  ds_read_b64_tr_b16 v[78:79], v24 offset:26624
  v_mfma_f32_16x16x32_bf16 v[124:127], v[84:87], v[196:199], v[124:127]
  ds_read_b64_tr_b16 v[80:81], v25 offset:12288
  ds_read_b64_tr_b16 v[82:83], v25 offset:26624
  v_mfma_f32_16x16x32_bf16 v[128:131], v[88:91], v[196:199], v[128:131]
  s_waitcnt lgkmcnt(8)
  ds_read_b64_tr_b16 v[84:85], v26 offset:12288
  ds_read_b64_tr_b16 v[86:87], v26 offset:26624
  v_mfma_f32_16x16x32_bf16 v[132:135], v[92:95], v[196:199], v[132:135]
  buffer_load_dwordx4 v[156:159], v4, s[52:55], s15 offen offset:0 sc1
  ds_read_b64_tr_b16 v[88:89], v27 offset:12288
  ds_read_b64_tr_b16 v[90:91], v27 offset:26624
  v_mfma_f32_16x16x32_bf16 v[120:123], v[96:99], v[200:203], v[120:123]
  ds_read_b64_tr_b16 v[92:93], v24 offset:36864
  ds_read_b64_tr_b16 v[94:95], v24 offset:38912
  v_mfma_f32_16x16x32_bf16 v[124:127], v[100:103], v[200:203], v[124:127]
  s_waitcnt lgkmcnt(8)
  ds_read_b64_tr_b16 v[96:97], v25 offset:36864
  ds_read_b64_tr_b16 v[98:99], v25 offset:38912
  v_mfma_f32_16x16x32_bf16 v[128:131], v[104:107], v[200:203], v[128:131]
  buffer_load_dwordx4 v[160:163], v4, s[52:55], s15 offen offset:1024 sc1
  ds_read_b64_tr_b16 v[100:101], v26 offset:36864
  ds_read_b64_tr_b16 v[102:103], v26 offset:38912
  v_mfma_f32_16x16x32_bf16 v[132:135], v[108:111], v[200:203], v[132:135]
  ds_read_b64_tr_b16 v[104:105], v27 offset:36864
  ds_read_b64_tr_b16 v[106:107], v27 offset:38912
  v_mfma_f32_16x16x32_bf16 v[120:123], v[112:115], v[204:207], v[120:123]
  s_waitcnt lgkmcnt(8)
  ds_read_b64_tr_b16 v[108:109], v24 offset:51200
  ds_read_b64_tr_b16 v[110:111], v24 offset:53248
  v_mfma_f32_16x16x32_bf16 v[124:127], v[116:119], v[204:207], v[124:127]
  buffer_load_dwordx4 v[164:167], v4, s[52:55], s16 offen offset:0 sc1
  ds_read_b64_tr_b16 v[112:113], v25 offset:51200
  ds_read_b64_tr_b16 v[114:115], v25 offset:53248
  v_mfma_f32_16x16x32_bf16 v[128:131], v[136:139], v[204:207], v[128:131]
  ds_read_b64_tr_b16 v[116:117], v26 offset:51200
  ds_read_b64_tr_b16 v[118:119], v26 offset:53248
  v_mfma_f32_16x16x32_bf16 v[132:135], v[44:47], v[204:207], v[132:135]
  s_waitcnt lgkmcnt(8)
  ds_read_b64_tr_b16 v[136:137], v27 offset:51200
  ds_read_b64_tr_b16 v[138:139], v27 offset:53248
  s_waitcnt vmcnt(6)
  v_mfma_f32_16x16x32_bf16 v[120:123], v[48:51], v[208:211], v[120:123]
  buffer_load_dwordx4 v[196:199], v4, s[52:55], s16 offen offset:3072 sc1
  ds_read_b64_tr_b16 v[44:45], v24 offset:40960
  ds_read_b64_tr_b16 v[46:47], v24 offset:55296
  v_mfma_f32_16x16x32_bf16 v[124:127], v[52:55], v[208:211], v[124:127]
  ds_read_b64_tr_b16 v[48:49], v25 offset:40960
  ds_read_b64_tr_b16 v[50:51], v25 offset:55296
  v_mfma_f32_16x16x32_bf16 v[128:131], v[56:59], v[208:211], v[128:131]
  s_waitcnt lgkmcnt(8)
  ds_read_b64_tr_b16 v[52:53], v26 offset:40960
  ds_read_b64_tr_b16 v[54:55], v26 offset:55296
  v_mfma_f32_16x16x32_bf16 v[132:135], v[60:63], v[208:211], v[132:135]
  buffer_load_dwordx4 v[200:203], v4, s[52:55], s17 offen offset:0 sc1
  ds_read_b64_tr_b16 v[56:57], v27 offset:40960
  ds_read_b64_tr_b16 v[58:59], v27 offset:55296
  s_waitcnt vmcnt(7)
  v_mfma_f32_16x16x32_bf16 v[120:123], v[64:67], v[212:215], v[120:123]
  ds_read_b64_tr_b16 v[60:61], v16 offset:8192
  ds_read_b64_tr_b16 v[62:63], v16 offset:10240
  v_mfma_f32_16x16x32_bf16 v[124:127], v[40:43], v[212:215], v[124:127]
  s_waitcnt lgkmcnt(8)
  ds_read_b64_tr_b16 v[64:65], v17 offset:8192
  ds_read_b64_tr_b16 v[66:67], v17 offset:10240
  v_mfma_f32_16x16x32_bf16 v[128:131], v[68:71], v[212:215], v[128:131]
  buffer_load_dwordx4 v[204:207], v4, s[52:55], s17 offen offset:3072 sc1
  ds_read_b64_tr_b16 v[40:41], v18 offset:8192
  ds_read_b64_tr_b16 v[42:43], v18 offset:10240
  v_mfma_f32_16x16x32_bf16 v[132:135], v[72:75], v[212:215], v[132:135]
  ds_read_b64_tr_b16 v[68:69], v19 offset:8192
  ds_read_b64_tr_b16 v[70:71], v19 offset:10240
  s_waitcnt vmcnt(7)
  v_mfma_f32_16x16x32_bf16 v[120:123], v[76:79], v[216:219], v[120:123]
  s_waitcnt lgkmcnt(8)
  ds_read_b64_tr_b16 v[72:73], v16 offset:22528
  ds_read_b64_tr_b16 v[74:75], v16 offset:24576
  v_mfma_f32_16x16x32_bf16 v[124:127], v[80:83], v[216:219], v[124:127]
  buffer_load_dwordx4 v[208:211], v4, s[52:55], s18 offen offset:2048 sc1
  ds_read_b64_tr_b16 v[76:77], v17 offset:22528
  ds_read_b64_tr_b16 v[78:79], v17 offset:24576
  v_mfma_f32_16x16x32_bf16 v[128:131], v[84:87], v[216:219], v[128:131]
  ds_read_b64_tr_b16 v[80:81], v18 offset:22528
  ds_read_b64_tr_b16 v[82:83], v18 offset:24576
  v_mfma_f32_16x16x32_bf16 v[132:135], v[88:91], v[216:219], v[132:135]
  s_waitcnt lgkmcnt(8)
  ds_read_b64_tr_b16 v[84:85], v19 offset:22528
  ds_read_b64_tr_b16 v[86:87], v19 offset:24576
  s_waitcnt vmcnt(7)
  v_mfma_f32_16x16x32_bf16 v[120:123], v[92:95], v[220:223], v[120:123]
  buffer_load_dwordx4 v[212:215], v4, s[52:55], s18 offen offset:3072 sc1
  ds_read_b64_tr_b16 v[88:89], v16 offset:12288
  ds_read_b64_tr_b16 v[90:91], v16 offset:26624
  v_mfma_f32_16x16x32_bf16 v[124:127], v[96:99], v[220:223], v[124:127]
  ds_read_b64_tr_b16 v[92:93], v17 offset:12288
  ds_read_b64_tr_b16 v[94:95], v17 offset:26624
  v_mfma_f32_16x16x32_bf16 v[128:131], v[100:103], v[220:223], v[128:131]
  s_waitcnt lgkmcnt(8)
  ds_read_b64_tr_b16 v[96:97], v18 offset:12288
  ds_read_b64_tr_b16 v[98:99], v18 offset:26624
  v_mfma_f32_16x16x32_bf16 v[132:135], v[104:107], v[220:223], v[132:135]
  ds_read_b64_tr_b16 v[100:101], v19 offset:12288
  ds_read_b64_tr_b16 v[102:103], v19 offset:26624
  s_waitcnt vmcnt(7)
  v_mfma_f32_16x16x32_bf16 v[120:123], v[108:111], v[156:159], v[120:123]
  ds_read_b64_tr_b16 v[104:105], v16 offset:36864
  ds_read_b64_tr_b16 v[106:107], v16 offset:38912
  v_mfma_f32_16x16x32_bf16 v[124:127], v[112:115], v[156:159], v[124:127]
  s_waitcnt lgkmcnt(8)
  ds_read_b64_tr_b16 v[108:109], v17 offset:36864
  ds_read_b64_tr_b16 v[110:111], v17 offset:38912
  v_mfma_f32_16x16x32_bf16 v[128:131], v[116:119], v[156:159], v[128:131]
  ds_read_b64_tr_b16 v[112:113], v18 offset:36864
  ds_read_b64_tr_b16 v[114:115], v18 offset:38912
  v_mfma_f32_16x16x32_bf16 v[132:135], v[136:139], v[156:159], v[132:135]
  ds_read_b64_tr_b16 v[116:117], v19 offset:36864
  ds_read_b64_tr_b16 v[118:119], v19 offset:38912
  s_waitcnt vmcnt(6)
  v_mfma_f32_16x16x32_bf16 v[120:123], v[44:47], v[160:163], v[120:123]
  v_lshlrev_b32_e64 v140, 16, v28
  v_and_b32 v141, 0xffff0000, v28
  s_waitcnt lgkmcnt(8)
  ds_read_b64_tr_b16 v[136:137], v16 offset:51200
  ds_read_b64_tr_b16 v[138:139], v16 offset:53248
  v_mfma_f32_16x16x32_bf16 v[124:127], v[48:51], v[160:163], v[124:127]
  v_lshlrev_b32 v142, 16, v29
  v_and_b32 v143, 0xffff0000, v29
  ds_read_b64_tr_b16 v[44:45], v17 offset:51200
  ds_read_b64_tr_b16 v[46:47], v17 offset:53248
  v_mfma_f32_16x16x32_bf16 v[128:131], v[52:55], v[160:163], v[128:131]
  v_lshlrev_b32_e64 v144, 16, v30
  v_and_b32 v145, 0xffff0000, v30
  ds_read_b64_tr_b16 v[48:49], v18 offset:51200
  ds_read_b64_tr_b16 v[50:51], v18 offset:53248
  v_mfma_f32_16x16x32_bf16 v[132:135], v[56:59], v[160:163], v[132:135]
  v_lshlrev_b32_e64 v146, 16, v31
  v_and_b32 v147, 0xffff0000, v31
  s_waitcnt lgkmcnt(8)
  ds_read_b64_tr_b16 v[52:53], v19 offset:51200
  ds_read_b64_tr_b16 v[54:55], v19 offset:53248
  s_waitcnt vmcnt(5)
  v_mfma_f32_16x16x32_bf16 v[120:123], v[60:63], v[164:167], v[120:123]
  v_lshlrev_b32_e64 v148, 16, v32
  v_and_b32 v149, 0xffff0000, v32
  ds_read_b64_tr_b16 v[56:57], v16 offset:40960
  ds_read_b64_tr_b16 v[58:59], v16 offset:55296
  v_mfma_f32_16x16x32_bf16 v[124:127], v[64:67], v[164:167], v[124:127]
  v_lshlrev_b32_e64 v150, 16, v33
  v_and_b32 v151, 0xffff0000, v33
  ds_read_b64_tr_b16 v[60:61], v17 offset:40960
  ds_read_b64_tr_b16 v[62:63], v17 offset:55296
  v_mfma_f32_16x16x32_bf16 v[128:131], v[40:43], v[164:167], v[128:131]
  v_lshlrev_b32_e64 v152, 16, v34
  v_and_b32 v153, 0xffff0000, v34
  s_waitcnt lgkmcnt(8)
  ds_read_b64_tr_b16 v[64:65], v18 offset:40960
  ds_read_b64_tr_b16 v[66:67], v18 offset:55296
  v_mfma_f32_16x16x32_bf16 v[132:135], v[68:71], v[164:167], v[132:135]
  v_lshlrev_b32 v154, 16, v35
  v_and_b32 v155, 0xffff0000, v35
  ds_read_b64_tr_b16 v[40:41], v19 offset:40960
  ds_read_b64_tr_b16 v[42:43], v19 offset:55296
  s_waitcnt vmcnt(4)
  v_mfma_f32_16x16x32_bf16 v[120:123], v[72:75], v[196:199], v[120:123]
  s_mul_i32 s65, s56, 2304
  s_add_u32 s65, s65, 114688
  v_mfma_f32_16x16x32_bf16 v[124:127], v[76:79], v[196:199], v[124:127]
  v_mul_u32_u24 v11, 144, v2
  v_lshl_add_u32 v11, v3, 3, v11
  v_mfma_f32_16x16x32_bf16 v[128:131], v[80:83], v[196:199], v[128:131]
  v_add_u32 v11, s65, v11
  v_lshrrev_b32_e64 v6, 3, v1
  v_mfma_f32_16x16x32_bf16 v[132:135], v[84:87], v[196:199], v[132:135]
  v_and_b32_e64 v7, 7, v1
  v_mul_u32_u24 v12, 144, v6
  s_waitcnt vmcnt(3)
  v_mfma_f32_16x16x32_bf16 v[120:123], v[88:91], v[200:203], v[120:123]
  v_lshl_add_u32 v12, v7, 4, v12
  v_add_u32 v12, s65, v12
  v_mfma_f32_16x16x32_bf16 v[124:127], v[92:95], v[200:203], v[124:127]
  v_lshlrev_b32_e64 v13, 10, v6
  v_lshl_add_u32 v13, v7, 4, v13
  v_mfma_f32_16x16x32_bf16 v[128:131], v[96:99], v[200:203], v[128:131]
  s_add_u32 s85, s74, 8192
  v_mfma_f32_16x16x32_bf16 v[132:135], v[100:103], v[200:203], v[132:135]
  ds_read_b128 v[224:227], v10 offset:768
  s_waitcnt vmcnt(2)
  v_mfma_f32_16x16x32_bf16 v[120:123], v[104:107], v[204:207], v[120:123]
  ds_read_b128 v[228:231], v10 offset:832
  v_mfma_f32_16x16x32_bf16 v[124:127], v[108:111], v[204:207], v[124:127]
  ds_read_b128 v[232:235], v10 offset:896
  v_mfma_f32_16x16x32_bf16 v[128:131], v[112:115], v[204:207], v[128:131]
  ds_read_b128 v[236:239], v10 offset:960
  v_mfma_f32_16x16x32_bf16 v[132:135], v[116:119], v[204:207], v[132:135]
  s_waitcnt vmcnt(1)
  v_mfma_f32_16x16x32_bf16 v[120:123], v[136:139], v[208:211], v[120:123]
  v_mfma_f32_16x16x32_bf16 v[124:127], v[44:47], v[208:211], v[124:127]
  s_waitcnt lgkmcnt(8)
  v_mfma_f32_16x16x32_bf16 v[128:131], v[48:51], v[208:211], v[128:131]
  v_mfma_f32_16x16x32_bf16 v[132:135], v[52:55], v[208:211], v[132:135]
  s_waitcnt vmcnt(0)
  v_mfma_f32_16x16x32_bf16 v[120:123], v[56:59], v[212:215], v[120:123]
  v_mfma_f32_16x16x32_bf16 v[124:127], v[60:63], v[212:215], v[124:127]
  s_waitcnt lgkmcnt(4)
  v_mfma_f32_16x16x32_bf16 v[128:131], v[64:67], v[212:215], v[128:131]
  v_mfma_f32_16x16x32_bf16 v[132:135], v[40:43], v[212:215], v[132:135]
  s_waitcnt lgkmcnt(0)
  s_nop 2
  v_pk_fma_f32 v[120:121], v[120:121], v[224:225], v[140:141]
  v_pk_fma_f32 v[122:123], v[122:123], v[226:227], v[142:143]
  v_cvt_pk_bf16_f32 v120, v120, v121
  v_cvt_pk_bf16_f32 v121, v122, v123
  ds_write_b64 v11, v[120:121] offset:0
  v_pk_fma_f32 v[124:125], v[124:125], v[228:229], v[144:145]
  v_pk_fma_f32 v[126:127], v[126:127], v[230:231], v[146:147]
  v_cvt_pk_bf16_f32 v124, v124, v125
  v_cvt_pk_bf16_f32 v125, v126, v127
  ds_write_b64 v11, v[124:125] offset:32
  v_pk_fma_f32 v[128:129], v[128:129], v[232:233], v[148:149]
  v_pk_fma_f32 v[130:131], v[130:131], v[234:235], v[150:151]
  v_cvt_pk_bf16_f32 v128, v128, v129
  v_cvt_pk_bf16_f32 v129, v130, v131
  ds_write_b64 v11, v[128:129] offset:64
  v_pk_fma_f32 v[132:133], v[132:133], v[236:237], v[152:153]
  v_pk_fma_f32 v[134:135], v[134:135], v[238:239], v[154:155]
  v_cvt_pk_bf16_f32 v132, v132, v133
  v_cvt_pk_bf16_f32 v133, v134, v135
  ds_write_b64 v11, v[132:133] offset:96
  ds_read_b128 v[140:143], v12
  ds_read_b128 v[144:147], v12 offset:1152
  s_waitcnt lgkmcnt(1)
  buffer_store_dwordx4 v[140:143], v13, s[48:51], s74 offen
  s_waitcnt lgkmcnt(0)
  buffer_store_dwordx4 v[144:147], v13, s[48:51], s85 offen
L_end:
  s_endpgm
L_giveup_25:
  s_waitcnt vmcnt(0)
  s_mov_b32 s63, 1
  s_branch L_pdone_24
L_rare_21:
  s_mov_b32 s64, s63
L_poll_23:
  buffer_load_dword v36, v9, s[52:55], s85 offen sc1
  s_sub_u32 s64, s64, 1
  s_cbranch_scc1 L_giveup_25
  s_waitcnt vmcnt(0)
  v_xor_b32 v6, s61, v36
  v_lshrrev_b32 v6, 4, v6
  v_cmp_ne_u32 vcc, 0, v6
  s_cbranch_vccnz L_poll_23
L_pdone_24:
  s_branch L_back_22
L_giveup_29:
  s_waitcnt vmcnt(0)
  s_mov_b32 s63, 1
  s_branch L_pdone_28
L_giveup_35:
  s_waitcnt vmcnt(0)
  s_mov_b32 s63, 1
  s_branch L_pdone_34
L_far_39:
  buffer_store_dwordx4 v[60:63], v10, s[52:55], s65 offen offset:0 sc1
  buffer_store_dwordx4 v[64:67], v10, s[52:55], s65 offen offset:2048 sc1
  buffer_store_dwordx4 v[68:71], v10, s[52:55], s66 offen offset:0 sc1
  buffer_store_dwordx4 v[72:75], v10, s[52:55], s66 offen offset:2048 sc1
  s_branch L_stored_40
L_far_41:
  buffer_store_dword v56, v10, s[52:55], s85 offen sc1
  s_branch L_stored_42
L_far_47:
  buffer_store_dwordx2 v[56:57], v10, s[52:55], s86 offen sc1
  s_branch L_stored_48
L_giveup_57:
  s_waitcnt vmcnt(0)
  s_mov_b32 s63, 1
  s_branch L_pdone_56
L_rare_53:
  s_mov_b32 s64, s63
L_poll_55:
  buffer_load_dwordx2 v[56:57], v10, s[52:55], s85 offen sc1
  s_sub_u32 s64, s64, 1
  s_cbranch_scc1 L_giveup_57
  s_waitcnt vmcnt(0)
  v_cmp_ne_u32 vcc, s61, v56
  s_cbranch_vccnz L_poll_55
L_pdone_56:
  s_branch L_back_54
L_rare_58:
  s_lshl_b32 s66, s57, 7
  s_add_u32 s66, s66, 4096
  v_max_f32_dpp v57, v57, v57 quad_perm:[1,0,3,2] row_mask:0xf bank_mask:0xf
  s_nop 1
  v_max_f32_dpp v57, v57, v57 quad_perm:[2,3,0,1] row_mask:0xf bank_mask:0xf
  s_nop 1
  v_max_f32_dpp v57, v57, v57 row_half_mirror row_mask:0xf bank_mask:0xf
  s_nop 1
  v_max_f32_dpp v57, v57, v57 row_mirror row_mask:0xf bank_mask:0xf
  v_mov_b32 v37, v57
  s_nop 1
  v_permlane16_swap_b32 v57, v37
  v_max_f32 v57, v57, v37
  v_mov_b32 v37, v57
  s_nop 1
  v_permlane32_swap_b32 v57, v37
  v_max_f32 v57, v57, v37
  v_mov_b32_e64 v56, s61
  s_mov_b64 exec, 1
  buffer_store_dwordx2 v[56:57], v10, s[52:55], s66 offen sc1
  s_mov_b64 exec, -1
  s_branch L_back_59
L_giveup_64:
  s_waitcnt vmcnt(0)
  s_mov_b32 s63, 1
  s_branch L_pdone_63
L_rare_60:
  s_mov_b32 s64, s63
L_poll_62:
  buffer_load_dwordx2 v[56:57], v38, s[52:55], s85 offen sc1
  s_sub_u32 s64, s64, 1
  s_cbranch_scc1 L_giveup_64
  s_waitcnt vmcnt(0)
  v_cmp_ne_u32 vcc, s61, v56
  s_cbranch_vccnz L_poll_62
L_pdone_63:
  s_branch L_back_61
L_rare_65:
  v_mov_b32 v56, s61
  v_mov_b32_e64 v140, 0
  s_mov_b64 exec, 1
  buffer_store_dword v56, v140, s[52:55], 0 offen sc1
  s_mov_b64 exec, -1
  s_branch L_back_66
L_rare_67:
  s_nop 7
  s_nop 7
  s_waitcnt lgkmcnt(0)
  v_mov_b32 v142, 0xff7fffff
  v_mov_b32 v143, 0xff7fffff
  s_mov_b32 s92, 65536
L_mx_69:
  buffer_load_dwordx4 v[184:187], v4, s[52:55], s92 offen sc1
  s_waitcnt vmcnt(0)
  v_mfma_f32_32x32x16_bf16 v[92:107], v[184:187], v[48:51], 0
  v_mfma_f32_32x32x16_bf16 v[108:123], v[184:187], v[52:55], 0
  s_nop 10
  v_max3_f32 v142, v142, v92, v93
  v_max3_f32 v142, v142, v94, v95
  v_max3_f32 v142, v142, v96, v97
  v_max3_f32 v142, v142, v98, v99
  v_max3_f32 v142, v142, v100, v101
  v_max3_f32 v142, v142, v102, v103
  v_max3_f32 v142, v142, v104, v105
  v_max3_f32 v142, v142, v106, v107
  v_max3_f32 v143, v143, v108, v109
  v_max3_f32 v143, v143, v110, v111
  v_max3_f32 v143, v143, v112, v113
  v_max3_f32 v143, v143, v114, v115
  v_max3_f32 v143, v143, v116, v117
  v_max3_f32 v143, v143, v118, v119
  v_max3_f32 v143, v143, v120, v121
  v_max3_f32 v143, v143, v122, v123
  s_add_u32 s92, s92, 2048
  s_cmp_lt_u32 s92, 196608
  s_cbranch_scc1 L_mx_69
  v_mov_b32 v145, v142
  s_nop 1
  v_permlane32_swap_b32 v142, v145
  v_max_f32 v142, v142, v145
  v_mov_b32 v145, v143
  s_nop 1
  v_permlane32_swap_b32 v143, v145
  v_max_f32 v143, v143, v145
  v_and_b32 v6, 27, v1
  v_cmp_eq_u32 vcc, 16, v6
  v_mov_b32 v7, s69
  s_nop 0
  v_cndmask_b32 v192, 0, v7, vcc
  v_mov_b32 v193, v192
  v_mov_b32 v194, v192
  v_mov_b32 v195, v192
  v_mov_b32 v196, v192
  v_mov_b32 v197, v192
  v_mov_b32 v198, v192
  v_mov_b32 v199, v192
  v_lshrrev_b32 v6, 5, v1
  v_lshlrev_b32 v6, 8, v6
  v_lshl_add_u32 v6, v2, 4, v6
  v_sub_f32 v168, 0, v142
  v_mov_b32 v92, 0
  v_mov_b32 v60, 0
  v_sub_f32 v169, 0, v142
  v_mov_b32 v93, 0
  v_mov_b32 v61, 0
  v_sub_f32 v170, 0, v142
  v_mov_b32 v94, 0
  v_mov_b32 v62, 0
  v_sub_f32 v171, 0, v142
  v_mov_b32 v95, 0
  v_mov_b32 v63, 0
  v_sub_f32 v172, 0, v142
  v_mov_b32 v96, 0
  v_mov_b32 v64, 0
  v_sub_f32 v173, 0, v142
  v_mov_b32 v97, 0
  v_mov_b32 v65, 0
  v_sub_f32 v174, 0, v142
  v_mov_b32 v98, 0
  v_mov_b32 v66, 0
  v_sub_f32 v175, 0, v142
  v_mov_b32 v99, 0
  v_mov_b32 v67, 0
  v_sub_f32 v176, 0, v142
  v_mov_b32 v100, 0
  v_mov_b32 v68, 0
  v_sub_f32 v177, 0, v142
  v_mov_b32 v101, 0
  v_mov_b32 v69, 0
  v_sub_f32 v178, 0, v142
  v_mov_b32 v102, 0
  v_mov_b32 v70, 0
  v_sub_f32 v179, 0, v142
  v_mov_b32 v103, 0
  v_mov_b32 v71, 0
  v_sub_f32 v180, 0, v142
  v_mov_b32 v104, 0
  v_mov_b32 v72, 0
  v_sub_f32 v181, 0, v142
  v_mov_b32 v105, 0
  v_mov_b32 v73, 0
  v_sub_f32 v182, 0, v142
  v_mov_b32 v106, 0
  v_mov_b32 v74, 0
  v_sub_f32 v183, 0, v142
  v_mov_b32 v107, 0
  v_mov_b32 v75, 0
  s_mov_b32 s92, 65536
L_redo_70:
  buffer_load_dwordx4 v[184:187], v4, s[52:55], s92 offen sc1
  s_mov_b32 exec_lo, 0xffff
  s_mov_b32 exec_hi, 0xffff
  buffer_load_dwordx4 v[192:195], v6, s[52:55], s92 offen offset:1024 sc1
  buffer_load_dwordx4 v[196:199], v6, s[52:55], s92 offen offset:1536 sc1
  s_mov_b64 exec, -1
  s_waitcnt vmcnt(0)
  v_mfma_f32_32x32x16_bf16 v[152:167], v[184:187], v[48:51], v[168:183]
  s_nop 11
  v_exp_f32 v152, v152
  v_exp_f32 v153, v153
  v_exp_f32 v154, v154
  v_exp_f32 v155, v155
  v_exp_f32 v156, v156
  v_exp_f32 v157, v157
  v_exp_f32 v158, v158
  v_exp_f32 v159, v159
  v_exp_f32 v160, v160
  v_exp_f32 v161, v161
  v_exp_f32 v162, v162
  v_exp_f32 v163, v163
  v_exp_f32 v164, v164
  v_exp_f32 v165, v165
  v_exp_f32 v166, v166
  v_exp_f32_e64 v167, v167
  v_cvt_pk_bf16_f32 v124, v152, v153
  v_cvt_pk_bf16_f32 v125, v154, v155
  v_cvt_pk_bf16_f32 v126, v156, v157
  v_cvt_pk_bf16_f32 v127, v158, v159
  v_cvt_pk_bf16_f32 v128, v160, v161
  v_cvt_pk_bf16_f32 v129, v162, v163
  v_cvt_pk_bf16_f32 v130, v164, v165
  v_cvt_pk_bf16_f32 v131, v166, v167
  v_mfma_f32_32x32x16_bf16 v[92:107], v[192:195], v[124:127], v[92:107]
  s_nop 0
  v_mfma_f32_32x32x16_bf16 v[92:107], v[196:199], v[128:131], v[92:107]
  s_add_u32 s92, s92, 2048
  s_nop 7
  s_cmp_lt_u32 s92, 196608
  s_cbranch_scc1 L_redo_70
  s_nop 7
  v_sub_f32 v168, 0, v143
  v_mov_b32 v108, 0
  v_mov_b32 v76, 0
  v_sub_f32 v169, 0, v143
  v_mov_b32 v109, 0
  v_mov_b32 v77, 0
  v_sub_f32 v170, 0, v143
  v_mov_b32 v110, 0
  v_mov_b32 v78, 0
  v_sub_f32 v171, 0, v143
  v_mov_b32 v111, 0
  v_mov_b32 v79, 0
  v_sub_f32 v172, 0, v143
  v_mov_b32 v112, 0
  v_mov_b32 v80, 0
  v_sub_f32 v173, 0, v143
  v_mov_b32 v113, 0
  v_mov_b32 v81, 0
  v_sub_f32 v174, 0, v143
  v_mov_b32 v114, 0
  v_mov_b32 v82, 0
  v_sub_f32 v175, 0, v143
  v_mov_b32 v115, 0
  v_mov_b32 v83, 0
  v_sub_f32 v176, 0, v143
  v_mov_b32 v116, 0
  v_mov_b32 v84, 0
  v_sub_f32 v177, 0, v143
  v_mov_b32 v117, 0
  v_mov_b32 v85, 0
  v_sub_f32 v178, 0, v143
  v_mov_b32 v118, 0
  v_mov_b32 v86, 0
  v_sub_f32 v179, 0, v143
  v_mov_b32 v119, 0
  v_mov_b32 v87, 0
  v_sub_f32 v180, 0, v143
  v_mov_b32 v120, 0
  v_mov_b32 v88, 0
  v_sub_f32 v181, 0, v143
  v_mov_b32 v121, 0
  v_mov_b32 v89, 0
  v_sub_f32 v182, 0, v143
  v_mov_b32 v122, 0
  v_mov_b32 v90, 0
  v_sub_f32 v183, 0, v143
  v_mov_b32 v123, 0
  v_mov_b32 v91, 0
  s_mov_b32 s92, 65536
L_redo_71:
  buffer_load_dwordx4 v[184:187], v4, s[52:55], s92 offen sc1
  s_mov_b32 exec_lo, 0xffff
  s_mov_b32 exec_hi, 0xffff
  buffer_load_dwordx4 v[192:195], v6, s[52:55], s92 offen offset:1024 sc1
  buffer_load_dwordx4 v[196:199], v6, s[52:55], s92 offen offset:1536 sc1
  s_mov_b64 exec, -1
  s_waitcnt vmcnt(0)
  v_mfma_f32_32x32x16_bf16 v[152:167], v[184:187], v[52:55], v[168:183]
  s_nop 11
  v_exp_f32 v152, v152
  v_exp_f32 v153, v153
  v_exp_f32 v154, v154
  v_exp_f32 v155, v155
  v_exp_f32 v156, v156
  v_exp_f32 v157, v157
  v_exp_f32 v158, v158
  v_exp_f32 v159, v159
  v_exp_f32 v160, v160
  v_exp_f32 v161, v161
  v_exp_f32 v162, v162
  v_exp_f32 v163, v163
  v_exp_f32 v164, v164
  v_exp_f32 v165, v165
  v_exp_f32 v166, v166
  v_exp_f32_e64 v167, v167
  v_cvt_pk_bf16_f32 v124, v152, v153
  v_cvt_pk_bf16_f32 v125, v154, v155
  v_cvt_pk_bf16_f32 v126, v156, v157
  v_cvt_pk_bf16_f32 v127, v158, v159
  v_cvt_pk_bf16_f32 v128, v160, v161
  v_cvt_pk_bf16_f32 v129, v162, v163
  v_cvt_pk_bf16_f32 v130, v164, v165
  v_cvt_pk_bf16_f32 v131, v166, v167
  v_mfma_f32_32x32x16_bf16 v[108:123], v[192:195], v[124:127], v[108:123]
  s_nop 0
  v_mfma_f32_32x32x16_bf16 v[108:123], v[196:199], v[128:131], v[108:123]
  s_add_u32 s92, s92, 2048
  s_nop 7
  s_cmp_lt_u32 s92, 196608
  s_cbranch_scc1 L_redo_71
  s_nop 7
  s_nop 7
  s_branch L_back_68
L_far_72:
  buffer_store_dwordx4 v[60:63], v144, s[52:55], s85 offen sc1
  buffer_store_dwordx4 v[76:79], v144, s[52:55], s85 offen offset:512 sc1
  s_branch L_stored_73
L_far_74:
  buffer_store_dword v12, off, s[52:55], s66 offset:512 sc1
  s_branch L_stored_75
L_giveup_80:
  s_waitcnt vmcnt(0)
  s_mov_b32 s63, 1
  s_branch L_pdone_79
L_rare_76:
  s_mov_b32 s64, s63
L_poll_78:
  buffer_load_dwordx2 v[208:209], v37, s[52:55], s84 offen offset:0 sc1
  buffer_load_dwordx2 v[210:211], v37, s[52:55], s84 offen offset:512 sc1
  buffer_load_dwordx2 v[212:213], v37, s[52:55], s84 offen offset:1024 sc1
  buffer_load_dwordx2 v[214:215], v37, s[52:55], s84 offen offset:1536 sc1
  buffer_load_dwordx2 v[216:217], v37, s[52:55], s84 offen offset:2048 sc1
  buffer_load_dwordx2 v[218:219], v37, s[52:55], s84 offen offset:2560 sc1
  buffer_load_dwordx2 v[220:221], v37, s[52:55], s84 offen offset:3072 sc1
  buffer_load_dwordx2 v[222:223], v37, s[52:55], s84 offen offset:3584 sc1
  s_sub_u32 s64, s64, 1
  s_cbranch_scc1 L_giveup_80
  s_waitcnt vmcnt(0)
  v_min3_u32 v6, v209, v211, v213
  v_max3_u32 v7, v209, v211, v213
  v_min3_u32 v6, v6, v215, v217
  v_max3_u32 v7, v7, v215, v217
  v_min3_u32 v6, v6, v219, v221
  v_max3_u32 v7, v7, v219, v221
  v_min_u32 v6, v6, v223
  v_max_u32 v7, v7, v223
  v_xor_b32 v6, s61, v6
  v_xor_b32 v7, s61, v7
  v_or_b32_e64 v6, v6, v7
  v_cmp_ne_u32 vcc, 0, v6
  s_cbranch_vccnz L_poll_78
L_pdone_79:
  s_branch L_back_77
L_far_83:
  buffer_store_dwordx4 v[240:243], v4, s[52:55], s86 offen sc1
  s_branch L_stored_84
L_giveup_87:
  s_waitcnt vmcnt(0)
  s_mov_b32 s63, 1
  s_branch L_pdone_86
L_far_88:
  buffer_store_dwordx4 v[96:99], v4, s[52:55], s85 offen sc1
  buffer_store_dwordx4 v[100:103], v4, s[52:55], s85 offen offset:1024 sc1
  s_branch L_stored_89
L_far_90:
  buffer_store_dword v23, off, s[52:55], s66 offset:1024 sc1
  s_branch L_stored_91
L_far_94:
  buffer_store_dwordx4 v[64:67], v4, s[52:55], s86 offen sc1
  s_branch L_stored_95
L_giveup_104:
  s_waitcnt vmcnt(0)
  s_mov_b32 s63, 1
  s_branch L_pdone_103
L_rare_100:
  s_mov_b32 s64, s63
L_poll_102:
  buffer_load_dword v41, v23, s[52:55], s85 offen sc1
  s_sub_u32 s64, s64, 1
  s_cbranch_scc1 L_giveup_104
  s_waitcnt vmcnt(0)
  v_cmp_ne_u32 vcc, s61, v41
  s_cbranch_vccnz L_poll_102
L_pdone_103:
  s_branch L_back_101
L_far_105:
  buffer_store_dwordx4 v[168:171], v4, s[52:55], s85 offen offset:0 sc1
  buffer_store_dwordx4 v[172:175], v4, s[52:55], s85 offen offset:1024 sc1
  s_branch L_stored_106
L_far_107:
  buffer_store_dword v36, off, s[52:55], s93 offset:0 sc1
  s_branch L_stored_108
L_giveup_113:
  s_waitcnt vmcnt(0)
  s_mov_b32 s63, 1
  s_branch L_pdone_112
L_rare_109:
  s_mov_b32 s64, s63
L_poll_111:
  buffer_load_dword v36, v23, s[52:55], s90 offen offset:0 sc1
  s_sub_u32 s64, s64, 1
  s_cbranch_scc1 L_giveup_113
  s_waitcnt vmcnt(0)
  v_cmp_ne_u32 vcc, s61, v36
  s_cbranch_vccnz L_poll_111
L_pdone_112:
  s_branch L_back_110
L_far_114:
  buffer_store_dwordx4 v[176:179], v4, s[52:55], s85 offen offset:2048 sc1
  s_branch L_stored_115
L_far_116:
  buffer_store_dwordx2 v[180:181], v4, s[52:55], s84 offen sc1
  s_branch L_stored_117
L_far_118:
  buffer_store_dword v36, off, s[52:55], s93 offset:64 sc1
  s_branch L_stored_119
L_giveup_124:
  s_waitcnt vmcnt(0)
  s_mov_b32 s63, 1
  s_branch L_pdone_123
L_rare_120:
  s_mov_b32 s64, s63
L_poll_122:
  buffer_load_dword v36, v23, s[52:55], s90 offen offset:64 sc1
  s_sub_u32 s64, s64, 1
  s_cbranch_scc1 L_giveup_124
  s_waitcnt vmcnt(0)
  v_cmp_ne_u32 vcc, s61, v36
  s_cbranch_vccnz L_poll_122
L_pdone_123:
  s_branch L_back_121
L_code_end:
.section .rodata,"a"
.p2align 6
.amdhsa_kernel adaLN_cond__grouped_kv_mqa__mixer_gmlp__prompt_kernel
  .amdhsa_next_free_vgpr 512
  .amdhsa_next_free_sgpr 102
  .amdhsa_accum_offset 256
  .amdhsa_group_segment_fixed_size 0
  .amdhsa_kernarg_size 120
  .amdhsa_user_sgpr_count 2
  .amdhsa_user_sgpr_kernarg_segment_ptr 1
  .amdhsa_system_sgpr_workgroup_id_x 1
.end_amdhsa_kernel
```
